```python
import torch

def _softmax(x, axis=-1):
    return torch.softmax(x, dim=axis)
def _gelu(x):
    return torch.nn.functional.gelu(x, approximate="tanh")
def _silu(x):
    return torch.nn.functional.silu(x)
def _sigmoid(x):
    return torch.sigmoid(x)
def _layernorm(x, axis=-1, eps=1e-5):
    m = x.mean(dim=axis, keepdim=True)
    v = x.var(dim=axis, keepdim=True, unbiased=False)
    return (x - m) / torch.sqrt(v + eps)
def _scatter_add(tgt, idx, src, axis=0):
    return tgt.clone().index_add_(axis, idx, src)
def _segment_sum(src, seg, n):
    out = torch.zeros((n,) + src.shape[1:], dtype=src.dtype)
    return out.index_add_(0, seg, src)
def _pad(x, pw):
    flat = tuple(v for pair in reversed(pw) for v in pair)
    return torch.nn.functional.pad(x, flat)

kernel_name = 'standalone__molecular_angular_gemnet__graph'

def setup_inputs():

    _w = (lambda a: (lambda t: t.to(torch.bfloat16) if t.is_floating_point() else t)(torch.as_tensor(a)))
    N, deg, De, L = 25000, 32, 4, 2
    E = N * deg
    T = E * deg
    NR = 8
    dist = torch.rand(E).to(float)
    angle = (torch.rand(T) * torch.pi).to(float)
    centers = torch.linspace(0.0, 1.0, NR).to(float)
    ang_freq = torch.arange(1, L + 1).to(float)
    return {
        "m": _w((lambda *s: torch.randn(*s, dtype=torch.bfloat16) * 0.05)(E, De)),
        "idx_in": _w((lambda lo, hi, *s: torch.randint(lo, hi, s))(0, E, T).to(torch.int64)),
        "idx_out": _w((lambda lo, hi, *s: torch.randint(lo, hi, s))(0, E, T).to(torch.int64)),
        "dist": _w(dist),
        "angle": _w(angle),
        "centers": _w(centers),
        "ang_freq": _w(ang_freq),
        "w_rbf": _w((lambda *s: torch.randn(*s, dtype=torch.bfloat16) * 0.2)(NR, De)),
        "w_sbf": _w((lambda *s: torch.randn(*s, dtype=torch.bfloat16) * 0.2)(NR * L, De)),
        "w_down": _w((lambda *s: torch.randn(*s, dtype=torch.bfloat16) * 0.2)(De, De)),
        "w_up": _w((lambda *s: torch.randn(*s, dtype=torch.bfloat16) * 0.2)(De, De)),
    }

def reference(m, idx_in, idx_out, dist, angle, centers, ang_freq, w_rbf, w_sbf, w_down, w_up):
    E, De = m.shape[0], m.shape[1]
    NR = centers.shape[0]
    L = ang_freq.shape[0]
    rbf = torch.exp(-10.0 * (dist[:, None] - centers[None, :]) ** 2)
    cbf = torch.cos(ang_freq[None, :] * angle[:, None])
    rbf_t = rbf[idx_out]
    sbf = torch.reshape(rbf_t[:, :, None] * cbf[:, None, :], (-1, NR * L))
    x = (m[idx_in] @ w_down) * (sbf @ w_sbf)
    agg = _segment_sum(x, idx_out, E)
    return m + (agg @ w_up) * (rbf @ w_rbf)
```

```asm
; @launch kernel=gemnet_part_kernel grid=(250,1,1) block=(1024,1,1) lds=161920
; @launch kernel=gemnet_accum_kernel grid=(256,1,1) block=(1024,1,1) lds=163632
.amdgcn_target "amdgcn-amd-amdhsa--gfx950"
.text
.globl gemnet_part_kernel
.p2align 8
.type gemnet_part_kernel,@function
gemnet_part_kernel:
    s_cmp_ge_u32 s2, 250
    s_cbranch_scc1 gemnet_part_kernel_done
    s_load_dwordx4 s[4:7], s[0:1], 8
    s_load_dwordx2 s[8:9], s[0:1], 32
    s_load_dwordx2 s[10:11], s[0:1], 104
    v_lshlrev_b32 v1, 4, v0
    v_lshlrev_b32 v2, 2, v0
    v_mov_b32 v3, 1
    v_lshrrev_b32 v29, 6, v0
    s_mov_b32 s32, 1374390
    s_mov_b32 s33, 4294964171
    v_readfirstlane_b32 s43, v29
    s_mov_b32 s34, 4294867296
    s_mov_b32 s46, 0
    s_mov_b32 s47, 0x80000000
    s_waitcnt lgkmcnt(0)
    s_mov_b32 s12, s4
    s_and_b32 s13, s5, 0xffff
    s_mov_b32 s14, 102400000
    s_mov_b32 s15, 0x00020000
    s_mov_b32 s16, s6
    s_and_b32 s17, s7, 0xffff
    s_mov_b32 s18, 102400000
    s_mov_b32 s19, 0x00020000
    s_mov_b32 s20, s8
    s_and_b32 s21, s9, 0xffff
    s_mov_b32 s22, 51200000
    s_mov_b32 s23, 0x00020000
    s_mov_b32 s24, s10
    s_and_b32 s25, s11, 0xffff
    s_mov_b32 s26, 153600000
    s_mov_b32 s27, 0x00020000
    s_add_u32 s10, s10, 153600000
    s_addc_u32 s11, s11, 0
    s_mov_b32 s28, s10
    s_and_b32 s29, s11, 0xffff
    s_mov_b32 s30, 4112000
    s_mov_b32 s31, 0x00020000
    s_mul_i32 s35, s2, 102400
    s_mul_i32 s36, s2, 51200
    s_mul_i32 s37, s2, 153600
    s_mul_i32 s38, s2, 4112
    s_add_u32 s40, s35, 0
    buffer_load_dwordx4 v[30:33], v1, s[16:19], s40 offen nt
    buffer_load_dwordx4 v[4:7], v1, s[12:15], s40 offen nt
    s_add_u32 s41, s35, 16384
    buffer_load_dwordx4 v[34:37], v1, s[16:19], s41 offen nt
    buffer_load_dwordx4 v[8:11], v1, s[12:15], s41 offen nt
    s_add_u32 s40, s35, 32768
    buffer_load_dwordx4 v[38:41], v1, s[16:19], s40 offen nt
    buffer_load_dwordx4 v[12:15], v1, s[12:15], s40 offen nt
    s_add_u32 s41, s35, 49152
    buffer_load_dwordx4 v[42:45], v1, s[16:19], s41 offen nt
    buffer_load_dwordx4 v[16:19], v1, s[12:15], s41 offen nt
    s_add_u32 s40, s35, 65536
    buffer_load_dwordx4 v[46:49], v1, s[16:19], s40 offen nt
    buffer_load_dwordx4 v[20:23], v1, s[12:15], s40 offen nt
    s_add_u32 s41, s35, 81920
    buffer_load_dwordx4 v[50:53], v1, s[16:19], s41 offen nt
    buffer_load_dwordx4 v[24:27], v1, s[12:15], s41 offen nt
    s_add_u32 s40, s35, 98304
    buffer_load_dword v54, v2, s[16:19], s40 offen nt
    buffer_load_dword v28, v2, s[12:15], s40 offen nt
    v_lshlrev_b32 v122, 16, v0
    v_add_u32 v123, 0x8000, v122
    v_lshlrev_b32 v124, 3, v0
    ds_write_b64 v124, v[122:123] offset:0
    v_mov_b32 v125, 4227884032
    v_mov_b32 v126, 8192
    ds_write_b32 v126, v125 offset:0
    s_waitcnt lgkmcnt(0)
    s_barrier
    s_mov_b32 s44, 0
    s_waitcnt vmcnt(0)
    v_lshlrev_b32 v29, 3, v0
    v_lshlrev_b32 v55, 1, v0
    s_add_u32 s40, s36, 0
    buffer_load_dwordx2 v[108:109], v29, s[20:23], s40 offen nt
    s_add_u32 s41, s36, 8192
    buffer_load_dwordx2 v[110:111], v29, s[20:23], s41 offen nt
    s_add_u32 s40, s36, 16384
    buffer_load_dwordx2 v[112:113], v29, s[20:23], s40 offen nt
    s_add_u32 s41, s36, 24576
    buffer_load_dwordx2 v[114:115], v29, s[20:23], s41 offen nt
    s_add_u32 s40, s36, 32768
    buffer_load_dwordx2 v[116:117], v29, s[20:23], s40 offen nt
    s_add_u32 s41, s36, 40960
    buffer_load_dwordx2 v[118:119], v29, s[20:23], s41 offen nt
    s_add_u32 s42, s36, 49152
    buffer_load_ushort v120, v55, s[20:23], s42 offen nt
    s_add_u32 s39, s35, 25600000
    v_mul_hi_u32_u24 v81, s32, v30
    v_lshrrev_b32 v121, 5, v4
    v_mad_i32_i24 v107, v81, s33, v30
    v_mul_hi_u32_u24 v121, s32, v121
    v_lshlrev_b32 v30, 2, v81
    v_mad_i32_i24 v4, v121, s34, v4
    v_lshl_add_u32 v30, v121, 10, v30
    v_lshlrev_b32 v4, 3, v4
    ds_add_rtn_u32 v30, v30, v3 offset:0
    v_lshl_or_b32 v4, v107, 20, v4
    v_mul_hi_u32_u24 v81, s32, v31
    v_lshrrev_b32 v121, 5, v5
    v_mad_i32_i24 v107, v81, s33, v31
    v_mul_hi_u32_u24 v121, s32, v121
    v_lshlrev_b32 v31, 2, v81
    v_mad_i32_i24 v5, v121, s34, v5
    v_lshl_add_u32 v31, v121, 10, v31
    v_lshlrev_b32 v5, 3, v5
    ds_add_rtn_u32 v31, v31, v3 offset:0
    v_lshl_or_b32 v5, v107, 20, v5
    v_mul_hi_u32_u24 v81, s32, v32
    v_lshrrev_b32 v121, 5, v6
    v_mad_i32_i24 v107, v81, s33, v32
    v_mul_hi_u32_u24 v121, s32, v121
    v_lshlrev_b32 v32, 2, v81
    v_mad_i32_i24 v6, v121, s34, v6
    v_lshl_add_u32 v32, v121, 10, v32
    v_lshlrev_b32 v6, 3, v6
    ds_add_rtn_u32 v32, v32, v3 offset:0
    v_lshl_or_b32 v6, v107, 20, v6
    v_mul_hi_u32_u24 v81, s32, v33
    v_lshrrev_b32 v121, 5, v7
    v_mad_i32_i24 v107, v81, s33, v33
    v_mul_hi_u32_u24 v121, s32, v121
    v_lshlrev_b32 v33, 2, v81
    v_mad_i32_i24 v7, v121, s34, v7
    v_lshl_add_u32 v33, v121, 10, v33
    v_lshlrev_b32 v7, 3, v7
    ds_add_rtn_u32 v33, v33, v3 offset:0
    v_lshl_or_b32 v7, v107, 20, v7
    v_mul_hi_u32_u24 v81, s32, v34
    v_lshrrev_b32 v121, 5, v8
    v_mad_i32_i24 v107, v81, s33, v34
    v_mul_hi_u32_u24 v121, s32, v121
    v_lshlrev_b32 v34, 2, v81
    v_mad_i32_i24 v8, v121, s34, v8
    v_lshl_add_u32 v34, v121, 10, v34
    v_lshlrev_b32 v8, 3, v8
    ds_add_rtn_u32 v34, v34, v3 offset:0
    v_lshl_or_b32 v8, v107, 20, v8
    v_mul_hi_u32_u24 v81, s32, v35
    v_lshrrev_b32 v121, 5, v9
    v_mad_i32_i24 v107, v81, s33, v35
    v_mul_hi_u32_u24 v121, s32, v121
    v_lshlrev_b32 v35, 2, v81
    v_mad_i32_i24 v9, v121, s34, v9
    v_lshl_add_u32 v35, v121, 10, v35
    v_lshlrev_b32 v9, 3, v9
    ds_add_rtn_u32 v35, v35, v3 offset:0
    v_lshl_or_b32 v9, v107, 20, v9
    v_mul_hi_u32_u24 v81, s32, v36
    v_lshrrev_b32 v121, 5, v10
    v_mad_i32_i24 v107, v81, s33, v36
    v_mul_hi_u32_u24 v121, s32, v121
    v_lshlrev_b32 v36, 2, v81
    v_mad_i32_i24 v10, v121, s34, v10
    v_lshl_add_u32 v36, v121, 10, v36
    v_lshlrev_b32 v10, 3, v10
    ds_add_rtn_u32 v36, v36, v3 offset:0
    v_lshl_or_b32 v10, v107, 20, v10
    v_mul_hi_u32_u24 v81, s32, v37
    v_lshrrev_b32 v121, 5, v11
    v_mad_i32_i24 v107, v81, s33, v37
    v_mul_hi_u32_u24 v121, s32, v121
    v_lshlrev_b32 v37, 2, v81
    v_mad_i32_i24 v11, v121, s34, v11
    v_lshl_add_u32 v37, v121, 10, v37
    v_lshlrev_b32 v11, 3, v11
    ds_add_rtn_u32 v37, v37, v3 offset:0
    v_lshl_or_b32 v11, v107, 20, v11
    v_mul_hi_u32_u24 v81, s32, v38
    v_lshrrev_b32 v121, 5, v12
    v_mad_i32_i24 v107, v81, s33, v38
    v_mul_hi_u32_u24 v121, s32, v121
    v_lshlrev_b32 v38, 2, v81
    v_mad_i32_i24 v12, v121, s34, v12
    v_lshl_add_u32 v38, v121, 10, v38
    v_lshlrev_b32 v12, 3, v12
    ds_add_rtn_u32 v38, v38, v3 offset:0
    v_lshl_or_b32 v12, v107, 20, v12
    v_mul_hi_u32_u24 v81, s32, v39
    v_lshrrev_b32 v121, 5, v13
    v_mad_i32_i24 v107, v81, s33, v39
    v_mul_hi_u32_u24 v121, s32, v121
    v_lshlrev_b32 v39, 2, v81
    v_mad_i32_i24 v13, v121, s34, v13
    v_lshl_add_u32 v39, v121, 10, v39
    v_lshlrev_b32 v13, 3, v13
    ds_add_rtn_u32 v39, v39, v3 offset:0
    v_lshl_or_b32 v13, v107, 20, v13
    v_mul_hi_u32_u24 v81, s32, v40
    v_lshrrev_b32 v121, 5, v14
    v_mad_i32_i24 v107, v81, s33, v40
    v_mul_hi_u32_u24 v121, s32, v121
    v_lshlrev_b32 v40, 2, v81
    v_mad_i32_i24 v14, v121, s34, v14
    v_lshl_add_u32 v40, v121, 10, v40
    v_lshlrev_b32 v14, 3, v14
    ds_add_rtn_u32 v40, v40, v3 offset:0
    v_lshl_or_b32 v14, v107, 20, v14
    v_mul_hi_u32_u24 v81, s32, v41
    v_lshrrev_b32 v121, 5, v15
    v_mad_i32_i24 v107, v81, s33, v41
    v_mul_hi_u32_u24 v121, s32, v121
    v_lshlrev_b32 v41, 2, v81
    v_mad_i32_i24 v15, v121, s34, v15
    v_lshl_add_u32 v41, v121, 10, v41
    v_lshlrev_b32 v15, 3, v15
    ds_add_rtn_u32 v41, v41, v3 offset:0
    v_lshl_or_b32 v15, v107, 20, v15
    v_mul_hi_u32_u24 v81, s32, v42
    v_lshrrev_b32 v121, 5, v16
    v_mad_i32_i24 v107, v81, s33, v42
    v_mul_hi_u32_u24 v121, s32, v121
    v_lshlrev_b32 v42, 2, v81
    v_mad_i32_i24 v16, v121, s34, v16
    v_lshl_add_u32 v42, v121, 10, v42
    v_lshlrev_b32 v16, 3, v16
    ds_add_rtn_u32 v42, v42, v3 offset:0
    v_lshl_or_b32 v16, v107, 20, v16
    v_mul_hi_u32_u24 v81, s32, v43
    v_lshrrev_b32 v121, 5, v17
    v_mad_i32_i24 v107, v81, s33, v43
    v_mul_hi_u32_u24 v121, s32, v121
    v_lshlrev_b32 v43, 2, v81
    v_mad_i32_i24 v17, v121, s34, v17
    v_lshl_add_u32 v43, v121, 10, v43
    v_lshlrev_b32 v17, 3, v17
    ds_add_rtn_u32 v43, v43, v3 offset:0
    v_lshl_or_b32 v17, v107, 20, v17
    v_mul_hi_u32_u24 v81, s32, v44
    v_lshrrev_b32 v121, 5, v18
    v_mad_i32_i24 v107, v81, s33, v44
    v_mul_hi_u32_u24 v121, s32, v121
    v_lshlrev_b32 v44, 2, v81
    v_mad_i32_i24 v18, v121, s34, v18
    v_lshl_add_u32 v44, v121, 10, v44
    v_lshlrev_b32 v18, 3, v18
    ds_add_rtn_u32 v44, v44, v3 offset:0
    v_lshl_or_b32 v18, v107, 20, v18
    v_mul_hi_u32_u24 v81, s32, v45
    v_lshrrev_b32 v121, 5, v19
    v_mad_i32_i24 v107, v81, s33, v45
    v_mul_hi_u32_u24 v121, s32, v121
    v_lshlrev_b32 v45, 2, v81
    v_mad_i32_i24 v19, v121, s34, v19
    v_lshl_add_u32 v45, v121, 10, v45
    v_lshlrev_b32 v19, 3, v19
    ds_add_rtn_u32 v45, v45, v3 offset:0
    v_lshl_or_b32 v19, v107, 20, v19
    v_mul_hi_u32_u24 v81, s32, v46
    v_lshrrev_b32 v121, 5, v20
    v_mad_i32_i24 v107, v81, s33, v46
    v_mul_hi_u32_u24 v121, s32, v121
    v_lshlrev_b32 v46, 2, v81
    v_mad_i32_i24 v20, v121, s34, v20
    v_lshl_add_u32 v46, v121, 10, v46
    v_lshlrev_b32 v20, 3, v20
    ds_add_rtn_u32 v46, v46, v3 offset:0
    v_lshl_or_b32 v20, v107, 20, v20
    v_mul_hi_u32_u24 v81, s32, v47
    v_lshrrev_b32 v121, 5, v21
    v_mad_i32_i24 v107, v81, s33, v47
    v_mul_hi_u32_u24 v121, s32, v121
    v_lshlrev_b32 v47, 2, v81
    v_mad_i32_i24 v21, v121, s34, v21
    v_lshl_add_u32 v47, v121, 10, v47
    v_lshlrev_b32 v21, 3, v21
    ds_add_rtn_u32 v47, v47, v3 offset:0
    v_lshl_or_b32 v21, v107, 20, v21
    v_mul_hi_u32_u24 v81, s32, v48
    v_lshrrev_b32 v121, 5, v22
    v_mad_i32_i24 v107, v81, s33, v48
    v_mul_hi_u32_u24 v121, s32, v121
    v_lshlrev_b32 v48, 2, v81
    v_mad_i32_i24 v22, v121, s34, v22
    v_lshl_add_u32 v48, v121, 10, v48
    v_lshlrev_b32 v22, 3, v22
    ds_add_rtn_u32 v48, v48, v3 offset:0
    v_lshl_or_b32 v22, v107, 20, v22
    v_mul_hi_u32_u24 v81, s32, v49
    v_lshrrev_b32 v121, 5, v23
    v_mad_i32_i24 v107, v81, s33, v49
    v_mul_hi_u32_u24 v121, s32, v121
    v_lshlrev_b32 v49, 2, v81
    v_mad_i32_i24 v23, v121, s34, v23
    v_lshl_add_u32 v49, v121, 10, v49
    v_lshlrev_b32 v23, 3, v23
    ds_add_rtn_u32 v49, v49, v3 offset:0
    v_lshl_or_b32 v23, v107, 20, v23
    v_mul_hi_u32_u24 v81, s32, v50
    v_lshrrev_b32 v121, 5, v24
    v_mad_i32_i24 v107, v81, s33, v50
    v_mul_hi_u32_u24 v121, s32, v121
    v_lshlrev_b32 v50, 2, v81
    v_mad_i32_i24 v24, v121, s34, v24
    v_lshl_add_u32 v50, v121, 10, v50
    v_lshlrev_b32 v24, 3, v24
    ds_add_rtn_u32 v50, v50, v3 offset:0
    v_lshl_or_b32 v24, v107, 20, v24
    v_mul_hi_u32_u24 v81, s32, v51
    v_lshrrev_b32 v121, 5, v25
    v_mad_i32_i24 v107, v81, s33, v51
    v_mul_hi_u32_u24 v121, s32, v121
    v_lshlrev_b32 v51, 2, v81
    v_mad_i32_i24 v25, v121, s34, v25
    v_lshl_add_u32 v51, v121, 10, v51
    v_lshlrev_b32 v25, 3, v25
    ds_add_rtn_u32 v51, v51, v3 offset:0
    v_lshl_or_b32 v25, v107, 20, v25
    v_mul_hi_u32_u24 v81, s32, v52
    v_lshrrev_b32 v121, 5, v26
    v_mad_i32_i24 v107, v81, s33, v52
    v_mul_hi_u32_u24 v121, s32, v121
    v_lshlrev_b32 v52, 2, v81
    v_mad_i32_i24 v26, v121, s34, v26
    v_lshl_add_u32 v52, v121, 10, v52
    v_lshlrev_b32 v26, 3, v26
    ds_add_rtn_u32 v52, v52, v3 offset:0
    v_lshl_or_b32 v26, v107, 20, v26
    v_mul_hi_u32_u24 v81, s32, v53
    v_lshrrev_b32 v121, 5, v27
    v_mad_i32_i24 v107, v81, s33, v53
    v_mul_hi_u32_u24 v121, s32, v121
    v_lshlrev_b32 v53, 2, v81
    v_mad_i32_i24 v27, v121, s34, v27
    v_lshl_add_u32 v53, v121, 10, v53
    v_lshlrev_b32 v27, 3, v27
    ds_add_rtn_u32 v53, v53, v3 offset:0
    v_lshl_or_b32 v27, v107, 20, v27
    v_mul_hi_u32_u24 v81, s32, v54
    v_lshrrev_b32 v121, 5, v28
    v_mad_i32_i24 v107, v81, s33, v54
    v_mul_hi_u32_u24 v121, s32, v121
    v_lshlrev_b32 v54, 2, v81
    v_mad_i32_i24 v28, v121, s34, v28
    v_lshl_add_u32 v54, v121, 10, v54
    v_lshlrev_b32 v28, 3, v28
    ds_add_rtn_u32 v54, v54, v3 offset:0
    v_lshl_or_b32 v28, v107, 20, v28
    s_waitcnt lgkmcnt(0)
    s_barrier
    v_lshlrev_b32 v125, 3, v0
    ds_read_b64 v[122:123], v125 offset:0
    s_waitcnt lgkmcnt(0)
    v_and_b32 v122, 0x7fff, v122
    v_and_b32 v123, 0x7fff, v123
    v_add_u32 v124, v122, v123
    v_mov_b32 v126, v124
    s_nop 1
    v_add_u32_dpp v126, v126, v126 row_shr:1 row_mask:0xf bank_mask:0xf
    s_nop 1
    v_add_u32_dpp v126, v126, v126 row_shr:2 row_mask:0xf bank_mask:0xf
    s_nop 1
    v_add_u32_dpp v126, v126, v126 row_shr:4 row_mask:0xf bank_mask:0xf
    s_nop 1
    v_add_u32_dpp v126, v126, v126 row_shr:8 row_mask:0xf bank_mask:0xf
    s_nop 1
    v_add_u32_dpp v126, v126, v126 row_bcast:15 row_mask:0xa bank_mask:0xf
    s_nop 1
    v_add_u32_dpp v126, v126, v126 row_bcast:31 row_mask:0xc bank_mask:0xf
    s_mov_b64 exec, s[46:47]
    s_lshl_b32 s40, s43, 2
    v_mov_b32 v127, s40
    ds_write_b32 v127, v126 offset:8208
    s_mov_b64 exec, -1
    s_waitcnt lgkmcnt(0)
    s_barrier
    v_and_b32 v127, 15, v0
    v_lshlrev_b32 v121, 2, v127
    ds_read_b32 v121, v121 offset:8208
    v_cmp_gt_u32 s[52:53], s43, v127
    v_sub_u32 v126, v126, v124
    s_waitcnt lgkmcnt(0)
    v_cndmask_b32 v121, 0, v121, s[52:53]
    s_nop 1
    v_add_u32_dpp v121, v121, v121 row_shr:1 row_mask:0xf bank_mask:0xf
    s_nop 1
    v_add_u32_dpp v121, v121, v121 row_shr:2 row_mask:0xf bank_mask:0xf
    s_nop 1
    v_add_u32_dpp v121, v121, v121 row_shr:4 row_mask:0xf bank_mask:0xf
    s_nop 1
    v_add_u32_dpp v121, v121, v121 row_shr:8 row_mask:0xf bank_mask:0xf
    s_nop 1
    v_readlane_b32 s50, v121, 15
    v_lshlrev_b32 v121, 16, v0
    v_sub_u32 v126, v126, v121
    v_add_u32 v126, s50, v126
    v_add_u32 v123, v126, v122
    v_mov_b32 v122, v126
    v_subrev_u32 v123, 0x8000, v123
    ds_write_b64 v125, v[122:123] offset:0
    s_waitcnt lgkmcnt(0)
    s_barrier
    s_waitcnt vmcnt(0)
    s_add_u32 s40, s39, 0
    buffer_load_dwordx4 v[82:85], v1, s[16:19], s40 offen nt
    buffer_load_dwordx4 v[56:59], v1, s[12:15], s40 offen nt
    s_add_u32 s41, s39, 16384
    buffer_load_dwordx4 v[86:89], v1, s[16:19], s41 offen nt
    buffer_load_dwordx4 v[60:63], v1, s[12:15], s41 offen nt
    v_lshrrev_b32 v29, 13, v30
    v_and_b32 v29, 0x1ffc, v29
    ds_read_b32 v29, v29 offset:0
    v_lshrrev_b32 v55, 13, v31
    v_and_b32 v55, 0x1ffc, v55
    ds_read_b32 v55, v55 offset:0
    v_lshrrev_b32 v81, 13, v32
    v_and_b32 v81, 0x1ffc, v81
    ds_read_b32 v81, v81 offset:0
    v_lshrrev_b32 v107, 13, v33
    v_and_b32 v107, 0x1ffc, v107
    ds_read_b32 v107, v107 offset:0
    v_lshrrev_b32 v121, 13, v34
    v_and_b32 v121, 0x1ffc, v121
    ds_read_b32 v121, v121 offset:0
    s_waitcnt lgkmcnt(0)
    v_add_u32 v30, v30, v29
    v_mul_u32_u24 v30, 6, v30
    v_and_b32 v29, 2, v30
    v_add_u32 v30, v30, v29
    ds_write_b32 v30, v4 offset:8320
    v_mad_i32_i24 v29, v29, -3, v30
    ds_write_b16 v29, v108 offset:8324
    v_add_u32 v31, v31, v55
    v_mul_u32_u24 v31, 6, v31
    v_and_b32 v55, 2, v31
    v_add_u32 v31, v31, v55
    ds_write_b32 v31, v5 offset:8320
    v_mad_i32_i24 v55, v55, -3, v31
    ds_write_b16_d16_hi v55, v108 offset:8324
    v_add_u32 v32, v32, v81
    v_mul_u32_u24 v32, 6, v32
    v_and_b32 v81, 2, v32
    v_add_u32 v32, v32, v81
    ds_write_b32 v32, v6 offset:8320
    v_mad_i32_i24 v81, v81, -3, v32
    ds_write_b16 v81, v109 offset:8324
    v_add_u32 v33, v33, v107
    v_mul_u32_u24 v33, 6, v33
    v_and_b32 v107, 2, v33
    v_add_u32 v33, v33, v107
    ds_write_b32 v33, v7 offset:8320
    v_mad_i32_i24 v107, v107, -3, v33
    ds_write_b16_d16_hi v107, v109 offset:8324
    v_add_u32 v34, v34, v121
    v_mul_u32_u24 v34, 6, v34
    v_and_b32 v121, 2, v34
    v_add_u32 v34, v34, v121
    ds_write_b32 v34, v8 offset:8320
    v_mad_i32_i24 v121, v121, -3, v34
    ds_write_b16 v121, v110 offset:8324
    s_add_u32 s40, s39, 32768
    buffer_load_dwordx4 v[90:93], v1, s[16:19], s40 offen nt
    buffer_load_dwordx4 v[64:67], v1, s[12:15], s40 offen nt
    v_lshrrev_b32 v29, 13, v35
    v_and_b32 v29, 0x1ffc, v29
    ds_read_b32 v29, v29 offset:0
    v_lshrrev_b32 v55, 13, v36
    v_and_b32 v55, 0x1ffc, v55
    ds_read_b32 v55, v55 offset:0
    v_lshrrev_b32 v81, 13, v37
    v_and_b32 v81, 0x1ffc, v81
    ds_read_b32 v81, v81 offset:0
    v_lshrrev_b32 v107, 13, v38
    v_and_b32 v107, 0x1ffc, v107
    ds_read_b32 v107, v107 offset:0
    v_lshrrev_b32 v121, 13, v39
    v_and_b32 v121, 0x1ffc, v121
    ds_read_b32 v121, v121 offset:0
    s_waitcnt lgkmcnt(0)
    v_add_u32 v35, v35, v29
    v_mul_u32_u24 v35, 6, v35
    v_and_b32 v29, 2, v35
    v_add_u32 v35, v35, v29
    ds_write_b32 v35, v9 offset:8320
    v_mad_i32_i24 v29, v29, -3, v35
    ds_write_b16_d16_hi v29, v110 offset:8324
    v_add_u32 v36, v36, v55
    v_mul_u32_u24 v36, 6, v36
    v_and_b32 v55, 2, v36
    v_add_u32 v36, v36, v55
    ds_write_b32 v36, v10 offset:8320
    v_mad_i32_i24 v55, v55, -3, v36
    ds_write_b16 v55, v111 offset:8324
    v_add_u32 v37, v37, v81
    v_mul_u32_u24 v37, 6, v37
    v_and_b32 v81, 2, v37
    v_add_u32 v37, v37, v81
    ds_write_b32 v37, v11 offset:8320
    v_mad_i32_i24 v81, v81, -3, v37
    ds_write_b16_d16_hi v81, v111 offset:8324
    v_add_u32 v38, v38, v107
    v_mul_u32_u24 v38, 6, v38
    v_and_b32 v107, 2, v38
    v_add_u32 v38, v38, v107
    ds_write_b32 v38, v12 offset:8320
    v_mad_i32_i24 v107, v107, -3, v38
    ds_write_b16 v107, v112 offset:8324
    v_add_u32 v39, v39, v121
    v_mul_u32_u24 v39, 6, v39
    v_and_b32 v121, 2, v39
    v_add_u32 v39, v39, v121
    ds_write_b32 v39, v13 offset:8320
    v_mad_i32_i24 v121, v121, -3, v39
    ds_write_b16_d16_hi v121, v112 offset:8324
    s_add_u32 s41, s39, 49152
    buffer_load_dwordx4 v[94:97], v1, s[16:19], s41 offen nt
    buffer_load_dwordx4 v[68:71], v1, s[12:15], s41 offen nt
    s_add_u32 s40, s39, 65536
    buffer_load_dwordx4 v[98:101], v1, s[16:19], s40 offen nt
    buffer_load_dwordx4 v[72:75], v1, s[12:15], s40 offen nt
    v_lshrrev_b32 v29, 13, v40
    v_and_b32 v29, 0x1ffc, v29
    ds_read_b32 v29, v29 offset:0
    v_lshrrev_b32 v55, 13, v41
    v_and_b32 v55, 0x1ffc, v55
    ds_read_b32 v55, v55 offset:0
    v_lshrrev_b32 v81, 13, v42
    v_and_b32 v81, 0x1ffc, v81
    ds_read_b32 v81, v81 offset:0
    v_lshrrev_b32 v107, 13, v43
    v_and_b32 v107, 0x1ffc, v107
    ds_read_b32 v107, v107 offset:0
    v_lshrrev_b32 v121, 13, v44
    v_and_b32 v121, 0x1ffc, v121
    ds_read_b32 v121, v121 offset:0
    s_waitcnt lgkmcnt(0)
    v_add_u32 v40, v40, v29
    v_mul_u32_u24 v40, 6, v40
    v_and_b32 v29, 2, v40
    v_add_u32 v40, v40, v29
    ds_write_b32 v40, v14 offset:8320
    v_mad_i32_i24 v29, v29, -3, v40
    ds_write_b16 v29, v113 offset:8324
    v_add_u32 v41, v41, v55
    v_mul_u32_u24 v41, 6, v41
    v_and_b32 v55, 2, v41
    v_add_u32 v41, v41, v55
    ds_write_b32 v41, v15 offset:8320
    v_mad_i32_i24 v55, v55, -3, v41
    ds_write_b16_d16_hi v55, v113 offset:8324
    v_add_u32 v42, v42, v81
    v_mul_u32_u24 v42, 6, v42
    v_and_b32 v81, 2, v42
    v_add_u32 v42, v42, v81
    ds_write_b32 v42, v16 offset:8320
    v_mad_i32_i24 v81, v81, -3, v42
    ds_write_b16 v81, v114 offset:8324
    v_add_u32 v43, v43, v107
    v_mul_u32_u24 v43, 6, v43
    v_and_b32 v107, 2, v43
    v_add_u32 v43, v43, v107
    ds_write_b32 v43, v17 offset:8320
    v_mad_i32_i24 v107, v107, -3, v43
    ds_write_b16_d16_hi v107, v114 offset:8324
    v_add_u32 v44, v44, v121
    v_mul_u32_u24 v44, 6, v44
    v_and_b32 v121, 2, v44
    v_add_u32 v44, v44, v121
    ds_write_b32 v44, v18 offset:8320
    v_mad_i32_i24 v121, v121, -3, v44
    ds_write_b16 v121, v115 offset:8324
    s_add_u32 s41, s39, 81920
    buffer_load_dwordx4 v[102:105], v1, s[16:19], s41 offen nt
    buffer_load_dwordx4 v[76:79], v1, s[12:15], s41 offen nt
    v_lshrrev_b32 v29, 13, v45
    v_and_b32 v29, 0x1ffc, v29
    ds_read_b32 v29, v29 offset:0
    v_lshrrev_b32 v55, 13, v46
    v_and_b32 v55, 0x1ffc, v55
    ds_read_b32 v55, v55 offset:0
    v_lshrrev_b32 v81, 13, v47
    v_and_b32 v81, 0x1ffc, v81
    ds_read_b32 v81, v81 offset:0
    v_lshrrev_b32 v107, 13, v48
    v_and_b32 v107, 0x1ffc, v107
    ds_read_b32 v107, v107 offset:0
    v_lshrrev_b32 v121, 13, v49
    v_and_b32 v121, 0x1ffc, v121
    ds_read_b32 v121, v121 offset:0
    s_waitcnt lgkmcnt(0)
    v_add_u32 v45, v45, v29
    v_mul_u32_u24 v45, 6, v45
    v_and_b32 v29, 2, v45
    v_add_u32 v45, v45, v29
    ds_write_b32 v45, v19 offset:8320
    v_mad_i32_i24 v29, v29, -3, v45
    ds_write_b16_d16_hi v29, v115 offset:8324
    v_add_u32 v46, v46, v55
    v_mul_u32_u24 v46, 6, v46
    v_and_b32 v55, 2, v46
    v_add_u32 v46, v46, v55
    ds_write_b32 v46, v20 offset:8320
    v_mad_i32_i24 v55, v55, -3, v46
    ds_write_b16 v55, v116 offset:8324
    v_add_u32 v47, v47, v81
    v_mul_u32_u24 v47, 6, v47
    v_and_b32 v81, 2, v47
    v_add_u32 v47, v47, v81
    ds_write_b32 v47, v21 offset:8320
    v_mad_i32_i24 v81, v81, -3, v47
    ds_write_b16_d16_hi v81, v116 offset:8324
    v_add_u32 v48, v48, v107
    v_mul_u32_u24 v48, 6, v48
    v_and_b32 v107, 2, v48
    v_add_u32 v48, v48, v107
    ds_write_b32 v48, v22 offset:8320
    v_mad_i32_i24 v107, v107, -3, v48
    ds_write_b16 v107, v117 offset:8324
    v_add_u32 v49, v49, v121
    v_mul_u32_u24 v49, 6, v49
    v_and_b32 v121, 2, v49
    v_add_u32 v49, v49, v121
    ds_write_b32 v49, v23 offset:8320
    v_mad_i32_i24 v121, v121, -3, v49
    ds_write_b16_d16_hi v121, v117 offset:8324
    s_add_u32 s40, s39, 98304
    buffer_load_dword v106, v2, s[16:19], s40 offen nt
    buffer_load_dword v80, v2, s[12:15], s40 offen nt
    v_lshrrev_b32 v29, 13, v50
    v_and_b32 v29, 0x1ffc, v29
    ds_read_b32 v29, v29 offset:0
    v_lshrrev_b32 v55, 13, v51
    v_and_b32 v55, 0x1ffc, v55
    ds_read_b32 v55, v55 offset:0
    v_lshrrev_b32 v81, 13, v52
    v_and_b32 v81, 0x1ffc, v81
    ds_read_b32 v81, v81 offset:0
    v_lshrrev_b32 v107, 13, v53
    v_and_b32 v107, 0x1ffc, v107
    ds_read_b32 v107, v107 offset:0
    v_lshrrev_b32 v121, 13, v54
    v_and_b32 v121, 0x1ffc, v121
    ds_read_b32 v121, v121 offset:0
    s_waitcnt lgkmcnt(0)
    v_add_u32 v50, v50, v29
    v_mul_u32_u24 v50, 6, v50
    v_and_b32 v29, 2, v50
    v_add_u32 v50, v50, v29
    ds_write_b32 v50, v24 offset:8320
    v_mad_i32_i24 v29, v29, -3, v50
    ds_write_b16 v29, v118 offset:8324
    v_add_u32 v51, v51, v55
    v_mul_u32_u24 v51, 6, v51
    v_and_b32 v55, 2, v51
    v_add_u32 v51, v51, v55
    ds_write_b32 v51, v25 offset:8320
    v_mad_i32_i24 v55, v55, -3, v51
    ds_write_b16_d16_hi v55, v118 offset:8324
    v_add_u32 v52, v52, v81
    v_mul_u32_u24 v52, 6, v52
    v_and_b32 v81, 2, v52
    v_add_u32 v52, v52, v81
    ds_write_b32 v52, v26 offset:8320
    v_mad_i32_i24 v81, v81, -3, v52
    ds_write_b16 v81, v119 offset:8324
    v_add_u32 v53, v53, v107
    v_mul_u32_u24 v53, 6, v53
    v_and_b32 v107, 2, v53
    v_add_u32 v53, v53, v107
    ds_write_b32 v53, v27 offset:8320
    v_mad_i32_i24 v107, v107, -3, v53
    ds_write_b16_d16_hi v107, v119 offset:8324
    v_add_u32 v54, v54, v121
    v_mul_u32_u24 v54, 6, v54
    v_and_b32 v121, 2, v54
    v_add_u32 v54, v54, v121
    ds_write_b32 v54, v28 offset:8320
    v_mad_i32_i24 v121, v121, -3, v54
    ds_write_b16 v121, v120 offset:8324
    v_cmp_gt_u32 vcc, 257, v0
    s_and_saveexec_b64 s[48:49], vcc
    s_cbranch_execz gemnet_part_kernel_nodesc_0
    ds_read_b32 v4, v2 offset:0
    ds_read_b32 v5, v2 offset:1024
    ds_read_b32 v6, v2 offset:2048
    ds_read_b32 v7, v2 offset:3072
    ds_read_b32 v8, v2 offset:4096
    ds_read_b32 v9, v2 offset:5120
    ds_read_b32 v10, v2 offset:6144
    ds_read_b32 v11, v2 offset:7168
    v_lshlrev_b32 v29, 15, v0
    s_waitcnt lgkmcnt(0)
    v_add_u32 v4, v4, v29
    v_add_u32 v5, v5, v29
    v_add_u32 v5, 8388608, v5
    v_add_u32 v6, v6, v29
    v_add_u32 v6, 16777216, v6
    v_add_u32 v7, v7, v29
    v_add_u32 v7, 25165824, v7
    v_add_u32 v8, v8, v29
    v_add_u32 v8, 33554432, v8
    v_add_u32 v9, v9, v29
    v_add_u32 v9, 41943040, v9
    v_add_u32 v10, v10, v29
    v_add_u32 v10, 50331648, v10
    v_add_u32 v11, v11, v29
    v_add_u32 v11, 58720256, v11
    v_lshl_or_b32 v12, v5, 16, v4
    v_lshl_or_b32 v13, v7, 16, v6
    v_lshl_or_b32 v14, v9, 16, v8
    v_lshl_or_b32 v15, v11, 16, v10
    buffer_store_dwordx4 v[12:15], v1, s[28:31], s38 offen
gemnet_part_kernel_nodesc_0:
    s_mov_b64 exec, s[48:49]
    s_waitcnt lgkmcnt(0)
    s_barrier
    ds_read_b128 v[30:33], v1 offset:8320
    ds_read_b128 v[34:37], v1 offset:24704
    ds_read_b128 v[38:41], v1 offset:41088
    ds_read_b128 v[42:45], v1 offset:57472
    v_add_u32 v29, 73856, v1
    ds_read_b128 v[46:49], v29 offset:0
    ds_read_b128 v[50:53], v29 offset:16384
    ds_read_b128 v[16:19], v29 offset:32768
    ds_read_b128 v[20:23], v29 offset:49152
    v_add_u32 v55, 139392, v1
    ds_read_b128 v[24:27], v55
    s_cmp_lt_u32 s43, 6
    s_cbranch_scc0 gemnet_part_kernel_notail_rd_0
    v_add_u32 v55, 155776, v1
    ds_read_b128 v[108:111], v55
gemnet_part_kernel_notail_rd_0:
    v_lshlrev_b32 v122, 16, v0
    v_add_u32 v123, 0x8000, v122
    v_lshlrev_b32 v124, 3, v0
    ds_write_b64 v124, v[122:123] offset:0
    s_add_u32 s40, s37, 0
    s_waitcnt lgkmcnt(0)
    buffer_store_dwordx4 v[30:33], v1, s[24:27], s40 offen sc0 sc1
    s_add_u32 s41, s37, 16384
    buffer_store_dwordx4 v[34:37], v1, s[24:27], s41 offen sc0 sc1
    s_add_u32 s40, s37, 32768
    buffer_store_dwordx4 v[38:41], v1, s[24:27], s40 offen sc0 sc1
    s_add_u32 s41, s37, 49152
    buffer_store_dwordx4 v[42:45], v1, s[24:27], s41 offen sc0 sc1
    s_add_u32 s40, s37, 65536
    buffer_store_dwordx4 v[46:49], v1, s[24:27], s40 offen sc0 sc1
    s_add_u32 s41, s37, 81920
    buffer_store_dwordx4 v[50:53], v1, s[24:27], s41 offen sc0 sc1
    s_add_u32 s40, s37, 98304
    buffer_store_dwordx4 v[16:19], v1, s[24:27], s40 offen sc0 sc1
    s_add_u32 s41, s37, 114688
    buffer_store_dwordx4 v[20:23], v1, s[24:27], s41 offen sc0 sc1
    s_add_u32 s40, s37, 131072
    buffer_store_dwordx4 v[24:27], v1, s[24:27], s40 offen sc0 sc1
    s_cmp_lt_u32 s43, 6
    s_cbranch_scc0 gemnet_part_kernel_notail_st_0
    s_add_u32 s42, s37, 147456
    buffer_store_dwordx4 v[108:111], v1, s[24:27], s42 offen sc0 sc1
gemnet_part_kernel_notail_st_0:
    s_barrier
    s_add_u32 s35, s35, 25600000
    s_add_u32 s36, s36, 12800000
    s_add_u32 s37, s37, 38400000
    s_add_u32 s38, s38, 1028000
    s_waitcnt vmcnt(9)
    v_lshlrev_b32 v29, 3, v0
    v_lshlrev_b32 v55, 1, v0
    s_add_u32 s40, s36, 0
    buffer_load_dwordx2 v[108:109], v29, s[20:23], s40 offen nt
    s_add_u32 s41, s36, 8192
    buffer_load_dwordx2 v[110:111], v29, s[20:23], s41 offen nt
    s_add_u32 s40, s36, 16384
    buffer_load_dwordx2 v[112:113], v29, s[20:23], s40 offen nt
    s_add_u32 s41, s36, 24576
    buffer_load_dwordx2 v[114:115], v29, s[20:23], s41 offen nt
    s_add_u32 s40, s36, 32768
    buffer_load_dwordx2 v[116:117], v29, s[20:23], s40 offen nt
    s_add_u32 s41, s36, 40960
    buffer_load_dwordx2 v[118:119], v29, s[20:23], s41 offen nt
    s_add_u32 s42, s36, 49152
    buffer_load_ushort v120, v55, s[20:23], s42 offen nt
    s_add_u32 s39, s35, 25600000
    v_mul_hi_u32_u24 v81, s32, v82
    v_lshrrev_b32 v121, 5, v56
    v_mad_i32_i24 v107, v81, s33, v82
    v_mul_hi_u32_u24 v121, s32, v121
    v_lshlrev_b32 v82, 2, v81
    v_mad_i32_i24 v56, v121, s34, v56
    v_lshl_add_u32 v82, v121, 10, v82
    v_lshlrev_b32 v56, 3, v56
    ds_add_rtn_u32 v82, v82, v3 offset:0
    v_lshl_or_b32 v56, v107, 20, v56
    v_mul_hi_u32_u24 v81, s32, v83
    v_lshrrev_b32 v121, 5, v57
    v_mad_i32_i24 v107, v81, s33, v83
    v_mul_hi_u32_u24 v121, s32, v121
    v_lshlrev_b32 v83, 2, v81
    v_mad_i32_i24 v57, v121, s34, v57
    v_lshl_add_u32 v83, v121, 10, v83
    v_lshlrev_b32 v57, 3, v57
    ds_add_rtn_u32 v83, v83, v3 offset:0
    v_lshl_or_b32 v57, v107, 20, v57
    v_mul_hi_u32_u24 v81, s32, v84
    v_lshrrev_b32 v121, 5, v58
    v_mad_i32_i24 v107, v81, s33, v84
    v_mul_hi_u32_u24 v121, s32, v121
    v_lshlrev_b32 v84, 2, v81
    v_mad_i32_i24 v58, v121, s34, v58
    v_lshl_add_u32 v84, v121, 10, v84
    v_lshlrev_b32 v58, 3, v58
    ds_add_rtn_u32 v84, v84, v3 offset:0
    v_lshl_or_b32 v58, v107, 20, v58
    v_mul_hi_u32_u24 v81, s32, v85
    v_lshrrev_b32 v121, 5, v59
    v_mad_i32_i24 v107, v81, s33, v85
    v_mul_hi_u32_u24 v121, s32, v121
    v_lshlrev_b32 v85, 2, v81
    v_mad_i32_i24 v59, v121, s34, v59
    v_lshl_add_u32 v85, v121, 10, v85
    v_lshlrev_b32 v59, 3, v59
    ds_add_rtn_u32 v85, v85, v3 offset:0
    v_lshl_or_b32 v59, v107, 20, v59
    v_mul_hi_u32_u24 v81, s32, v86
    v_lshrrev_b32 v121, 5, v60
    v_mad_i32_i24 v107, v81, s33, v86
    v_mul_hi_u32_u24 v121, s32, v121
    v_lshlrev_b32 v86, 2, v81
    v_mad_i32_i24 v60, v121, s34, v60
    v_lshl_add_u32 v86, v121, 10, v86
    v_lshlrev_b32 v60, 3, v60
    ds_add_rtn_u32 v86, v86, v3 offset:0
    v_lshl_or_b32 v60, v107, 20, v60
    v_mul_hi_u32_u24 v81, s32, v87
    v_lshrrev_b32 v121, 5, v61
    v_mad_i32_i24 v107, v81, s33, v87
    v_mul_hi_u32_u24 v121, s32, v121
    v_lshlrev_b32 v87, 2, v81
    v_mad_i32_i24 v61, v121, s34, v61
    v_lshl_add_u32 v87, v121, 10, v87
    v_lshlrev_b32 v61, 3, v61
    ds_add_rtn_u32 v87, v87, v3 offset:0
    v_lshl_or_b32 v61, v107, 20, v61
    v_mul_hi_u32_u24 v81, s32, v88
    v_lshrrev_b32 v121, 5, v62
    v_mad_i32_i24 v107, v81, s33, v88
    v_mul_hi_u32_u24 v121, s32, v121
    v_lshlrev_b32 v88, 2, v81
    v_mad_i32_i24 v62, v121, s34, v62
    v_lshl_add_u32 v88, v121, 10, v88
    v_lshlrev_b32 v62, 3, v62
    ds_add_rtn_u32 v88, v88, v3 offset:0
    v_lshl_or_b32 v62, v107, 20, v62
    v_mul_hi_u32_u24 v81, s32, v89
    v_lshrrev_b32 v121, 5, v63
    v_mad_i32_i24 v107, v81, s33, v89
    v_mul_hi_u32_u24 v121, s32, v121
    v_lshlrev_b32 v89, 2, v81
    v_mad_i32_i24 v63, v121, s34, v63
    v_lshl_add_u32 v89, v121, 10, v89
    v_lshlrev_b32 v63, 3, v63
    ds_add_rtn_u32 v89, v89, v3 offset:0
    v_lshl_or_b32 v63, v107, 20, v63
    v_mul_hi_u32_u24 v81, s32, v90
    v_lshrrev_b32 v121, 5, v64
    v_mad_i32_i24 v107, v81, s33, v90
    v_mul_hi_u32_u24 v121, s32, v121
    v_lshlrev_b32 v90, 2, v81
    v_mad_i32_i24 v64, v121, s34, v64
    v_lshl_add_u32 v90, v121, 10, v90
    v_lshlrev_b32 v64, 3, v64
    ds_add_rtn_u32 v90, v90, v3 offset:0
    v_lshl_or_b32 v64, v107, 20, v64
    v_mul_hi_u32_u24 v81, s32, v91
    v_lshrrev_b32 v121, 5, v65
    v_mad_i32_i24 v107, v81, s33, v91
    v_mul_hi_u32_u24 v121, s32, v121
    v_lshlrev_b32 v91, 2, v81
    v_mad_i32_i24 v65, v121, s34, v65
    v_lshl_add_u32 v91, v121, 10, v91
    v_lshlrev_b32 v65, 3, v65
    ds_add_rtn_u32 v91, v91, v3 offset:0
    v_lshl_or_b32 v65, v107, 20, v65
    v_mul_hi_u32_u24 v81, s32, v92
    v_lshrrev_b32 v121, 5, v66
    v_mad_i32_i24 v107, v81, s33, v92
    v_mul_hi_u32_u24 v121, s32, v121
    v_lshlrev_b32 v92, 2, v81
    v_mad_i32_i24 v66, v121, s34, v66
    v_lshl_add_u32 v92, v121, 10, v92
    v_lshlrev_b32 v66, 3, v66
    ds_add_rtn_u32 v92, v92, v3 offset:0
    v_lshl_or_b32 v66, v107, 20, v66
    v_mul_hi_u32_u24 v81, s32, v93
    v_lshrrev_b32 v121, 5, v67
    v_mad_i32_i24 v107, v81, s33, v93
    v_mul_hi_u32_u24 v121, s32, v121
    v_lshlrev_b32 v93, 2, v81
    v_mad_i32_i24 v67, v121, s34, v67
    v_lshl_add_u32 v93, v121, 10, v93
    v_lshlrev_b32 v67, 3, v67
    ds_add_rtn_u32 v93, v93, v3 offset:0
    v_lshl_or_b32 v67, v107, 20, v67
    v_mul_hi_u32_u24 v81, s32, v94
    v_lshrrev_b32 v121, 5, v68
    v_mad_i32_i24 v107, v81, s33, v94
    v_mul_hi_u32_u24 v121, s32, v121
    v_lshlrev_b32 v94, 2, v81
    v_mad_i32_i24 v68, v121, s34, v68
    v_lshl_add_u32 v94, v121, 10, v94
    v_lshlrev_b32 v68, 3, v68
    ds_add_rtn_u32 v94, v94, v3 offset:0
    v_lshl_or_b32 v68, v107, 20, v68
    v_mul_hi_u32_u24 v81, s32, v95
    v_lshrrev_b32 v121, 5, v69
    v_mad_i32_i24 v107, v81, s33, v95
    v_mul_hi_u32_u24 v121, s32, v121
    v_lshlrev_b32 v95, 2, v81
    v_mad_i32_i24 v69, v121, s34, v69
    v_lshl_add_u32 v95, v121, 10, v95
    v_lshlrev_b32 v69, 3, v69
    ds_add_rtn_u32 v95, v95, v3 offset:0
    v_lshl_or_b32 v69, v107, 20, v69
    v_mul_hi_u32_u24 v81, s32, v96
    v_lshrrev_b32 v121, 5, v70
    v_mad_i32_i24 v107, v81, s33, v96
    v_mul_hi_u32_u24 v121, s32, v121
    v_lshlrev_b32 v96, 2, v81
    v_mad_i32_i24 v70, v121, s34, v70
    v_lshl_add_u32 v96, v121, 10, v96
    v_lshlrev_b32 v70, 3, v70
    ds_add_rtn_u32 v96, v96, v3 offset:0
    v_lshl_or_b32 v70, v107, 20, v70
    v_mul_hi_u32_u24 v81, s32, v97
    v_lshrrev_b32 v121, 5, v71
    v_mad_i32_i24 v107, v81, s33, v97
    v_mul_hi_u32_u24 v121, s32, v121
    v_lshlrev_b32 v97, 2, v81
    v_mad_i32_i24 v71, v121, s34, v71
    v_lshl_add_u32 v97, v121, 10, v97
    v_lshlrev_b32 v71, 3, v71
    ds_add_rtn_u32 v97, v97, v3 offset:0
    v_lshl_or_b32 v71, v107, 20, v71
    v_mul_hi_u32_u24 v81, s32, v98
    v_lshrrev_b32 v121, 5, v72
    v_mad_i32_i24 v107, v81, s33, v98
    v_mul_hi_u32_u24 v121, s32, v121
    v_lshlrev_b32 v98, 2, v81
    v_mad_i32_i24 v72, v121, s34, v72
    v_lshl_add_u32 v98, v121, 10, v98
    v_lshlrev_b32 v72, 3, v72
    ds_add_rtn_u32 v98, v98, v3 offset:0
    v_lshl_or_b32 v72, v107, 20, v72
    v_mul_hi_u32_u24 v81, s32, v99
    v_lshrrev_b32 v121, 5, v73
    v_mad_i32_i24 v107, v81, s33, v99
    v_mul_hi_u32_u24 v121, s32, v121
    v_lshlrev_b32 v99, 2, v81
    v_mad_i32_i24 v73, v121, s34, v73
    v_lshl_add_u32 v99, v121, 10, v99
    v_lshlrev_b32 v73, 3, v73
    ds_add_rtn_u32 v99, v99, v3 offset:0
    v_lshl_or_b32 v73, v107, 20, v73
    v_mul_hi_u32_u24 v81, s32, v100
    v_lshrrev_b32 v121, 5, v74
    v_mad_i32_i24 v107, v81, s33, v100
    v_mul_hi_u32_u24 v121, s32, v121
    v_lshlrev_b32 v100, 2, v81
    v_mad_i32_i24 v74, v121, s34, v74
    v_lshl_add_u32 v100, v121, 10, v100
    v_lshlrev_b32 v74, 3, v74
    ds_add_rtn_u32 v100, v100, v3 offset:0
    v_lshl_or_b32 v74, v107, 20, v74
    v_mul_hi_u32_u24 v81, s32, v101
    v_lshrrev_b32 v121, 5, v75
    v_mad_i32_i24 v107, v81, s33, v101
    v_mul_hi_u32_u24 v121, s32, v121
    v_lshlrev_b32 v101, 2, v81
    v_mad_i32_i24 v75, v121, s34, v75
    v_lshl_add_u32 v101, v121, 10, v101
    v_lshlrev_b32 v75, 3, v75
    ds_add_rtn_u32 v101, v101, v3 offset:0
    v_lshl_or_b32 v75, v107, 20, v75
    v_mul_hi_u32_u24 v81, s32, v102
    v_lshrrev_b32 v121, 5, v76
    v_mad_i32_i24 v107, v81, s33, v102
    v_mul_hi_u32_u24 v121, s32, v121
    v_lshlrev_b32 v102, 2, v81
    v_mad_i32_i24 v76, v121, s34, v76
    v_lshl_add_u32 v102, v121, 10, v102
    v_lshlrev_b32 v76, 3, v76
    ds_add_rtn_u32 v102, v102, v3 offset:0
    v_lshl_or_b32 v76, v107, 20, v76
    v_mul_hi_u32_u24 v81, s32, v103
    v_lshrrev_b32 v121, 5, v77
    v_mad_i32_i24 v107, v81, s33, v103
    v_mul_hi_u32_u24 v121, s32, v121
    v_lshlrev_b32 v103, 2, v81
    v_mad_i32_i24 v77, v121, s34, v77
    v_lshl_add_u32 v103, v121, 10, v103
    v_lshlrev_b32 v77, 3, v77
    ds_add_rtn_u32 v103, v103, v3 offset:0
    v_lshl_or_b32 v77, v107, 20, v77
    v_mul_hi_u32_u24 v81, s32, v104
    v_lshrrev_b32 v121, 5, v78
    v_mad_i32_i24 v107, v81, s33, v104
    v_mul_hi_u32_u24 v121, s32, v121
    v_lshlrev_b32 v104, 2, v81
    v_mad_i32_i24 v78, v121, s34, v78
    v_lshl_add_u32 v104, v121, 10, v104
    v_lshlrev_b32 v78, 3, v78
    ds_add_rtn_u32 v104, v104, v3 offset:0
    v_lshl_or_b32 v78, v107, 20, v78
    v_mul_hi_u32_u24 v81, s32, v105
    v_lshrrev_b32 v121, 5, v79
    v_mad_i32_i24 v107, v81, s33, v105
    v_mul_hi_u32_u24 v121, s32, v121
    v_lshlrev_b32 v105, 2, v81
    v_mad_i32_i24 v79, v121, s34, v79
    v_lshl_add_u32 v105, v121, 10, v105
    v_lshlrev_b32 v79, 3, v79
    ds_add_rtn_u32 v105, v105, v3 offset:0
    v_lshl_or_b32 v79, v107, 20, v79
    v_mul_hi_u32_u24 v81, s32, v106
    v_lshrrev_b32 v121, 5, v80
    v_mad_i32_i24 v107, v81, s33, v106
    v_mul_hi_u32_u24 v121, s32, v121
    v_lshlrev_b32 v106, 2, v81
    v_mad_i32_i24 v80, v121, s34, v80
    v_lshl_add_u32 v106, v121, 10, v106
    v_lshlrev_b32 v80, 3, v80
    ds_add_rtn_u32 v106, v106, v3 offset:0
    v_lshl_or_b32 v80, v107, 20, v80
    s_waitcnt lgkmcnt(0)
    s_barrier
    v_lshlrev_b32 v125, 3, v0
    ds_read_b64 v[122:123], v125 offset:0
    s_waitcnt lgkmcnt(0)
    v_and_b32 v122, 0x7fff, v122
    v_and_b32 v123, 0x7fff, v123
    v_add_u32 v124, v122, v123
    v_mov_b32 v126, v124
    s_nop 1
    v_add_u32_dpp v126, v126, v126 row_shr:1 row_mask:0xf bank_mask:0xf
    s_nop 1
    v_add_u32_dpp v126, v126, v126 row_shr:2 row_mask:0xf bank_mask:0xf
    s_nop 1
    v_add_u32_dpp v126, v126, v126 row_shr:4 row_mask:0xf bank_mask:0xf
    s_nop 1
    v_add_u32_dpp v126, v126, v126 row_shr:8 row_mask:0xf bank_mask:0xf
    s_nop 1
    v_add_u32_dpp v126, v126, v126 row_bcast:15 row_mask:0xa bank_mask:0xf
    s_nop 1
    v_add_u32_dpp v126, v126, v126 row_bcast:31 row_mask:0xc bank_mask:0xf
    s_mov_b64 exec, s[46:47]
    s_lshl_b32 s40, s43, 2
    v_mov_b32 v127, s40
    ds_write_b32 v127, v126 offset:8208
    s_mov_b64 exec, -1
    s_waitcnt lgkmcnt(0)
    s_barrier
    v_and_b32 v127, 15, v0
    v_lshlrev_b32 v121, 2, v127
    ds_read_b32 v121, v121 offset:8208
    v_cmp_gt_u32 s[52:53], s43, v127
    v_sub_u32 v126, v126, v124
    s_waitcnt lgkmcnt(0)
    v_cndmask_b32 v121, 0, v121, s[52:53]
    s_nop 1
    v_add_u32_dpp v121, v121, v121 row_shr:1 row_mask:0xf bank_mask:0xf
    s_nop 1
    v_add_u32_dpp v121, v121, v121 row_shr:2 row_mask:0xf bank_mask:0xf
    s_nop 1
    v_add_u32_dpp v121, v121, v121 row_shr:4 row_mask:0xf bank_mask:0xf
    s_nop 1
    v_add_u32_dpp v121, v121, v121 row_shr:8 row_mask:0xf bank_mask:0xf
    s_nop 1
    v_readlane_b32 s50, v121, 15
    v_lshlrev_b32 v121, 16, v0
    v_sub_u32 v126, v126, v121
    v_add_u32 v126, s50, v126
    v_add_u32 v123, v126, v122
    v_mov_b32 v122, v126
    v_subrev_u32 v123, 0x8000, v123
    ds_write_b64 v125, v[122:123] offset:0
    s_waitcnt lgkmcnt(0)
    s_barrier
    s_waitcnt vmcnt(0)
    s_add_u32 s40, s39, 0
    buffer_load_dwordx4 v[30:33], v1, s[16:19], s40 offen nt
    buffer_load_dwordx4 v[4:7], v1, s[12:15], s40 offen nt
    s_add_u32 s41, s39, 16384
    buffer_load_dwordx4 v[34:37], v1, s[16:19], s41 offen nt
    buffer_load_dwordx4 v[8:11], v1, s[12:15], s41 offen nt
    v_lshrrev_b32 v29, 13, v82
    v_and_b32 v29, 0x1ffc, v29
    ds_read_b32 v29, v29 offset:0
    v_lshrrev_b32 v55, 13, v83
    v_and_b32 v55, 0x1ffc, v55
    ds_read_b32 v55, v55 offset:0
    v_lshrrev_b32 v81, 13, v84
    v_and_b32 v81, 0x1ffc, v81
    ds_read_b32 v81, v81 offset:0
    v_lshrrev_b32 v107, 13, v85
    v_and_b32 v107, 0x1ffc, v107
    ds_read_b32 v107, v107 offset:0
    v_lshrrev_b32 v121, 13, v86
    v_and_b32 v121, 0x1ffc, v121
    ds_read_b32 v121, v121 offset:0
    s_waitcnt lgkmcnt(0)
    v_add_u32 v82, v82, v29
    v_mul_u32_u24 v82, 6, v82
    v_and_b32 v29, 2, v82
    v_add_u32 v82, v82, v29
    ds_write_b32 v82, v56 offset:8320
    v_mad_i32_i24 v29, v29, -3, v82
    ds_write_b16 v29, v108 offset:8324
    v_add_u32 v83, v83, v55
    v_mul_u32_u24 v83, 6, v83
    v_and_b32 v55, 2, v83
    v_add_u32 v83, v83, v55
    ds_write_b32 v83, v57 offset:8320
    v_mad_i32_i24 v55, v55, -3, v83
    ds_write_b16_d16_hi v55, v108 offset:8324
    v_add_u32 v84, v84, v81
    v_mul_u32_u24 v84, 6, v84
    v_and_b32 v81, 2, v84
    v_add_u32 v84, v84, v81
    ds_write_b32 v84, v58 offset:8320
    v_mad_i32_i24 v81, v81, -3, v84
    ds_write_b16 v81, v109 offset:8324
    v_add_u32 v85, v85, v107
    v_mul_u32_u24 v85, 6, v85
    v_and_b32 v107, 2, v85
    v_add_u32 v85, v85, v107
    ds_write_b32 v85, v59 offset:8320
    v_mad_i32_i24 v107, v107, -3, v85
    ds_write_b16_d16_hi v107, v109 offset:8324
    v_add_u32 v86, v86, v121
    v_mul_u32_u24 v86, 6, v86
    v_and_b32 v121, 2, v86
    v_add_u32 v86, v86, v121
    ds_write_b32 v86, v60 offset:8320
    v_mad_i32_i24 v121, v121, -3, v86
    ds_write_b16 v121, v110 offset:8324
    s_add_u32 s40, s39, 32768
    buffer_load_dwordx4 v[38:41], v1, s[16:19], s40 offen nt
    buffer_load_dwordx4 v[12:15], v1, s[12:15], s40 offen nt
    v_lshrrev_b32 v29, 13, v87
    v_and_b32 v29, 0x1ffc, v29
    ds_read_b32 v29, v29 offset:0
    v_lshrrev_b32 v55, 13, v88
    v_and_b32 v55, 0x1ffc, v55
    ds_read_b32 v55, v55 offset:0
    v_lshrrev_b32 v81, 13, v89
    v_and_b32 v81, 0x1ffc, v81
    ds_read_b32 v81, v81 offset:0
    v_lshrrev_b32 v107, 13, v90
    v_and_b32 v107, 0x1ffc, v107
    ds_read_b32 v107, v107 offset:0
    v_lshrrev_b32 v121, 13, v91
    v_and_b32 v121, 0x1ffc, v121
    ds_read_b32 v121, v121 offset:0
    s_waitcnt lgkmcnt(0)
    v_add_u32 v87, v87, v29
    v_mul_u32_u24 v87, 6, v87
    v_and_b32 v29, 2, v87
    v_add_u32 v87, v87, v29
    ds_write_b32 v87, v61 offset:8320
    v_mad_i32_i24 v29, v29, -3, v87
    ds_write_b16_d16_hi v29, v110 offset:8324
    v_add_u32 v88, v88, v55
    v_mul_u32_u24 v88, 6, v88
    v_and_b32 v55, 2, v88
    v_add_u32 v88, v88, v55
    ds_write_b32 v88, v62 offset:8320
    v_mad_i32_i24 v55, v55, -3, v88
    ds_write_b16 v55, v111 offset:8324
    v_add_u32 v89, v89, v81
    v_mul_u32_u24 v89, 6, v89
    v_and_b32 v81, 2, v89
    v_add_u32 v89, v89, v81
    ds_write_b32 v89, v63 offset:8320
    v_mad_i32_i24 v81, v81, -3, v89
    ds_write_b16_d16_hi v81, v111 offset:8324
    v_add_u32 v90, v90, v107
    v_mul_u32_u24 v90, 6, v90
    v_and_b32 v107, 2, v90
    v_add_u32 v90, v90, v107
    ds_write_b32 v90, v64 offset:8320
    v_mad_i32_i24 v107, v107, -3, v90
    ds_write_b16 v107, v112 offset:8324
    v_add_u32 v91, v91, v121
    v_mul_u32_u24 v91, 6, v91
    v_and_b32 v121, 2, v91
    v_add_u32 v91, v91, v121
    ds_write_b32 v91, v65 offset:8320
    v_mad_i32_i24 v121, v121, -3, v91
    ds_write_b16_d16_hi v121, v112 offset:8324
    s_add_u32 s41, s39, 49152
    buffer_load_dwordx4 v[42:45], v1, s[16:19], s41 offen nt
    buffer_load_dwordx4 v[16:19], v1, s[12:15], s41 offen nt
    s_add_u32 s40, s39, 65536
    buffer_load_dwordx4 v[46:49], v1, s[16:19], s40 offen nt
    buffer_load_dwordx4 v[20:23], v1, s[12:15], s40 offen nt
    v_lshrrev_b32 v29, 13, v92
    v_and_b32 v29, 0x1ffc, v29
    ds_read_b32 v29, v29 offset:0
    v_lshrrev_b32 v55, 13, v93
    v_and_b32 v55, 0x1ffc, v55
    ds_read_b32 v55, v55 offset:0
    v_lshrrev_b32 v81, 13, v94
    v_and_b32 v81, 0x1ffc, v81
    ds_read_b32 v81, v81 offset:0
    v_lshrrev_b32 v107, 13, v95
    v_and_b32 v107, 0x1ffc, v107
    ds_read_b32 v107, v107 offset:0
    v_lshrrev_b32 v121, 13, v96
    v_and_b32 v121, 0x1ffc, v121
    ds_read_b32 v121, v121 offset:0
    s_waitcnt lgkmcnt(0)
    v_add_u32 v92, v92, v29
    v_mul_u32_u24 v92, 6, v92
    v_and_b32 v29, 2, v92
    v_add_u32 v92, v92, v29
    ds_write_b32 v92, v66 offset:8320
    v_mad_i32_i24 v29, v29, -3, v92
    ds_write_b16 v29, v113 offset:8324
    v_add_u32 v93, v93, v55
    v_mul_u32_u24 v93, 6, v93
    v_and_b32 v55, 2, v93
    v_add_u32 v93, v93, v55
    ds_write_b32 v93, v67 offset:8320
    v_mad_i32_i24 v55, v55, -3, v93
    ds_write_b16_d16_hi v55, v113 offset:8324
    v_add_u32 v94, v94, v81
    v_mul_u32_u24 v94, 6, v94
    v_and_b32 v81, 2, v94
    v_add_u32 v94, v94, v81
    ds_write_b32 v94, v68 offset:8320
    v_mad_i32_i24 v81, v81, -3, v94
    ds_write_b16 v81, v114 offset:8324
    v_add_u32 v95, v95, v107
    v_mul_u32_u24 v95, 6, v95
    v_and_b32 v107, 2, v95
    v_add_u32 v95, v95, v107
    ds_write_b32 v95, v69 offset:8320
    v_mad_i32_i24 v107, v107, -3, v95
    ds_write_b16_d16_hi v107, v114 offset:8324
    v_add_u32 v96, v96, v121
    v_mul_u32_u24 v96, 6, v96
    v_and_b32 v121, 2, v96
    v_add_u32 v96, v96, v121
    ds_write_b32 v96, v70 offset:8320
    v_mad_i32_i24 v121, v121, -3, v96
    ds_write_b16 v121, v115 offset:8324
    s_add_u32 s41, s39, 81920
    buffer_load_dwordx4 v[50:53], v1, s[16:19], s41 offen nt
    buffer_load_dwordx4 v[24:27], v1, s[12:15], s41 offen nt
    v_lshrrev_b32 v29, 13, v97
    v_and_b32 v29, 0x1ffc, v29
    ds_read_b32 v29, v29 offset:0
    v_lshrrev_b32 v55, 13, v98
    v_and_b32 v55, 0x1ffc, v55
    ds_read_b32 v55, v55 offset:0
    v_lshrrev_b32 v81, 13, v99
    v_and_b32 v81, 0x1ffc, v81
    ds_read_b32 v81, v81 offset:0
    v_lshrrev_b32 v107, 13, v100
    v_and_b32 v107, 0x1ffc, v107
    ds_read_b32 v107, v107 offset:0
    v_lshrrev_b32 v121, 13, v101
    v_and_b32 v121, 0x1ffc, v121
    ds_read_b32 v121, v121 offset:0
    s_waitcnt lgkmcnt(0)
    v_add_u32 v97, v97, v29
    v_mul_u32_u24 v97, 6, v97
    v_and_b32 v29, 2, v97
    v_add_u32 v97, v97, v29
    ds_write_b32 v97, v71 offset:8320
    v_mad_i32_i24 v29, v29, -3, v97
    ds_write_b16_d16_hi v29, v115 offset:8324
    v_add_u32 v98, v98, v55
    v_mul_u32_u24 v98, 6, v98
    v_and_b32 v55, 2, v98
    v_add_u32 v98, v98, v55
    ds_write_b32 v98, v72 offset:8320
    v_mad_i32_i24 v55, v55, -3, v98
    ds_write_b16 v55, v116 offset:8324
    v_add_u32 v99, v99, v81
    v_mul_u32_u24 v99, 6, v99
    v_and_b32 v81, 2, v99
    v_add_u32 v99, v99, v81
    ds_write_b32 v99, v73 offset:8320
    v_mad_i32_i24 v81, v81, -3, v99
    ds_write_b16_d16_hi v81, v116 offset:8324
    v_add_u32 v100, v100, v107
    v_mul_u32_u24 v100, 6, v100
    v_and_b32 v107, 2, v100
    v_add_u32 v100, v100, v107
    ds_write_b32 v100, v74 offset:8320
    v_mad_i32_i24 v107, v107, -3, v100
    ds_write_b16 v107, v117 offset:8324
    v_add_u32 v101, v101, v121
    v_mul_u32_u24 v101, 6, v101
    v_and_b32 v121, 2, v101
    v_add_u32 v101, v101, v121
    ds_write_b32 v101, v75 offset:8320
    v_mad_i32_i24 v121, v121, -3, v101
    ds_write_b16_d16_hi v121, v117 offset:8324
    s_add_u32 s40, s39, 98304
    buffer_load_dword v54, v2, s[16:19], s40 offen nt
    buffer_load_dword v28, v2, s[12:15], s40 offen nt
    v_lshrrev_b32 v29, 13, v102
    v_and_b32 v29, 0x1ffc, v29
    ds_read_b32 v29, v29 offset:0
    v_lshrrev_b32 v55, 13, v103
    v_and_b32 v55, 0x1ffc, v55
    ds_read_b32 v55, v55 offset:0
    v_lshrrev_b32 v81, 13, v104
    v_and_b32 v81, 0x1ffc, v81
    ds_read_b32 v81, v81 offset:0
    v_lshrrev_b32 v107, 13, v105
    v_and_b32 v107, 0x1ffc, v107
    ds_read_b32 v107, v107 offset:0
    v_lshrrev_b32 v121, 13, v106
    v_and_b32 v121, 0x1ffc, v121
    ds_read_b32 v121, v121 offset:0
    s_waitcnt lgkmcnt(0)
    v_add_u32 v102, v102, v29
    v_mul_u32_u24 v102, 6, v102
    v_and_b32 v29, 2, v102
    v_add_u32 v102, v102, v29
    ds_write_b32 v102, v76 offset:8320
    v_mad_i32_i24 v29, v29, -3, v102
    ds_write_b16 v29, v118 offset:8324
    v_add_u32 v103, v103, v55
    v_mul_u32_u24 v103, 6, v103
    v_and_b32 v55, 2, v103
    v_add_u32 v103, v103, v55
    ds_write_b32 v103, v77 offset:8320
    v_mad_i32_i24 v55, v55, -3, v103
    ds_write_b16_d16_hi v55, v118 offset:8324
    v_add_u32 v104, v104, v81
    v_mul_u32_u24 v104, 6, v104
    v_and_b32 v81, 2, v104
    v_add_u32 v104, v104, v81
    ds_write_b32 v104, v78 offset:8320
    v_mad_i32_i24 v81, v81, -3, v104
    ds_write_b16 v81, v119 offset:8324
    v_add_u32 v105, v105, v107
    v_mul_u32_u24 v105, 6, v105
    v_and_b32 v107, 2, v105
    v_add_u32 v105, v105, v107
    ds_write_b32 v105, v79 offset:8320
    v_mad_i32_i24 v107, v107, -3, v105
    ds_write_b16_d16_hi v107, v119 offset:8324
    v_add_u32 v106, v106, v121
    v_mul_u32_u24 v106, 6, v106
    v_and_b32 v121, 2, v106
    v_add_u32 v106, v106, v121
    ds_write_b32 v106, v80 offset:8320
    v_mad_i32_i24 v121, v121, -3, v106
    ds_write_b16 v121, v120 offset:8324
    v_cmp_gt_u32 vcc, 257, v0
    s_and_saveexec_b64 s[48:49], vcc
    s_cbranch_execz gemnet_part_kernel_nodesc_1
    ds_read_b32 v56, v2 offset:0
    ds_read_b32 v57, v2 offset:1024
    ds_read_b32 v58, v2 offset:2048
    ds_read_b32 v59, v2 offset:3072
    ds_read_b32 v60, v2 offset:4096
    ds_read_b32 v61, v2 offset:5120
    ds_read_b32 v62, v2 offset:6144
    ds_read_b32 v63, v2 offset:7168
    v_lshlrev_b32 v29, 15, v0
    s_waitcnt lgkmcnt(0)
    v_add_u32 v56, v56, v29
    v_add_u32 v57, v57, v29
    v_add_u32 v57, 8388608, v57
    v_add_u32 v58, v58, v29
    v_add_u32 v58, 16777216, v58
    v_add_u32 v59, v59, v29
    v_add_u32 v59, 25165824, v59
    v_add_u32 v60, v60, v29
    v_add_u32 v60, 33554432, v60
    v_add_u32 v61, v61, v29
    v_add_u32 v61, 41943040, v61
    v_add_u32 v62, v62, v29
    v_add_u32 v62, 50331648, v62
    v_add_u32 v63, v63, v29
    v_add_u32 v63, 58720256, v63
    v_lshl_or_b32 v64, v57, 16, v56
    v_lshl_or_b32 v65, v59, 16, v58
    v_lshl_or_b32 v66, v61, 16, v60
    v_lshl_or_b32 v67, v63, 16, v62
    buffer_store_dwordx4 v[64:67], v1, s[28:31], s38 offen
gemnet_part_kernel_nodesc_1:
    s_mov_b64 exec, s[48:49]
    s_waitcnt lgkmcnt(0)
    s_barrier
    ds_read_b128 v[82:85], v1 offset:8320
    ds_read_b128 v[86:89], v1 offset:24704
    ds_read_b128 v[90:93], v1 offset:41088
    ds_read_b128 v[94:97], v1 offset:57472
    v_add_u32 v29, 73856, v1
    ds_read_b128 v[98:101], v29 offset:0
    ds_read_b128 v[102:105], v29 offset:16384
    ds_read_b128 v[68:71], v29 offset:32768
    ds_read_b128 v[72:75], v29 offset:49152
    v_add_u32 v55, 139392, v1
    ds_read_b128 v[76:79], v55
    s_cmp_lt_u32 s43, 6
    s_cbranch_scc0 gemnet_part_kernel_notail_rd_1
    v_add_u32 v55, 155776, v1
    ds_read_b128 v[108:111], v55
gemnet_part_kernel_notail_rd_1:
    v_lshlrev_b32 v122, 16, v0
    v_add_u32 v123, 0x8000, v122
    v_lshlrev_b32 v124, 3, v0
    ds_write_b64 v124, v[122:123] offset:0
    s_add_u32 s40, s37, 0
    s_waitcnt lgkmcnt(0)
    buffer_store_dwordx4 v[82:85], v1, s[24:27], s40 offen sc0 sc1
    s_add_u32 s41, s37, 16384
    buffer_store_dwordx4 v[86:89], v1, s[24:27], s41 offen sc0 sc1
    s_add_u32 s40, s37, 32768
    buffer_store_dwordx4 v[90:93], v1, s[24:27], s40 offen sc0 sc1
    s_add_u32 s41, s37, 49152
    buffer_store_dwordx4 v[94:97], v1, s[24:27], s41 offen sc0 sc1
    s_add_u32 s40, s37, 65536
    buffer_store_dwordx4 v[98:101], v1, s[24:27], s40 offen sc0 sc1
    s_add_u32 s41, s37, 81920
    buffer_store_dwordx4 v[102:105], v1, s[24:27], s41 offen sc0 sc1
    s_add_u32 s40, s37, 98304
    buffer_store_dwordx4 v[68:71], v1, s[24:27], s40 offen sc0 sc1
    s_add_u32 s41, s37, 114688
    buffer_store_dwordx4 v[72:75], v1, s[24:27], s41 offen sc0 sc1
    s_add_u32 s40, s37, 131072
    buffer_store_dwordx4 v[76:79], v1, s[24:27], s40 offen sc0 sc1
    s_cmp_lt_u32 s43, 6
    s_cbranch_scc0 gemnet_part_kernel_notail_st_1
    s_add_u32 s42, s37, 147456
    buffer_store_dwordx4 v[108:111], v1, s[24:27], s42 offen sc0 sc1
gemnet_part_kernel_notail_st_1:
    s_barrier
    s_add_u32 s35, s35, 25600000
    s_add_u32 s36, s36, 12800000
    s_add_u32 s37, s37, 38400000
    s_add_u32 s38, s38, 1028000
    s_waitcnt vmcnt(9)
    v_lshlrev_b32 v29, 3, v0
    v_lshlrev_b32 v55, 1, v0
    s_add_u32 s40, s36, 0
    buffer_load_dwordx2 v[108:109], v29, s[20:23], s40 offen nt
    s_add_u32 s41, s36, 8192
    buffer_load_dwordx2 v[110:111], v29, s[20:23], s41 offen nt
    s_add_u32 s40, s36, 16384
    buffer_load_dwordx2 v[112:113], v29, s[20:23], s40 offen nt
    s_add_u32 s41, s36, 24576
    buffer_load_dwordx2 v[114:115], v29, s[20:23], s41 offen nt
    s_add_u32 s40, s36, 32768
    buffer_load_dwordx2 v[116:117], v29, s[20:23], s40 offen nt
    s_add_u32 s41, s36, 40960
    buffer_load_dwordx2 v[118:119], v29, s[20:23], s41 offen nt
    s_add_u32 s42, s36, 49152
    buffer_load_ushort v120, v55, s[20:23], s42 offen nt
    s_add_u32 s39, s35, 25600000
    v_mul_hi_u32_u24 v81, s32, v30
    v_lshrrev_b32 v121, 5, v4
    v_mad_i32_i24 v107, v81, s33, v30
    v_mul_hi_u32_u24 v121, s32, v121
    v_lshlrev_b32 v30, 2, v81
    v_mad_i32_i24 v4, v121, s34, v4
    v_lshl_add_u32 v30, v121, 10, v30
    v_lshlrev_b32 v4, 3, v4
    ds_add_rtn_u32 v30, v30, v3 offset:0
    v_lshl_or_b32 v4, v107, 20, v4
    v_mul_hi_u32_u24 v81, s32, v31
    v_lshrrev_b32 v121, 5, v5
    v_mad_i32_i24 v107, v81, s33, v31
    v_mul_hi_u32_u24 v121, s32, v121
    v_lshlrev_b32 v31, 2, v81
    v_mad_i32_i24 v5, v121, s34, v5
    v_lshl_add_u32 v31, v121, 10, v31
    v_lshlrev_b32 v5, 3, v5
    ds_add_rtn_u32 v31, v31, v3 offset:0
    v_lshl_or_b32 v5, v107, 20, v5
    v_mul_hi_u32_u24 v81, s32, v32
    v_lshrrev_b32 v121, 5, v6
    v_mad_i32_i24 v107, v81, s33, v32
    v_mul_hi_u32_u24 v121, s32, v121
    v_lshlrev_b32 v32, 2, v81
    v_mad_i32_i24 v6, v121, s34, v6
    v_lshl_add_u32 v32, v121, 10, v32
    v_lshlrev_b32 v6, 3, v6
    ds_add_rtn_u32 v32, v32, v3 offset:0
    v_lshl_or_b32 v6, v107, 20, v6
    v_mul_hi_u32_u24 v81, s32, v33
    v_lshrrev_b32 v121, 5, v7
    v_mad_i32_i24 v107, v81, s33, v33
    v_mul_hi_u32_u24 v121, s32, v121
    v_lshlrev_b32 v33, 2, v81
    v_mad_i32_i24 v7, v121, s34, v7
    v_lshl_add_u32 v33, v121, 10, v33
    v_lshlrev_b32 v7, 3, v7
    ds_add_rtn_u32 v33, v33, v3 offset:0
    v_lshl_or_b32 v7, v107, 20, v7
    v_mul_hi_u32_u24 v81, s32, v34
    v_lshrrev_b32 v121, 5, v8
    v_mad_i32_i24 v107, v81, s33, v34
    v_mul_hi_u32_u24 v121, s32, v121
    v_lshlrev_b32 v34, 2, v81
    v_mad_i32_i24 v8, v121, s34, v8
    v_lshl_add_u32 v34, v121, 10, v34
    v_lshlrev_b32 v8, 3, v8
    ds_add_rtn_u32 v34, v34, v3 offset:0
    v_lshl_or_b32 v8, v107, 20, v8
    v_mul_hi_u32_u24 v81, s32, v35
    v_lshrrev_b32 v121, 5, v9
    v_mad_i32_i24 v107, v81, s33, v35
    v_mul_hi_u32_u24 v121, s32, v121
    v_lshlrev_b32 v35, 2, v81
    v_mad_i32_i24 v9, v121, s34, v9
    v_lshl_add_u32 v35, v121, 10, v35
    v_lshlrev_b32 v9, 3, v9
    ds_add_rtn_u32 v35, v35, v3 offset:0
    v_lshl_or_b32 v9, v107, 20, v9
    v_mul_hi_u32_u24 v81, s32, v36
    v_lshrrev_b32 v121, 5, v10
    v_mad_i32_i24 v107, v81, s33, v36
    v_mul_hi_u32_u24 v121, s32, v121
    v_lshlrev_b32 v36, 2, v81
    v_mad_i32_i24 v10, v121, s34, v10
    v_lshl_add_u32 v36, v121, 10, v36
    v_lshlrev_b32 v10, 3, v10
    ds_add_rtn_u32 v36, v36, v3 offset:0
    v_lshl_or_b32 v10, v107, 20, v10
    v_mul_hi_u32_u24 v81, s32, v37
    v_lshrrev_b32 v121, 5, v11
    v_mad_i32_i24 v107, v81, s33, v37
    v_mul_hi_u32_u24 v121, s32, v121
    v_lshlrev_b32 v37, 2, v81
    v_mad_i32_i24 v11, v121, s34, v11
    v_lshl_add_u32 v37, v121, 10, v37
    v_lshlrev_b32 v11, 3, v11
    ds_add_rtn_u32 v37, v37, v3 offset:0
    v_lshl_or_b32 v11, v107, 20, v11
    v_mul_hi_u32_u24 v81, s32, v38
    v_lshrrev_b32 v121, 5, v12
    v_mad_i32_i24 v107, v81, s33, v38
    v_mul_hi_u32_u24 v121, s32, v121
    v_lshlrev_b32 v38, 2, v81
    v_mad_i32_i24 v12, v121, s34, v12
    v_lshl_add_u32 v38, v121, 10, v38
    v_lshlrev_b32 v12, 3, v12
    ds_add_rtn_u32 v38, v38, v3 offset:0
    v_lshl_or_b32 v12, v107, 20, v12
    v_mul_hi_u32_u24 v81, s32, v39
    v_lshrrev_b32 v121, 5, v13
    v_mad_i32_i24 v107, v81, s33, v39
    v_mul_hi_u32_u24 v121, s32, v121
    v_lshlrev_b32 v39, 2, v81
    v_mad_i32_i24 v13, v121, s34, v13
    v_lshl_add_u32 v39, v121, 10, v39
    v_lshlrev_b32 v13, 3, v13
    ds_add_rtn_u32 v39, v39, v3 offset:0
    v_lshl_or_b32 v13, v107, 20, v13
    v_mul_hi_u32_u24 v81, s32, v40
    v_lshrrev_b32 v121, 5, v14
    v_mad_i32_i24 v107, v81, s33, v40
    v_mul_hi_u32_u24 v121, s32, v121
    v_lshlrev_b32 v40, 2, v81
    v_mad_i32_i24 v14, v121, s34, v14
    v_lshl_add_u32 v40, v121, 10, v40
    v_lshlrev_b32 v14, 3, v14
    ds_add_rtn_u32 v40, v40, v3 offset:0
    v_lshl_or_b32 v14, v107, 20, v14
    v_mul_hi_u32_u24 v81, s32, v41
    v_lshrrev_b32 v121, 5, v15
    v_mad_i32_i24 v107, v81, s33, v41
    v_mul_hi_u32_u24 v121, s32, v121
    v_lshlrev_b32 v41, 2, v81
    v_mad_i32_i24 v15, v121, s34, v15
    v_lshl_add_u32 v41, v121, 10, v41
    v_lshlrev_b32 v15, 3, v15
    ds_add_rtn_u32 v41, v41, v3 offset:0
    v_lshl_or_b32 v15, v107, 20, v15
    v_mul_hi_u32_u24 v81, s32, v42
    v_lshrrev_b32 v121, 5, v16
    v_mad_i32_i24 v107, v81, s33, v42
    v_mul_hi_u32_u24 v121, s32, v121
    v_lshlrev_b32 v42, 2, v81
    v_mad_i32_i24 v16, v121, s34, v16
    v_lshl_add_u32 v42, v121, 10, v42
    v_lshlrev_b32 v16, 3, v16
    ds_add_rtn_u32 v42, v42, v3 offset:0
    v_lshl_or_b32 v16, v107, 20, v16
    v_mul_hi_u32_u24 v81, s32, v43
    v_lshrrev_b32 v121, 5, v17
    v_mad_i32_i24 v107, v81, s33, v43
    v_mul_hi_u32_u24 v121, s32, v121
    v_lshlrev_b32 v43, 2, v81
    v_mad_i32_i24 v17, v121, s34, v17
    v_lshl_add_u32 v43, v121, 10, v43
    v_lshlrev_b32 v17, 3, v17
    ds_add_rtn_u32 v43, v43, v3 offset:0
    v_lshl_or_b32 v17, v107, 20, v17
    v_mul_hi_u32_u24 v81, s32, v44
    v_lshrrev_b32 v121, 5, v18
    v_mad_i32_i24 v107, v81, s33, v44
    v_mul_hi_u32_u24 v121, s32, v121
    v_lshlrev_b32 v44, 2, v81
    v_mad_i32_i24 v18, v121, s34, v18
    v_lshl_add_u32 v44, v121, 10, v44
    v_lshlrev_b32 v18, 3, v18
    ds_add_rtn_u32 v44, v44, v3 offset:0
    v_lshl_or_b32 v18, v107, 20, v18
    v_mul_hi_u32_u24 v81, s32, v45
    v_lshrrev_b32 v121, 5, v19
    v_mad_i32_i24 v107, v81, s33, v45
    v_mul_hi_u32_u24 v121, s32, v121
    v_lshlrev_b32 v45, 2, v81
    v_mad_i32_i24 v19, v121, s34, v19
    v_lshl_add_u32 v45, v121, 10, v45
    v_lshlrev_b32 v19, 3, v19
    ds_add_rtn_u32 v45, v45, v3 offset:0
    v_lshl_or_b32 v19, v107, 20, v19
    v_mul_hi_u32_u24 v81, s32, v46
    v_lshrrev_b32 v121, 5, v20
    v_mad_i32_i24 v107, v81, s33, v46
    v_mul_hi_u32_u24 v121, s32, v121
    v_lshlrev_b32 v46, 2, v81
    v_mad_i32_i24 v20, v121, s34, v20
    v_lshl_add_u32 v46, v121, 10, v46
    v_lshlrev_b32 v20, 3, v20
    ds_add_rtn_u32 v46, v46, v3 offset:0
    v_lshl_or_b32 v20, v107, 20, v20
    v_mul_hi_u32_u24 v81, s32, v47
    v_lshrrev_b32 v121, 5, v21
    v_mad_i32_i24 v107, v81, s33, v47
    v_mul_hi_u32_u24 v121, s32, v121
    v_lshlrev_b32 v47, 2, v81
    v_mad_i32_i24 v21, v121, s34, v21
    v_lshl_add_u32 v47, v121, 10, v47
    v_lshlrev_b32 v21, 3, v21
    ds_add_rtn_u32 v47, v47, v3 offset:0
    v_lshl_or_b32 v21, v107, 20, v21
    v_mul_hi_u32_u24 v81, s32, v48
    v_lshrrev_b32 v121, 5, v22
    v_mad_i32_i24 v107, v81, s33, v48
    v_mul_hi_u32_u24 v121, s32, v121
    v_lshlrev_b32 v48, 2, v81
    v_mad_i32_i24 v22, v121, s34, v22
    v_lshl_add_u32 v48, v121, 10, v48
    v_lshlrev_b32 v22, 3, v22
    ds_add_rtn_u32 v48, v48, v3 offset:0
    v_lshl_or_b32 v22, v107, 20, v22
    v_mul_hi_u32_u24 v81, s32, v49
    v_lshrrev_b32 v121, 5, v23
    v_mad_i32_i24 v107, v81, s33, v49
    v_mul_hi_u32_u24 v121, s32, v121
    v_lshlrev_b32 v49, 2, v81
    v_mad_i32_i24 v23, v121, s34, v23
    v_lshl_add_u32 v49, v121, 10, v49
    v_lshlrev_b32 v23, 3, v23
    ds_add_rtn_u32 v49, v49, v3 offset:0
    v_lshl_or_b32 v23, v107, 20, v23
    v_mul_hi_u32_u24 v81, s32, v50
    v_lshrrev_b32 v121, 5, v24
    v_mad_i32_i24 v107, v81, s33, v50
    v_mul_hi_u32_u24 v121, s32, v121
    v_lshlrev_b32 v50, 2, v81
    v_mad_i32_i24 v24, v121, s34, v24
    v_lshl_add_u32 v50, v121, 10, v50
    v_lshlrev_b32 v24, 3, v24
    ds_add_rtn_u32 v50, v50, v3 offset:0
    v_lshl_or_b32 v24, v107, 20, v24
    v_mul_hi_u32_u24 v81, s32, v51
    v_lshrrev_b32 v121, 5, v25
    v_mad_i32_i24 v107, v81, s33, v51
    v_mul_hi_u32_u24 v121, s32, v121
    v_lshlrev_b32 v51, 2, v81
    v_mad_i32_i24 v25, v121, s34, v25
    v_lshl_add_u32 v51, v121, 10, v51
    v_lshlrev_b32 v25, 3, v25
    ds_add_rtn_u32 v51, v51, v3 offset:0
    v_lshl_or_b32 v25, v107, 20, v25
    v_mul_hi_u32_u24 v81, s32, v52
    v_lshrrev_b32 v121, 5, v26
    v_mad_i32_i24 v107, v81, s33, v52
    v_mul_hi_u32_u24 v121, s32, v121
    v_lshlrev_b32 v52, 2, v81
    v_mad_i32_i24 v26, v121, s34, v26
    v_lshl_add_u32 v52, v121, 10, v52
    v_lshlrev_b32 v26, 3, v26
    ds_add_rtn_u32 v52, v52, v3 offset:0
    v_lshl_or_b32 v26, v107, 20, v26
    v_mul_hi_u32_u24 v81, s32, v53
    v_lshrrev_b32 v121, 5, v27
    v_mad_i32_i24 v107, v81, s33, v53
    v_mul_hi_u32_u24 v121, s32, v121
    v_lshlrev_b32 v53, 2, v81
    v_mad_i32_i24 v27, v121, s34, v27
    v_lshl_add_u32 v53, v121, 10, v53
    v_lshlrev_b32 v27, 3, v27
    ds_add_rtn_u32 v53, v53, v3 offset:0
    v_lshl_or_b32 v27, v107, 20, v27
    v_mul_hi_u32_u24 v81, s32, v54
    v_lshrrev_b32 v121, 5, v28
    v_mad_i32_i24 v107, v81, s33, v54
    v_mul_hi_u32_u24 v121, s32, v121
    v_lshlrev_b32 v54, 2, v81
    v_mad_i32_i24 v28, v121, s34, v28
    v_lshl_add_u32 v54, v121, 10, v54
    v_lshlrev_b32 v28, 3, v28
    ds_add_rtn_u32 v54, v54, v3 offset:0
    v_lshl_or_b32 v28, v107, 20, v28
    s_waitcnt lgkmcnt(0)
    s_barrier
    v_lshlrev_b32 v125, 3, v0
    ds_read_b64 v[122:123], v125 offset:0
    s_waitcnt lgkmcnt(0)
    v_and_b32 v122, 0x7fff, v122
    v_and_b32 v123, 0x7fff, v123
    v_add_u32 v124, v122, v123
    v_mov_b32 v126, v124
    s_nop 1
    v_add_u32_dpp v126, v126, v126 row_shr:1 row_mask:0xf bank_mask:0xf
    s_nop 1
    v_add_u32_dpp v126, v126, v126 row_shr:2 row_mask:0xf bank_mask:0xf
    s_nop 1
    v_add_u32_dpp v126, v126, v126 row_shr:4 row_mask:0xf bank_mask:0xf
    s_nop 1
    v_add_u32_dpp v126, v126, v126 row_shr:8 row_mask:0xf bank_mask:0xf
    s_nop 1
    v_add_u32_dpp v126, v126, v126 row_bcast:15 row_mask:0xa bank_mask:0xf
    s_nop 1
    v_add_u32_dpp v126, v126, v126 row_bcast:31 row_mask:0xc bank_mask:0xf
    s_mov_b64 exec, s[46:47]
    s_lshl_b32 s40, s43, 2
    v_mov_b32 v127, s40
    ds_write_b32 v127, v126 offset:8208
    s_mov_b64 exec, -1
    s_waitcnt lgkmcnt(0)
    s_barrier
    v_and_b32 v127, 15, v0
    v_lshlrev_b32 v121, 2, v127
    ds_read_b32 v121, v121 offset:8208
    v_cmp_gt_u32 s[52:53], s43, v127
    v_sub_u32 v126, v126, v124
    s_waitcnt lgkmcnt(0)
    v_cndmask_b32 v121, 0, v121, s[52:53]
    s_nop 1
    v_add_u32_dpp v121, v121, v121 row_shr:1 row_mask:0xf bank_mask:0xf
    s_nop 1
    v_add_u32_dpp v121, v121, v121 row_shr:2 row_mask:0xf bank_mask:0xf
    s_nop 1
    v_add_u32_dpp v121, v121, v121 row_shr:4 row_mask:0xf bank_mask:0xf
    s_nop 1
    v_add_u32_dpp v121, v121, v121 row_shr:8 row_mask:0xf bank_mask:0xf
    s_nop 1
    v_readlane_b32 s50, v121, 15
    v_lshlrev_b32 v121, 16, v0
    v_sub_u32 v126, v126, v121
    v_add_u32 v126, s50, v126
    v_add_u32 v123, v126, v122
    v_mov_b32 v122, v126
    v_subrev_u32 v123, 0x8000, v123
    ds_write_b64 v125, v[122:123] offset:0
    s_waitcnt lgkmcnt(0)
    s_barrier
    s_waitcnt vmcnt(0)
    s_add_u32 s40, s39, 0
    buffer_load_dwordx4 v[82:85], v1, s[16:19], s40 offen nt
    buffer_load_dwordx4 v[56:59], v1, s[12:15], s40 offen nt
    s_add_u32 s41, s39, 16384
    buffer_load_dwordx4 v[86:89], v1, s[16:19], s41 offen nt
    buffer_load_dwordx4 v[60:63], v1, s[12:15], s41 offen nt
    v_lshrrev_b32 v29, 13, v30
    v_and_b32 v29, 0x1ffc, v29
    ds_read_b32 v29, v29 offset:0
    v_lshrrev_b32 v55, 13, v31
    v_and_b32 v55, 0x1ffc, v55
    ds_read_b32 v55, v55 offset:0
    v_lshrrev_b32 v81, 13, v32
    v_and_b32 v81, 0x1ffc, v81
    ds_read_b32 v81, v81 offset:0
    v_lshrrev_b32 v107, 13, v33
    v_and_b32 v107, 0x1ffc, v107
    ds_read_b32 v107, v107 offset:0
    v_lshrrev_b32 v121, 13, v34
    v_and_b32 v121, 0x1ffc, v121
    ds_read_b32 v121, v121 offset:0
    s_waitcnt lgkmcnt(0)
    v_add_u32 v30, v30, v29
    v_mul_u32_u24 v30, 6, v30
    v_and_b32 v29, 2, v30
    v_add_u32 v30, v30, v29
    ds_write_b32 v30, v4 offset:8320
    v_mad_i32_i24 v29, v29, -3, v30
    ds_write_b16 v29, v108 offset:8324
    v_add_u32 v31, v31, v55
    v_mul_u32_u24 v31, 6, v31
    v_and_b32 v55, 2, v31
    v_add_u32 v31, v31, v55
    ds_write_b32 v31, v5 offset:8320
    v_mad_i32_i24 v55, v55, -3, v31
    ds_write_b16_d16_hi v55, v108 offset:8324
    v_add_u32 v32, v32, v81
    v_mul_u32_u24 v32, 6, v32
    v_and_b32 v81, 2, v32
    v_add_u32 v32, v32, v81
    ds_write_b32 v32, v6 offset:8320
    v_mad_i32_i24 v81, v81, -3, v32
    ds_write_b16 v81, v109 offset:8324
    v_add_u32 v33, v33, v107
    v_mul_u32_u24 v33, 6, v33
    v_and_b32 v107, 2, v33
    v_add_u32 v33, v33, v107
    ds_write_b32 v33, v7 offset:8320
    v_mad_i32_i24 v107, v107, -3, v33
    ds_write_b16_d16_hi v107, v109 offset:8324
    v_add_u32 v34, v34, v121
    v_mul_u32_u24 v34, 6, v34
    v_and_b32 v121, 2, v34
    v_add_u32 v34, v34, v121
    ds_write_b32 v34, v8 offset:8320
    v_mad_i32_i24 v121, v121, -3, v34
    ds_write_b16 v121, v110 offset:8324
    s_add_u32 s40, s39, 32768
    buffer_load_dwordx4 v[90:93], v1, s[16:19], s40 offen nt
    buffer_load_dwordx4 v[64:67], v1, s[12:15], s40 offen nt
    v_lshrrev_b32 v29, 13, v35
    v_and_b32 v29, 0x1ffc, v29
    ds_read_b32 v29, v29 offset:0
    v_lshrrev_b32 v55, 13, v36
    v_and_b32 v55, 0x1ffc, v55
    ds_read_b32 v55, v55 offset:0
    v_lshrrev_b32 v81, 13, v37
    v_and_b32 v81, 0x1ffc, v81
    ds_read_b32 v81, v81 offset:0
    v_lshrrev_b32 v107, 13, v38
    v_and_b32 v107, 0x1ffc, v107
    ds_read_b32 v107, v107 offset:0
    v_lshrrev_b32 v121, 13, v39
    v_and_b32 v121, 0x1ffc, v121
    ds_read_b32 v121, v121 offset:0
    s_waitcnt lgkmcnt(0)
    v_add_u32 v35, v35, v29
    v_mul_u32_u24 v35, 6, v35
    v_and_b32 v29, 2, v35
    v_add_u32 v35, v35, v29
    ds_write_b32 v35, v9 offset:8320
    v_mad_i32_i24 v29, v29, -3, v35
    ds_write_b16_d16_hi v29, v110 offset:8324
    v_add_u32 v36, v36, v55
    v_mul_u32_u24 v36, 6, v36
    v_and_b32 v55, 2, v36
    v_add_u32 v36, v36, v55
    ds_write_b32 v36, v10 offset:8320
    v_mad_i32_i24 v55, v55, -3, v36
    ds_write_b16 v55, v111 offset:8324
    v_add_u32 v37, v37, v81
    v_mul_u32_u24 v37, 6, v37
    v_and_b32 v81, 2, v37
    v_add_u32 v37, v37, v81
    ds_write_b32 v37, v11 offset:8320
    v_mad_i32_i24 v81, v81, -3, v37
    ds_write_b16_d16_hi v81, v111 offset:8324
    v_add_u32 v38, v38, v107
    v_mul_u32_u24 v38, 6, v38
    v_and_b32 v107, 2, v38
    v_add_u32 v38, v38, v107
    ds_write_b32 v38, v12 offset:8320
    v_mad_i32_i24 v107, v107, -3, v38
    ds_write_b16 v107, v112 offset:8324
    v_add_u32 v39, v39, v121
    v_mul_u32_u24 v39, 6, v39
    v_and_b32 v121, 2, v39
    v_add_u32 v39, v39, v121
    ds_write_b32 v39, v13 offset:8320
    v_mad_i32_i24 v121, v121, -3, v39
    ds_write_b16_d16_hi v121, v112 offset:8324
    s_add_u32 s41, s39, 49152
    buffer_load_dwordx4 v[94:97], v1, s[16:19], s41 offen nt
    buffer_load_dwordx4 v[68:71], v1, s[12:15], s41 offen nt
    s_add_u32 s40, s39, 65536
    buffer_load_dwordx4 v[98:101], v1, s[16:19], s40 offen nt
    buffer_load_dwordx4 v[72:75], v1, s[12:15], s40 offen nt
    v_lshrrev_b32 v29, 13, v40
    v_and_b32 v29, 0x1ffc, v29
    ds_read_b32 v29, v29 offset:0
    v_lshrrev_b32 v55, 13, v41
    v_and_b32 v55, 0x1ffc, v55
    ds_read_b32 v55, v55 offset:0
    v_lshrrev_b32 v81, 13, v42
    v_and_b32 v81, 0x1ffc, v81
    ds_read_b32 v81, v81 offset:0
    v_lshrrev_b32 v107, 13, v43
    v_and_b32 v107, 0x1ffc, v107
    ds_read_b32 v107, v107 offset:0
    v_lshrrev_b32 v121, 13, v44
    v_and_b32 v121, 0x1ffc, v121
    ds_read_b32 v121, v121 offset:0
    s_waitcnt lgkmcnt(0)
    v_add_u32 v40, v40, v29
    v_mul_u32_u24 v40, 6, v40
    v_and_b32 v29, 2, v40
    v_add_u32 v40, v40, v29
    ds_write_b32 v40, v14 offset:8320
    v_mad_i32_i24 v29, v29, -3, v40
    ds_write_b16 v29, v113 offset:8324
    v_add_u32 v41, v41, v55
    v_mul_u32_u24 v41, 6, v41
    v_and_b32 v55, 2, v41
    v_add_u32 v41, v41, v55
    ds_write_b32 v41, v15 offset:8320
    v_mad_i32_i24 v55, v55, -3, v41
    ds_write_b16_d16_hi v55, v113 offset:8324
    v_add_u32 v42, v42, v81
    v_mul_u32_u24 v42, 6, v42
    v_and_b32 v81, 2, v42
    v_add_u32 v42, v42, v81
    ds_write_b32 v42, v16 offset:8320
    v_mad_i32_i24 v81, v81, -3, v42
    ds_write_b16 v81, v114 offset:8324
    v_add_u32 v43, v43, v107
    v_mul_u32_u24 v43, 6, v43
    v_and_b32 v107, 2, v43
    v_add_u32 v43, v43, v107
    ds_write_b32 v43, v17 offset:8320
    v_mad_i32_i24 v107, v107, -3, v43
    ds_write_b16_d16_hi v107, v114 offset:8324
    v_add_u32 v44, v44, v121
    v_mul_u32_u24 v44, 6, v44
    v_and_b32 v121, 2, v44
    v_add_u32 v44, v44, v121
    ds_write_b32 v44, v18 offset:8320
    v_mad_i32_i24 v121, v121, -3, v44
    ds_write_b16 v121, v115 offset:8324
    s_add_u32 s41, s39, 81920
    buffer_load_dwordx4 v[102:105], v1, s[16:19], s41 offen nt
    buffer_load_dwordx4 v[76:79], v1, s[12:15], s41 offen nt
    v_lshrrev_b32 v29, 13, v45
    v_and_b32 v29, 0x1ffc, v29
    ds_read_b32 v29, v29 offset:0
    v_lshrrev_b32 v55, 13, v46
    v_and_b32 v55, 0x1ffc, v55
    ds_read_b32 v55, v55 offset:0
    v_lshrrev_b32 v81, 13, v47
    v_and_b32 v81, 0x1ffc, v81
    ds_read_b32 v81, v81 offset:0
    v_lshrrev_b32 v107, 13, v48
    v_and_b32 v107, 0x1ffc, v107
    ds_read_b32 v107, v107 offset:0
    v_lshrrev_b32 v121, 13, v49
    v_and_b32 v121, 0x1ffc, v121
    ds_read_b32 v121, v121 offset:0
    s_waitcnt lgkmcnt(0)
    v_add_u32 v45, v45, v29
    v_mul_u32_u24 v45, 6, v45
    v_and_b32 v29, 2, v45
    v_add_u32 v45, v45, v29
    ds_write_b32 v45, v19 offset:8320
    v_mad_i32_i24 v29, v29, -3, v45
    ds_write_b16_d16_hi v29, v115 offset:8324
    v_add_u32 v46, v46, v55
    v_mul_u32_u24 v46, 6, v46
    v_and_b32 v55, 2, v46
    v_add_u32 v46, v46, v55
    ds_write_b32 v46, v20 offset:8320
    v_mad_i32_i24 v55, v55, -3, v46
    ds_write_b16 v55, v116 offset:8324
    v_add_u32 v47, v47, v81
    v_mul_u32_u24 v47, 6, v47
    v_and_b32 v81, 2, v47
    v_add_u32 v47, v47, v81
    ds_write_b32 v47, v21 offset:8320
    v_mad_i32_i24 v81, v81, -3, v47
    ds_write_b16_d16_hi v81, v116 offset:8324
    v_add_u32 v48, v48, v107
    v_mul_u32_u24 v48, 6, v48
    v_and_b32 v107, 2, v48
    v_add_u32 v48, v48, v107
    ds_write_b32 v48, v22 offset:8320
    v_mad_i32_i24 v107, v107, -3, v48
    ds_write_b16 v107, v117 offset:8324
    v_add_u32 v49, v49, v121
    v_mul_u32_u24 v49, 6, v49
    v_and_b32 v121, 2, v49
    v_add_u32 v49, v49, v121
    ds_write_b32 v49, v23 offset:8320
    v_mad_i32_i24 v121, v121, -3, v49
    ds_write_b16_d16_hi v121, v117 offset:8324
    s_add_u32 s40, s39, 98304
    buffer_load_dword v106, v2, s[16:19], s40 offen nt
    buffer_load_dword v80, v2, s[12:15], s40 offen nt
    v_lshrrev_b32 v29, 13, v50
    v_and_b32 v29, 0x1ffc, v29
    ds_read_b32 v29, v29 offset:0
    v_lshrrev_b32 v55, 13, v51
    v_and_b32 v55, 0x1ffc, v55
    ds_read_b32 v55, v55 offset:0
    v_lshrrev_b32 v81, 13, v52
    v_and_b32 v81, 0x1ffc, v81
    ds_read_b32 v81, v81 offset:0
    v_lshrrev_b32 v107, 13, v53
    v_and_b32 v107, 0x1ffc, v107
    ds_read_b32 v107, v107 offset:0
    v_lshrrev_b32 v121, 13, v54
    v_and_b32 v121, 0x1ffc, v121
    ds_read_b32 v121, v121 offset:0
    s_waitcnt lgkmcnt(0)
    v_add_u32 v50, v50, v29
    v_mul_u32_u24 v50, 6, v50
    v_and_b32 v29, 2, v50
    v_add_u32 v50, v50, v29
    ds_write_b32 v50, v24 offset:8320
    v_mad_i32_i24 v29, v29, -3, v50
    ds_write_b16 v29, v118 offset:8324
    v_add_u32 v51, v51, v55
    v_mul_u32_u24 v51, 6, v51
    v_and_b32 v55, 2, v51
    v_add_u32 v51, v51, v55
    ds_write_b32 v51, v25 offset:8320
    v_mad_i32_i24 v55, v55, -3, v51
    ds_write_b16_d16_hi v55, v118 offset:8324
    v_add_u32 v52, v52, v81
    v_mul_u32_u24 v52, 6, v52
    v_and_b32 v81, 2, v52
    v_add_u32 v52, v52, v81
    ds_write_b32 v52, v26 offset:8320
    v_mad_i32_i24 v81, v81, -3, v52
    ds_write_b16 v81, v119 offset:8324
    v_add_u32 v53, v53, v107
    v_mul_u32_u24 v53, 6, v53
    v_and_b32 v107, 2, v53
    v_add_u32 v53, v53, v107
    ds_write_b32 v53, v27 offset:8320
    v_mad_i32_i24 v107, v107, -3, v53
    ds_write_b16_d16_hi v107, v119 offset:8324
    v_add_u32 v54, v54, v121
    v_mul_u32_u24 v54, 6, v54
    v_and_b32 v121, 2, v54
    v_add_u32 v54, v54, v121
    ds_write_b32 v54, v28 offset:8320
    v_mad_i32_i24 v121, v121, -3, v54
    ds_write_b16 v121, v120 offset:8324
    v_cmp_gt_u32 vcc, 257, v0
    s_and_saveexec_b64 s[48:49], vcc
    s_cbranch_execz gemnet_part_kernel_nodesc_2
    ds_read_b32 v4, v2 offset:0
    ds_read_b32 v5, v2 offset:1024
    ds_read_b32 v6, v2 offset:2048
    ds_read_b32 v7, v2 offset:3072
    ds_read_b32 v8, v2 offset:4096
    ds_read_b32 v9, v2 offset:5120
    ds_read_b32 v10, v2 offset:6144
    ds_read_b32 v11, v2 offset:7168
    v_lshlrev_b32 v29, 15, v0
    s_waitcnt lgkmcnt(0)
    v_add_u32 v4, v4, v29
    v_add_u32 v5, v5, v29
    v_add_u32 v5, 8388608, v5
    v_add_u32 v6, v6, v29
    v_add_u32 v6, 16777216, v6
    v_add_u32 v7, v7, v29
    v_add_u32 v7, 25165824, v7
    v_add_u32 v8, v8, v29
    v_add_u32 v8, 33554432, v8
    v_add_u32 v9, v9, v29
    v_add_u32 v9, 41943040, v9
    v_add_u32 v10, v10, v29
    v_add_u32 v10, 50331648, v10
    v_add_u32 v11, v11, v29
    v_add_u32 v11, 58720256, v11
    v_lshl_or_b32 v12, v5, 16, v4
    v_lshl_or_b32 v13, v7, 16, v6
    v_lshl_or_b32 v14, v9, 16, v8
    v_lshl_or_b32 v15, v11, 16, v10
    buffer_store_dwordx4 v[12:15], v1, s[28:31], s38 offen
gemnet_part_kernel_nodesc_2:
    s_mov_b64 exec, s[48:49]
    s_waitcnt lgkmcnt(0)
    s_barrier
    ds_read_b128 v[30:33], v1 offset:8320
    ds_read_b128 v[34:37], v1 offset:24704
    ds_read_b128 v[38:41], v1 offset:41088
    ds_read_b128 v[42:45], v1 offset:57472
    v_add_u32 v29, 73856, v1
    ds_read_b128 v[46:49], v29 offset:0
    ds_read_b128 v[50:53], v29 offset:16384
    ds_read_b128 v[16:19], v29 offset:32768
    ds_read_b128 v[20:23], v29 offset:49152
    v_add_u32 v55, 139392, v1
    ds_read_b128 v[24:27], v55
    s_cmp_lt_u32 s43, 6
    s_cbranch_scc0 gemnet_part_kernel_notail_rd_2
    v_add_u32 v55, 155776, v1
    ds_read_b128 v[108:111], v55
gemnet_part_kernel_notail_rd_2:
    v_lshlrev_b32 v122, 16, v0
    v_add_u32 v123, 0x8000, v122
    v_lshlrev_b32 v124, 3, v0
    ds_write_b64 v124, v[122:123] offset:0
    s_add_u32 s40, s37, 0
    s_waitcnt lgkmcnt(0)
    buffer_store_dwordx4 v[30:33], v1, s[24:27], s40 offen sc0 sc1
    s_add_u32 s41, s37, 16384
    buffer_store_dwordx4 v[34:37], v1, s[24:27], s41 offen sc0 sc1
    s_add_u32 s40, s37, 32768
    buffer_store_dwordx4 v[38:41], v1, s[24:27], s40 offen sc0 sc1
    s_add_u32 s41, s37, 49152
    buffer_store_dwordx4 v[42:45], v1, s[24:27], s41 offen sc0 sc1
    s_add_u32 s40, s37, 65536
    buffer_store_dwordx4 v[46:49], v1, s[24:27], s40 offen sc0 sc1
    s_add_u32 s41, s37, 81920
    buffer_store_dwordx4 v[50:53], v1, s[24:27], s41 offen sc0 sc1
    s_add_u32 s40, s37, 98304
    buffer_store_dwordx4 v[16:19], v1, s[24:27], s40 offen sc0 sc1
    s_add_u32 s41, s37, 114688
    buffer_store_dwordx4 v[20:23], v1, s[24:27], s41 offen sc0 sc1
    s_add_u32 s40, s37, 131072
    buffer_store_dwordx4 v[24:27], v1, s[24:27], s40 offen sc0 sc1
    s_cmp_lt_u32 s43, 6
    s_cbranch_scc0 gemnet_part_kernel_notail_st_2
    s_add_u32 s42, s37, 147456
    buffer_store_dwordx4 v[108:111], v1, s[24:27], s42 offen sc0 sc1
gemnet_part_kernel_notail_st_2:
    s_barrier
    s_add_u32 s35, s35, 25600000
    s_add_u32 s36, s36, 12800000
    s_add_u32 s37, s37, 38400000
    s_add_u32 s38, s38, 1028000
    s_waitcnt vmcnt(9)
    v_lshlrev_b32 v29, 3, v0
    v_lshlrev_b32 v55, 1, v0
    s_add_u32 s40, s36, 0
    buffer_load_dwordx2 v[108:109], v29, s[20:23], s40 offen nt
    s_add_u32 s41, s36, 8192
    buffer_load_dwordx2 v[110:111], v29, s[20:23], s41 offen nt
    s_add_u32 s40, s36, 16384
    buffer_load_dwordx2 v[112:113], v29, s[20:23], s40 offen nt
    s_add_u32 s41, s36, 24576
    buffer_load_dwordx2 v[114:115], v29, s[20:23], s41 offen nt
    s_add_u32 s40, s36, 32768
    buffer_load_dwordx2 v[116:117], v29, s[20:23], s40 offen nt
    s_add_u32 s41, s36, 40960
    buffer_load_dwordx2 v[118:119], v29, s[20:23], s41 offen nt
    s_add_u32 s42, s36, 49152
    buffer_load_ushort v120, v55, s[20:23], s42 offen nt
    v_mul_hi_u32_u24 v81, s32, v82
    v_lshrrev_b32 v121, 5, v56
    v_mad_i32_i24 v107, v81, s33, v82
    v_mul_hi_u32_u24 v121, s32, v121
    v_lshlrev_b32 v82, 2, v81
    v_mad_i32_i24 v56, v121, s34, v56
    v_lshl_add_u32 v82, v121, 10, v82
    v_lshlrev_b32 v56, 3, v56
    ds_add_rtn_u32 v82, v82, v3 offset:0
    v_lshl_or_b32 v56, v107, 20, v56
    v_mul_hi_u32_u24 v81, s32, v83
    v_lshrrev_b32 v121, 5, v57
    v_mad_i32_i24 v107, v81, s33, v83
    v_mul_hi_u32_u24 v121, s32, v121
    v_lshlrev_b32 v83, 2, v81
    v_mad_i32_i24 v57, v121, s34, v57
    v_lshl_add_u32 v83, v121, 10, v83
    v_lshlrev_b32 v57, 3, v57
    ds_add_rtn_u32 v83, v83, v3 offset:0
    v_lshl_or_b32 v57, v107, 20, v57
    v_mul_hi_u32_u24 v81, s32, v84
    v_lshrrev_b32 v121, 5, v58
    v_mad_i32_i24 v107, v81, s33, v84
    v_mul_hi_u32_u24 v121, s32, v121
    v_lshlrev_b32 v84, 2, v81
    v_mad_i32_i24 v58, v121, s34, v58
    v_lshl_add_u32 v84, v121, 10, v84
    v_lshlrev_b32 v58, 3, v58
    ds_add_rtn_u32 v84, v84, v3 offset:0
    v_lshl_or_b32 v58, v107, 20, v58
    v_mul_hi_u32_u24 v81, s32, v85
    v_lshrrev_b32 v121, 5, v59
    v_mad_i32_i24 v107, v81, s33, v85
    v_mul_hi_u32_u24 v121, s32, v121
    v_lshlrev_b32 v85, 2, v81
    v_mad_i32_i24 v59, v121, s34, v59
    v_lshl_add_u32 v85, v121, 10, v85
    v_lshlrev_b32 v59, 3, v59
    ds_add_rtn_u32 v85, v85, v3 offset:0
    v_lshl_or_b32 v59, v107, 20, v59
    v_mul_hi_u32_u24 v81, s32, v86
    v_lshrrev_b32 v121, 5, v60
    v_mad_i32_i24 v107, v81, s33, v86
    v_mul_hi_u32_u24 v121, s32, v121
    v_lshlrev_b32 v86, 2, v81
    v_mad_i32_i24 v60, v121, s34, v60
    v_lshl_add_u32 v86, v121, 10, v86
    v_lshlrev_b32 v60, 3, v60
    ds_add_rtn_u32 v86, v86, v3 offset:0
    v_lshl_or_b32 v60, v107, 20, v60
    v_mul_hi_u32_u24 v81, s32, v87
    v_lshrrev_b32 v121, 5, v61
    v_mad_i32_i24 v107, v81, s33, v87
    v_mul_hi_u32_u24 v121, s32, v121
    v_lshlrev_b32 v87, 2, v81
    v_mad_i32_i24 v61, v121, s34, v61
    v_lshl_add_u32 v87, v121, 10, v87
    v_lshlrev_b32 v61, 3, v61
    ds_add_rtn_u32 v87, v87, v3 offset:0
    v_lshl_or_b32 v61, v107, 20, v61
    v_mul_hi_u32_u24 v81, s32, v88
    v_lshrrev_b32 v121, 5, v62
    v_mad_i32_i24 v107, v81, s33, v88
    v_mul_hi_u32_u24 v121, s32, v121
    v_lshlrev_b32 v88, 2, v81
    v_mad_i32_i24 v62, v121, s34, v62
    v_lshl_add_u32 v88, v121, 10, v88
    v_lshlrev_b32 v62, 3, v62
    ds_add_rtn_u32 v88, v88, v3 offset:0
    v_lshl_or_b32 v62, v107, 20, v62
    v_mul_hi_u32_u24 v81, s32, v89
    v_lshrrev_b32 v121, 5, v63
    v_mad_i32_i24 v107, v81, s33, v89
    v_mul_hi_u32_u24 v121, s32, v121
    v_lshlrev_b32 v89, 2, v81
    v_mad_i32_i24 v63, v121, s34, v63
    v_lshl_add_u32 v89, v121, 10, v89
    v_lshlrev_b32 v63, 3, v63
    ds_add_rtn_u32 v89, v89, v3 offset:0
    v_lshl_or_b32 v63, v107, 20, v63
    v_mul_hi_u32_u24 v81, s32, v90
    v_lshrrev_b32 v121, 5, v64
    v_mad_i32_i24 v107, v81, s33, v90
    v_mul_hi_u32_u24 v121, s32, v121
    v_lshlrev_b32 v90, 2, v81
    v_mad_i32_i24 v64, v121, s34, v64
    v_lshl_add_u32 v90, v121, 10, v90
    v_lshlrev_b32 v64, 3, v64
    ds_add_rtn_u32 v90, v90, v3 offset:0
    v_lshl_or_b32 v64, v107, 20, v64
    v_mul_hi_u32_u24 v81, s32, v91
    v_lshrrev_b32 v121, 5, v65
    v_mad_i32_i24 v107, v81, s33, v91
    v_mul_hi_u32_u24 v121, s32, v121
    v_lshlrev_b32 v91, 2, v81
    v_mad_i32_i24 v65, v121, s34, v65
    v_lshl_add_u32 v91, v121, 10, v91
    v_lshlrev_b32 v65, 3, v65
    ds_add_rtn_u32 v91, v91, v3 offset:0
    v_lshl_or_b32 v65, v107, 20, v65
    v_mul_hi_u32_u24 v81, s32, v92
    v_lshrrev_b32 v121, 5, v66
    v_mad_i32_i24 v107, v81, s33, v92
    v_mul_hi_u32_u24 v121, s32, v121
    v_lshlrev_b32 v92, 2, v81
    v_mad_i32_i24 v66, v121, s34, v66
    v_lshl_add_u32 v92, v121, 10, v92
    v_lshlrev_b32 v66, 3, v66
    ds_add_rtn_u32 v92, v92, v3 offset:0
    v_lshl_or_b32 v66, v107, 20, v66
    v_mul_hi_u32_u24 v81, s32, v93
    v_lshrrev_b32 v121, 5, v67
    v_mad_i32_i24 v107, v81, s33, v93
    v_mul_hi_u32_u24 v121, s32, v121
    v_lshlrev_b32 v93, 2, v81
    v_mad_i32_i24 v67, v121, s34, v67
    v_lshl_add_u32 v93, v121, 10, v93
    v_lshlrev_b32 v67, 3, v67
    ds_add_rtn_u32 v93, v93, v3 offset:0
    v_lshl_or_b32 v67, v107, 20, v67
    v_mul_hi_u32_u24 v81, s32, v94
    v_lshrrev_b32 v121, 5, v68
    v_mad_i32_i24 v107, v81, s33, v94
    v_mul_hi_u32_u24 v121, s32, v121
    v_lshlrev_b32 v94, 2, v81
    v_mad_i32_i24 v68, v121, s34, v68
    v_lshl_add_u32 v94, v121, 10, v94
    v_lshlrev_b32 v68, 3, v68
    ds_add_rtn_u32 v94, v94, v3 offset:0
    v_lshl_or_b32 v68, v107, 20, v68
    v_mul_hi_u32_u24 v81, s32, v95
    v_lshrrev_b32 v121, 5, v69
    v_mad_i32_i24 v107, v81, s33, v95
    v_mul_hi_u32_u24 v121, s32, v121
    v_lshlrev_b32 v95, 2, v81
    v_mad_i32_i24 v69, v121, s34, v69
    v_lshl_add_u32 v95, v121, 10, v95
    v_lshlrev_b32 v69, 3, v69
    ds_add_rtn_u32 v95, v95, v3 offset:0
    v_lshl_or_b32 v69, v107, 20, v69
    v_mul_hi_u32_u24 v81, s32, v96
    v_lshrrev_b32 v121, 5, v70
    v_mad_i32_i24 v107, v81, s33, v96
    v_mul_hi_u32_u24 v121, s32, v121
    v_lshlrev_b32 v96, 2, v81
    v_mad_i32_i24 v70, v121, s34, v70
    v_lshl_add_u32 v96, v121, 10, v96
    v_lshlrev_b32 v70, 3, v70
    ds_add_rtn_u32 v96, v96, v3 offset:0
    v_lshl_or_b32 v70, v107, 20, v70
    v_mul_hi_u32_u24 v81, s32, v97
    v_lshrrev_b32 v121, 5, v71
    v_mad_i32_i24 v107, v81, s33, v97
    v_mul_hi_u32_u24 v121, s32, v121
    v_lshlrev_b32 v97, 2, v81
    v_mad_i32_i24 v71, v121, s34, v71
    v_lshl_add_u32 v97, v121, 10, v97
    v_lshlrev_b32 v71, 3, v71
    ds_add_rtn_u32 v97, v97, v3 offset:0
    v_lshl_or_b32 v71, v107, 20, v71
    v_mul_hi_u32_u24 v81, s32, v98
    v_lshrrev_b32 v121, 5, v72
    v_mad_i32_i24 v107, v81, s33, v98
    v_mul_hi_u32_u24 v121, s32, v121
    v_lshlrev_b32 v98, 2, v81
    v_mad_i32_i24 v72, v121, s34, v72
    v_lshl_add_u32 v98, v121, 10, v98
    v_lshlrev_b32 v72, 3, v72
    ds_add_rtn_u32 v98, v98, v3 offset:0
    v_lshl_or_b32 v72, v107, 20, v72
    v_mul_hi_u32_u24 v81, s32, v99
    v_lshrrev_b32 v121, 5, v73
    v_mad_i32_i24 v107, v81, s33, v99
    v_mul_hi_u32_u24 v121, s32, v121
    v_lshlrev_b32 v99, 2, v81
    v_mad_i32_i24 v73, v121, s34, v73
    v_lshl_add_u32 v99, v121, 10, v99
    v_lshlrev_b32 v73, 3, v73
    ds_add_rtn_u32 v99, v99, v3 offset:0
    v_lshl_or_b32 v73, v107, 20, v73
    v_mul_hi_u32_u24 v81, s32, v100
    v_lshrrev_b32 v121, 5, v74
    v_mad_i32_i24 v107, v81, s33, v100
    v_mul_hi_u32_u24 v121, s32, v121
    v_lshlrev_b32 v100, 2, v81
    v_mad_i32_i24 v74, v121, s34, v74
    v_lshl_add_u32 v100, v121, 10, v100
    v_lshlrev_b32 v74, 3, v74
    ds_add_rtn_u32 v100, v100, v3 offset:0
    v_lshl_or_b32 v74, v107, 20, v74
    v_mul_hi_u32_u24 v81, s32, v101
    v_lshrrev_b32 v121, 5, v75
    v_mad_i32_i24 v107, v81, s33, v101
    v_mul_hi_u32_u24 v121, s32, v121
    v_lshlrev_b32 v101, 2, v81
    v_mad_i32_i24 v75, v121, s34, v75
    v_lshl_add_u32 v101, v121, 10, v101
    v_lshlrev_b32 v75, 3, v75
    ds_add_rtn_u32 v101, v101, v3 offset:0
    v_lshl_or_b32 v75, v107, 20, v75
    v_mul_hi_u32_u24 v81, s32, v102
    v_lshrrev_b32 v121, 5, v76
    v_mad_i32_i24 v107, v81, s33, v102
    v_mul_hi_u32_u24 v121, s32, v121
    v_lshlrev_b32 v102, 2, v81
    v_mad_i32_i24 v76, v121, s34, v76
    v_lshl_add_u32 v102, v121, 10, v102
    v_lshlrev_b32 v76, 3, v76
    ds_add_rtn_u32 v102, v102, v3 offset:0
    v_lshl_or_b32 v76, v107, 20, v76
    v_mul_hi_u32_u24 v81, s32, v103
    v_lshrrev_b32 v121, 5, v77
    v_mad_i32_i24 v107, v81, s33, v103
    v_mul_hi_u32_u24 v121, s32, v121
    v_lshlrev_b32 v103, 2, v81
    v_mad_i32_i24 v77, v121, s34, v77
    v_lshl_add_u32 v103, v121, 10, v103
    v_lshlrev_b32 v77, 3, v77
    ds_add_rtn_u32 v103, v103, v3 offset:0
    v_lshl_or_b32 v77, v107, 20, v77
    v_mul_hi_u32_u24 v81, s32, v104
    v_lshrrev_b32 v121, 5, v78
    v_mad_i32_i24 v107, v81, s33, v104
    v_mul_hi_u32_u24 v121, s32, v121
    v_lshlrev_b32 v104, 2, v81
    v_mad_i32_i24 v78, v121, s34, v78
    v_lshl_add_u32 v104, v121, 10, v104
    v_lshlrev_b32 v78, 3, v78
    ds_add_rtn_u32 v104, v104, v3 offset:0
    v_lshl_or_b32 v78, v107, 20, v78
    v_mul_hi_u32_u24 v81, s32, v105
    v_lshrrev_b32 v121, 5, v79
    v_mad_i32_i24 v107, v81, s33, v105
    v_mul_hi_u32_u24 v121, s32, v121
    v_lshlrev_b32 v105, 2, v81
    v_mad_i32_i24 v79, v121, s34, v79
    v_lshl_add_u32 v105, v121, 10, v105
    v_lshlrev_b32 v79, 3, v79
    ds_add_rtn_u32 v105, v105, v3 offset:0
    v_lshl_or_b32 v79, v107, 20, v79
    v_mul_hi_u32_u24 v81, s32, v106
    v_lshrrev_b32 v121, 5, v80
    v_mad_i32_i24 v107, v81, s33, v106
    v_mul_hi_u32_u24 v121, s32, v121
    v_lshlrev_b32 v106, 2, v81
    v_mad_i32_i24 v80, v121, s34, v80
    v_lshl_add_u32 v106, v121, 10, v106
    v_lshlrev_b32 v80, 3, v80
    ds_add_rtn_u32 v106, v106, v3 offset:0
    v_lshl_or_b32 v80, v107, 20, v80
    s_waitcnt lgkmcnt(0)
    s_barrier
    v_lshlrev_b32 v125, 3, v0
    ds_read_b64 v[122:123], v125 offset:0
    s_waitcnt lgkmcnt(0)
    v_and_b32 v122, 0x7fff, v122
    v_and_b32 v123, 0x7fff, v123
    v_add_u32 v124, v122, v123
    v_mov_b32 v126, v124
    s_nop 1
    v_add_u32_dpp v126, v126, v126 row_shr:1 row_mask:0xf bank_mask:0xf
    s_nop 1
    v_add_u32_dpp v126, v126, v126 row_shr:2 row_mask:0xf bank_mask:0xf
    s_nop 1
    v_add_u32_dpp v126, v126, v126 row_shr:4 row_mask:0xf bank_mask:0xf
    s_nop 1
    v_add_u32_dpp v126, v126, v126 row_shr:8 row_mask:0xf bank_mask:0xf
    s_nop 1
    v_add_u32_dpp v126, v126, v126 row_bcast:15 row_mask:0xa bank_mask:0xf
    s_nop 1
    v_add_u32_dpp v126, v126, v126 row_bcast:31 row_mask:0xc bank_mask:0xf
    s_mov_b64 exec, s[46:47]
    s_lshl_b32 s40, s43, 2
    v_mov_b32 v127, s40
    ds_write_b32 v127, v126 offset:8208
    s_mov_b64 exec, -1
    s_waitcnt lgkmcnt(0)
    s_barrier
    v_and_b32 v127, 15, v0
    v_lshlrev_b32 v121, 2, v127
    ds_read_b32 v121, v121 offset:8208
    v_cmp_gt_u32 s[52:53], s43, v127
    v_sub_u32 v126, v126, v124
    s_waitcnt lgkmcnt(0)
    v_cndmask_b32 v121, 0, v121, s[52:53]
    s_nop 1
    v_add_u32_dpp v121, v121, v121 row_shr:1 row_mask:0xf bank_mask:0xf
    s_nop 1
    v_add_u32_dpp v121, v121, v121 row_shr:2 row_mask:0xf bank_mask:0xf
    s_nop 1
    v_add_u32_dpp v121, v121, v121 row_shr:4 row_mask:0xf bank_mask:0xf
    s_nop 1
    v_add_u32_dpp v121, v121, v121 row_shr:8 row_mask:0xf bank_mask:0xf
    s_nop 1
    v_readlane_b32 s50, v121, 15
    v_lshlrev_b32 v121, 16, v0
    v_sub_u32 v126, v126, v121
    v_add_u32 v126, s50, v126
    v_add_u32 v123, v126, v122
    v_mov_b32 v122, v126
    v_subrev_u32 v123, 0x8000, v123
    ds_write_b64 v125, v[122:123] offset:0
    s_waitcnt lgkmcnt(0)
    s_barrier
    s_waitcnt vmcnt(0)
    v_lshrrev_b32 v29, 13, v82
    v_and_b32 v29, 0x1ffc, v29
    ds_read_b32 v29, v29 offset:0
    v_lshrrev_b32 v55, 13, v83
    v_and_b32 v55, 0x1ffc, v55
    ds_read_b32 v55, v55 offset:0
    v_lshrrev_b32 v81, 13, v84
    v_and_b32 v81, 0x1ffc, v81
    ds_read_b32 v81, v81 offset:0
    v_lshrrev_b32 v107, 13, v85
    v_and_b32 v107, 0x1ffc, v107
    ds_read_b32 v107, v107 offset:0
    v_lshrrev_b32 v121, 13, v86
    v_and_b32 v121, 0x1ffc, v121
    ds_read_b32 v121, v121 offset:0
    s_waitcnt lgkmcnt(0)
    v_add_u32 v82, v82, v29
    v_mul_u32_u24 v82, 6, v82
    v_and_b32 v29, 2, v82
    v_add_u32 v82, v82, v29
    ds_write_b32 v82, v56 offset:8320
    v_mad_i32_i24 v29, v29, -3, v82
    ds_write_b16 v29, v108 offset:8324
    v_add_u32 v83, v83, v55
    v_mul_u32_u24 v83, 6, v83
    v_and_b32 v55, 2, v83
    v_add_u32 v83, v83, v55
    ds_write_b32 v83, v57 offset:8320
    v_mad_i32_i24 v55, v55, -3, v83
    ds_write_b16_d16_hi v55, v108 offset:8324
    v_add_u32 v84, v84, v81
    v_mul_u32_u24 v84, 6, v84
    v_and_b32 v81, 2, v84
    v_add_u32 v84, v84, v81
    ds_write_b32 v84, v58 offset:8320
    v_mad_i32_i24 v81, v81, -3, v84
    ds_write_b16 v81, v109 offset:8324
    v_add_u32 v85, v85, v107
    v_mul_u32_u24 v85, 6, v85
    v_and_b32 v107, 2, v85
    v_add_u32 v85, v85, v107
    ds_write_b32 v85, v59 offset:8320
    v_mad_i32_i24 v107, v107, -3, v85
    ds_write_b16_d16_hi v107, v109 offset:8324
    v_add_u32 v86, v86, v121
    v_mul_u32_u24 v86, 6, v86
    v_and_b32 v121, 2, v86
    v_add_u32 v86, v86, v121
    ds_write_b32 v86, v60 offset:8320
    v_mad_i32_i24 v121, v121, -3, v86
    ds_write_b16 v121, v110 offset:8324
    v_lshrrev_b32 v29, 13, v87
    v_and_b32 v29, 0x1ffc, v29
    ds_read_b32 v29, v29 offset:0
    v_lshrrev_b32 v55, 13, v88
    v_and_b32 v55, 0x1ffc, v55
    ds_read_b32 v55, v55 offset:0
    v_lshrrev_b32 v81, 13, v89
    v_and_b32 v81, 0x1ffc, v81
    ds_read_b32 v81, v81 offset:0
    v_lshrrev_b32 v107, 13, v90
    v_and_b32 v107, 0x1ffc, v107
    ds_read_b32 v107, v107 offset:0
    v_lshrrev_b32 v121, 13, v91
    v_and_b32 v121, 0x1ffc, v121
    ds_read_b32 v121, v121 offset:0
    s_waitcnt lgkmcnt(0)
    v_add_u32 v87, v87, v29
    v_mul_u32_u24 v87, 6, v87
    v_and_b32 v29, 2, v87
    v_add_u32 v87, v87, v29
    ds_write_b32 v87, v61 offset:8320
    v_mad_i32_i24 v29, v29, -3, v87
    ds_write_b16_d16_hi v29, v110 offset:8324
    v_add_u32 v88, v88, v55
    v_mul_u32_u24 v88, 6, v88
    v_and_b32 v55, 2, v88
    v_add_u32 v88, v88, v55
    ds_write_b32 v88, v62 offset:8320
    v_mad_i32_i24 v55, v55, -3, v88
    ds_write_b16 v55, v111 offset:8324
    v_add_u32 v89, v89, v81
    v_mul_u32_u24 v89, 6, v89
    v_and_b32 v81, 2, v89
    v_add_u32 v89, v89, v81
    ds_write_b32 v89, v63 offset:8320
    v_mad_i32_i24 v81, v81, -3, v89
    ds_write_b16_d16_hi v81, v111 offset:8324
    v_add_u32 v90, v90, v107
    v_mul_u32_u24 v90, 6, v90
    v_and_b32 v107, 2, v90
    v_add_u32 v90, v90, v107
    ds_write_b32 v90, v64 offset:8320
    v_mad_i32_i24 v107, v107, -3, v90
    ds_write_b16 v107, v112 offset:8324
    v_add_u32 v91, v91, v121
    v_mul_u32_u24 v91, 6, v91
    v_and_b32 v121, 2, v91
    v_add_u32 v91, v91, v121
    ds_write_b32 v91, v65 offset:8320
    v_mad_i32_i24 v121, v121, -3, v91
    ds_write_b16_d16_hi v121, v112 offset:8324
    v_lshrrev_b32 v29, 13, v92
    v_and_b32 v29, 0x1ffc, v29
    ds_read_b32 v29, v29 offset:0
    v_lshrrev_b32 v55, 13, v93
    v_and_b32 v55, 0x1ffc, v55
    ds_read_b32 v55, v55 offset:0
    v_lshrrev_b32 v81, 13, v94
    v_and_b32 v81, 0x1ffc, v81
    ds_read_b32 v81, v81 offset:0
    v_lshrrev_b32 v107, 13, v95
    v_and_b32 v107, 0x1ffc, v107
    ds_read_b32 v107, v107 offset:0
    v_lshrrev_b32 v121, 13, v96
    v_and_b32 v121, 0x1ffc, v121
    ds_read_b32 v121, v121 offset:0
    s_waitcnt lgkmcnt(0)
    v_add_u32 v92, v92, v29
    v_mul_u32_u24 v92, 6, v92
    v_and_b32 v29, 2, v92
    v_add_u32 v92, v92, v29
    ds_write_b32 v92, v66 offset:8320
    v_mad_i32_i24 v29, v29, -3, v92
    ds_write_b16 v29, v113 offset:8324
    v_add_u32 v93, v93, v55
    v_mul_u32_u24 v93, 6, v93
    v_and_b32 v55, 2, v93
    v_add_u32 v93, v93, v55
    ds_write_b32 v93, v67 offset:8320
    v_mad_i32_i24 v55, v55, -3, v93
    ds_write_b16_d16_hi v55, v113 offset:8324
    v_add_u32 v94, v94, v81
    v_mul_u32_u24 v94, 6, v94
    v_and_b32 v81, 2, v94
    v_add_u32 v94, v94, v81
    ds_write_b32 v94, v68 offset:8320
    v_mad_i32_i24 v81, v81, -3, v94
    ds_write_b16 v81, v114 offset:8324
    v_add_u32 v95, v95, v107
    v_mul_u32_u24 v95, 6, v95
    v_and_b32 v107, 2, v95
    v_add_u32 v95, v95, v107
    ds_write_b32 v95, v69 offset:8320
    v_mad_i32_i24 v107, v107, -3, v95
    ds_write_b16_d16_hi v107, v114 offset:8324
    v_add_u32 v96, v96, v121
    v_mul_u32_u24 v96, 6, v96
    v_and_b32 v121, 2, v96
    v_add_u32 v96, v96, v121
    ds_write_b32 v96, v70 offset:8320
    v_mad_i32_i24 v121, v121, -3, v96
    ds_write_b16 v121, v115 offset:8324
    v_lshrrev_b32 v29, 13, v97
    v_and_b32 v29, 0x1ffc, v29
    ds_read_b32 v29, v29 offset:0
    v_lshrrev_b32 v55, 13, v98
    v_and_b32 v55, 0x1ffc, v55
    ds_read_b32 v55, v55 offset:0
    v_lshrrev_b32 v81, 13, v99
    v_and_b32 v81, 0x1ffc, v81
    ds_read_b32 v81, v81 offset:0
    v_lshrrev_b32 v107, 13, v100
    v_and_b32 v107, 0x1ffc, v107
    ds_read_b32 v107, v107 offset:0
    v_lshrrev_b32 v121, 13, v101
    v_and_b32 v121, 0x1ffc, v121
    ds_read_b32 v121, v121 offset:0
    s_waitcnt lgkmcnt(0)
    v_add_u32 v97, v97, v29
    v_mul_u32_u24 v97, 6, v97
    v_and_b32 v29, 2, v97
    v_add_u32 v97, v97, v29
    ds_write_b32 v97, v71 offset:8320
    v_mad_i32_i24 v29, v29, -3, v97
    ds_write_b16_d16_hi v29, v115 offset:8324
    v_add_u32 v98, v98, v55
    v_mul_u32_u24 v98, 6, v98
    v_and_b32 v55, 2, v98
    v_add_u32 v98, v98, v55
    ds_write_b32 v98, v72 offset:8320
    v_mad_i32_i24 v55, v55, -3, v98
    ds_write_b16 v55, v116 offset:8324
    v_add_u32 v99, v99, v81
    v_mul_u32_u24 v99, 6, v99
    v_and_b32 v81, 2, v99
    v_add_u32 v99, v99, v81
    ds_write_b32 v99, v73 offset:8320
    v_mad_i32_i24 v81, v81, -3, v99
    ds_write_b16_d16_hi v81, v116 offset:8324
    v_add_u32 v100, v100, v107
    v_mul_u32_u24 v100, 6, v100
    v_and_b32 v107, 2, v100
    v_add_u32 v100, v100, v107
    ds_write_b32 v100, v74 offset:8320
    v_mad_i32_i24 v107, v107, -3, v100
    ds_write_b16 v107, v117 offset:8324
    v_add_u32 v101, v101, v121
    v_mul_u32_u24 v101, 6, v101
    v_and_b32 v121, 2, v101
    v_add_u32 v101, v101, v121
    ds_write_b32 v101, v75 offset:8320
    v_mad_i32_i24 v121, v121, -3, v101
    ds_write_b16_d16_hi v121, v117 offset:8324
    v_lshrrev_b32 v29, 13, v102
    v_and_b32 v29, 0x1ffc, v29
    ds_read_b32 v29, v29 offset:0
    v_lshrrev_b32 v55, 13, v103
    v_and_b32 v55, 0x1ffc, v55
    ds_read_b32 v55, v55 offset:0
    v_lshrrev_b32 v81, 13, v104
    v_and_b32 v81, 0x1ffc, v81
    ds_read_b32 v81, v81 offset:0
    v_lshrrev_b32 v107, 13, v105
    v_and_b32 v107, 0x1ffc, v107
    ds_read_b32 v107, v107 offset:0
    v_lshrrev_b32 v121, 13, v106
    v_and_b32 v121, 0x1ffc, v121
    ds_read_b32 v121, v121 offset:0
    s_waitcnt lgkmcnt(0)
    v_add_u32 v102, v102, v29
    v_mul_u32_u24 v102, 6, v102
    v_and_b32 v29, 2, v102
    v_add_u32 v102, v102, v29
    ds_write_b32 v102, v76 offset:8320
    v_mad_i32_i24 v29, v29, -3, v102
    ds_write_b16 v29, v118 offset:8324
    v_add_u32 v103, v103, v55
    v_mul_u32_u24 v103, 6, v103
    v_and_b32 v55, 2, v103
    v_add_u32 v103, v103, v55
    ds_write_b32 v103, v77 offset:8320
    v_mad_i32_i24 v55, v55, -3, v103
    ds_write_b16_d16_hi v55, v118 offset:8324
    v_add_u32 v104, v104, v81
    v_mul_u32_u24 v104, 6, v104
    v_and_b32 v81, 2, v104
    v_add_u32 v104, v104, v81
    ds_write_b32 v104, v78 offset:8320
    v_mad_i32_i24 v81, v81, -3, v104
    ds_write_b16 v81, v119 offset:8324
    v_add_u32 v105, v105, v107
    v_mul_u32_u24 v105, 6, v105
    v_and_b32 v107, 2, v105
    v_add_u32 v105, v105, v107
    ds_write_b32 v105, v79 offset:8320
    v_mad_i32_i24 v107, v107, -3, v105
    ds_write_b16_d16_hi v107, v119 offset:8324
    v_add_u32 v106, v106, v121
    v_mul_u32_u24 v106, 6, v106
    v_and_b32 v121, 2, v106
    v_add_u32 v106, v106, v121
    ds_write_b32 v106, v80 offset:8320
    v_mad_i32_i24 v121, v121, -3, v106
    ds_write_b16 v121, v120 offset:8324
    v_cmp_gt_u32 vcc, 257, v0
    s_and_saveexec_b64 s[48:49], vcc
    s_cbranch_execz gemnet_part_kernel_nodesc_3
    ds_read_b32 v56, v2 offset:0
    ds_read_b32 v57, v2 offset:1024
    ds_read_b32 v58, v2 offset:2048
    ds_read_b32 v59, v2 offset:3072
    ds_read_b32 v60, v2 offset:4096
    ds_read_b32 v61, v2 offset:5120
    ds_read_b32 v62, v2 offset:6144
    ds_read_b32 v63, v2 offset:7168
    v_lshlrev_b32 v29, 15, v0
    s_waitcnt lgkmcnt(0)
    v_add_u32 v56, v56, v29
    v_add_u32 v57, v57, v29
    v_add_u32 v57, 8388608, v57
    v_add_u32 v58, v58, v29
    v_add_u32 v58, 16777216, v58
    v_add_u32 v59, v59, v29
    v_add_u32 v59, 25165824, v59
    v_add_u32 v60, v60, v29
    v_add_u32 v60, 33554432, v60
    v_add_u32 v61, v61, v29
    v_add_u32 v61, 41943040, v61
    v_add_u32 v62, v62, v29
    v_add_u32 v62, 50331648, v62
    v_add_u32 v63, v63, v29
    v_add_u32 v63, 58720256, v63
    v_lshl_or_b32 v64, v57, 16, v56
    v_lshl_or_b32 v65, v59, 16, v58
    v_lshl_or_b32 v66, v61, 16, v60
    v_lshl_or_b32 v67, v63, 16, v62
    buffer_store_dwordx4 v[64:67], v1, s[28:31], s38 offen
gemnet_part_kernel_nodesc_3:
    s_mov_b64 exec, s[48:49]
    s_waitcnt lgkmcnt(0)
    s_barrier
    ds_read_b128 v[82:85], v1 offset:8320
    ds_read_b128 v[86:89], v1 offset:24704
    ds_read_b128 v[90:93], v1 offset:41088
    ds_read_b128 v[94:97], v1 offset:57472
    v_add_u32 v29, 73856, v1
    ds_read_b128 v[98:101], v29 offset:0
    ds_read_b128 v[102:105], v29 offset:16384
    ds_read_b128 v[68:71], v29 offset:32768
    ds_read_b128 v[72:75], v29 offset:49152
    v_add_u32 v55, 139392, v1
    ds_read_b128 v[76:79], v55
    s_cmp_lt_u32 s43, 6
    s_cbranch_scc0 gemnet_part_kernel_notail_rd_3
    v_add_u32 v55, 155776, v1
    ds_read_b128 v[108:111], v55
gemnet_part_kernel_notail_rd_3:
    v_lshlrev_b32 v122, 16, v0
    v_add_u32 v123, 0x8000, v122
    v_lshlrev_b32 v124, 3, v0
    ds_write_b64 v124, v[122:123] offset:0
    s_add_u32 s40, s37, 0
    s_waitcnt lgkmcnt(0)
    buffer_store_dwordx4 v[82:85], v1, s[24:27], s40 offen sc0 sc1
    s_add_u32 s41, s37, 16384
    buffer_store_dwordx4 v[86:89], v1, s[24:27], s41 offen sc0 sc1
    s_add_u32 s40, s37, 32768
    buffer_store_dwordx4 v[90:93], v1, s[24:27], s40 offen sc0 sc1
    s_add_u32 s41, s37, 49152
    buffer_store_dwordx4 v[94:97], v1, s[24:27], s41 offen sc0 sc1
    s_add_u32 s40, s37, 65536
    buffer_store_dwordx4 v[98:101], v1, s[24:27], s40 offen sc0 sc1
    s_add_u32 s41, s37, 81920
    buffer_store_dwordx4 v[102:105], v1, s[24:27], s41 offen sc0 sc1
    s_add_u32 s40, s37, 98304
    buffer_store_dwordx4 v[68:71], v1, s[24:27], s40 offen sc0 sc1
    s_add_u32 s41, s37, 114688
    buffer_store_dwordx4 v[72:75], v1, s[24:27], s41 offen sc0 sc1
    s_add_u32 s40, s37, 131072
    buffer_store_dwordx4 v[76:79], v1, s[24:27], s40 offen sc0 sc1
    s_cmp_lt_u32 s43, 6
    s_cbranch_scc0 gemnet_part_kernel_notail_st_3
    s_add_u32 s42, s37, 147456
    buffer_store_dwordx4 v[108:111], v1, s[24:27], s42 offen sc0 sc1
gemnet_part_kernel_notail_st_3:
    s_barrier
gemnet_part_kernel_done:
    s_endpgm
.globl gemnet_accum_kernel
.p2align 8
.type gemnet_accum_kernel,@function
gemnet_accum_kernel:
    s_cmp_ge_u32 s2, 256
    s_cbranch_scc1 gemnet_accum_kernel_exit
    s_load_dwordx2 s[4:5], s[0:1], 0
    s_load_dwordx2 s[8:9], s[0:1], 104
    s_load_dwordx4 s[92:95], s[0:1], 40
    s_load_dwordx4 s[96:99], s[0:1], 64
    s_load_dwordx2 s[76:77], s[0:1], 24
    s_and_b32 s3, s2, 7
    s_lshl_b32 s3, s3, 5
    s_lshr_b32 s22, s2, 3
    s_add_u32 s3, s3, s22
    v_lshrrev_b32 v90, 6, v0
    v_and_b32 v1, 63, v0
    v_mov_b32 v3, 1
    v_readfirstlane_b32 s22, v90
    v_mul_u32_u24 v2, 6, v1
    v_lshlrev_b32 v91, 4, v1
    v_add_u32 v91, s22, v91
    v_mul_u32_u24 v92, 4112, v91
    v_mul_u32_u24 v4, 153600, v91
    v_lshlrev_b32 v110, 1, v0
    v_lshlrev_b32 v111, 4, v0
    s_waitcnt lgkmcnt(0)
    s_add_u32 s84, s8, 153600000
    s_addc_u32 s85, s9, 0
    s_and_b32 s85, s85, 0xffff
    s_mov_b32 s86, 4112000
    s_mov_b32 s87, 0x00020000
    s_lshl_b32 s73, s3, 4
    buffer_load_dwordx4 v[6:9], v92, s[84:87], s73 offen
    buffer_load_dwordx4 v[10:13], v92, s[84:87], s73 offen offset:16
    s_load_dwordx16 s[28:43], s[96:97], 0
    s_load_dwordx16 s[44:59], s[96:97], 64
    s_load_dwordx8 s[60:67], s[98:99], 0
    s_load_dwordx4 s[68:71], s[92:93], 0
    s_load_dword s72, s[94:95], 0
    s_and_b32 s77, s77, 0xffff
    s_mov_b32 s78, 1600000
    s_mov_b32 s79, 0x00020000
    s_mul_i32 s74, s3, 6250
    s_add_u32 s75, s74, 0
    buffer_load_ushort v106, v110, s[76:79], s75 offen
    s_add_u32 s75, s74, 2048
    buffer_load_ushort v107, v110, s[76:79], s75 offen
    s_add_u32 s75, s74, 4096
    buffer_load_ushort v108, v110, s[76:79], s75 offen
    s_add_u32 s75, s74, 6144
    buffer_load_ushort v109, v110, s[76:79], s75 offen
    s_and_b32 s5, s5, 0xffff
    s_mov_b32 s6, 6400000
    s_mov_b32 s7, 0x00020000
    s_and_b32 s9, s9, 0xffff
    s_mov_b32 s10, 153600000
    s_mov_b32 s11, 0x00020000
    v_mov_b32 v14, 0
    v_mov_b32 v15, 0
    v_mov_b32 v16, 0
    v_mov_b32 v17, 0
    v_mov_b32 v18, 0
    v_mov_b32 v19, 0
    v_mov_b32 v20, 0
    v_mov_b32 v21, 0
    v_mov_b32 v22, 0
    v_mov_b32 v23, 0
    v_mov_b32 v24, 0
    v_mov_b32 v25, 0
    v_mov_b32 v26, 0
    v_mov_b32 v27, 0
    v_mov_b32 v28, 0
    v_mov_b32 v29, 0
    v_mov_b32 v30, 0
    v_mov_b32 v31, 0
    v_mov_b32 v32, 0
    v_mov_b32 v33, 0
    v_mov_b32 v34, 0
    v_mov_b32 v35, 0
    v_mov_b32 v36, 0
    v_mov_b32 v37, 0
    v_mov_b32 v38, 0
    v_mov_b32 v39, 0
    v_mov_b32 v40, 0
    v_mov_b32 v41, 0
    v_mov_b32 v42, 0
    v_mov_b32 v43, 0
    v_mov_b32 v44, 0
    v_mov_b32 v45, 0
    v_mov_b32 v46, 0
    v_mov_b32 v47, 0
    v_mov_b32 v48, 0
    v_mov_b32 v49, 0
    v_mov_b32 v50, 0
    v_mov_b32 v51, 0
    v_mov_b32 v52, 0
    v_mov_b32 v53, 0
    v_mov_b32 v54, 0
    v_mov_b32 v55, 0
    v_mov_b32 v56, 0
    v_mov_b32 v57, 0
    v_mov_b32 v58, 0
    v_mov_b32 v59, 0
    v_mov_b32 v60, 0
    v_mov_b32 v61, 0
    v_mov_b32 v62, 0
    v_mov_b32 v63, 0
    v_mov_b32 v64, 0
    v_mov_b32 v65, 0
    v_mov_b32 v66, 0
    v_mov_b32 v67, 0
    v_mov_b32 v68, 0
    v_mov_b32 v69, 0
    v_mov_b32 v70, 0
    v_mov_b32 v71, 0
    v_mov_b32 v72, 0
    v_mov_b32 v73, 0
    v_mov_b32 v74, 0
    v_mov_b32 v75, 0
    v_mov_b32 v76, 0
    v_mov_b32 v77, 0
    v_mov_b32 v78, 0
    v_mov_b32 v79, 0
    v_mov_b32 v80, 0
    v_mov_b32 v81, 0
    v_mov_b32 v82, 0
    v_mov_b32 v83, 0
    v_mov_b32 v84, 0
    v_mov_b32 v85, 0
    v_mov_b32 v86, 0
    v_mov_b32 v87, 0
    v_mov_b32 v88, 0
    s_waitcnt lgkmcnt(0)
    s_pack_ll_b32_b16 s12, s60, s62
    s_pack_ll_b32_b16 s16, s64, s66
    s_pack_hh_b32_b16 s13, s60, s62
    s_pack_hh_b32_b16 s17, s64, s66
    s_pack_ll_b32_b16 s14, s61, s63
    s_pack_ll_b32_b16 s18, s65, s67
    s_pack_hh_b32_b16 s15, s61, s63
    s_pack_hh_b32_b16 s19, s65, s67
    s_lshl_b32 s92, s68, 16
    s_and_b32 s93, s68, 0xffff0000
    s_lshl_b32 s94, s69, 16
    s_and_b32 s95, s69, 0xffff0000
    s_lshl_b32 s96, s70, 16
    s_and_b32 s97, s70, 0xffff0000
    s_lshl_b32 s98, s71, 16
    s_and_b32 s99, s71, 0xffff0000
    s_lshl_b32 s74, s72, 16
    s_and_b32 s75, s72, 0xffff0000
    v_mov_b32 v112, s74
    v_mov_b32 v113, s75
    v_mul_f32 v112, 0.15915494, v112
    v_mul_f32 v113, 0.15915494, v113
    s_nop 0
    v_readfirstlane_b32 s20, v112
    v_readfirstlane_b32 s21, v113
    s_mov_b32 s64, 286331153
    s_mov_b32 s65, 286331153
    s_mov_b64 exec, s[64:65]
    v_mov_b32 v122, s12
    v_mov_b32 v123, s16
    s_mov_b32 s64, 572662306
    s_mov_b32 s65, 572662306
    s_mov_b64 exec, s[64:65]
    v_mov_b32 v122, s13
    v_mov_b32 v123, s17
    s_mov_b32 s64, 1145324612
    s_mov_b32 s65, 1145324612
    s_mov_b64 exec, s[64:65]
    v_mov_b32 v122, s14
    v_mov_b32 v123, s18
    s_mov_b32 s64, 2290649224
    s_mov_b32 s65, 2290649224
    s_mov_b64 exec, s[64:65]
    v_mov_b32 v122, s15
    v_mov_b32 v123, s19
    s_mov_b64 exec, -1
    s_mov_b32 s64, 286331153
    s_mov_b32 s65, 286331153
    s_mov_b64 exec, s[64:65]
    v_mov_b32 v124, 16256
    v_mov_b32 v125, 0
    s_mov_b32 s64, 572662306
    s_mov_b32 s65, 572662306
    s_mov_b64 exec, s[64:65]
    v_mov_b32 v124, 1065353216
    v_mov_b32 v125, 0
    s_mov_b32 s64, 1145324612
    s_mov_b32 s65, 1145324612
    s_mov_b64 exec, s[64:65]
    v_mov_b32 v124, 0
    v_mov_b32 v125, 16256
    s_mov_b32 s64, 2290649224
    s_mov_b32 s65, 2290649224
    s_mov_b64 exec, s[64:65]
    v_mov_b32 v124, 0
    v_mov_b32 v125, 1065353216
    s_mov_b64 exec, -1
    s_pack_ll_b32_b16 s66, s28, s32
    s_pack_ll_b32_b16 s67, s36, s40
    s_pack_ll_b32_b16 s68, s44, s48
    s_pack_ll_b32_b16 s69, s52, s56
    s_pack_ll_b32_b16 s70, s30, s34
    s_pack_ll_b32_b16 s71, s38, s42
    s_pack_ll_b32_b16 s72, s46, s50
    s_pack_ll_b32_b16 s73, s54, s58
    s_mov_b32 s64, 286331153
    s_mov_b32 s65, 286331153
    s_mov_b64 exec, s[64:65]
    v_mov_b32 v114, s66
    v_mov_b32 v115, s67
    v_mov_b32 v116, s68
    v_mov_b32 v117, s69
    v_mov_b32 v118, s70
    v_mov_b32 v119, s71
    v_mov_b32 v120, s72
    v_mov_b32 v121, s73
    s_mov_b64 exec, -1
    s_pack_hh_b32_b16 s66, s28, s32
    s_pack_hh_b32_b16 s67, s36, s40
    s_pack_hh_b32_b16 s68, s44, s48
    s_pack_hh_b32_b16 s69, s52, s56
    s_pack_hh_b32_b16 s70, s30, s34
    s_pack_hh_b32_b16 s71, s38, s42
    s_pack_hh_b32_b16 s72, s46, s50
    s_pack_hh_b32_b16 s73, s54, s58
    s_mov_b32 s64, 572662306
    s_mov_b32 s65, 572662306
    s_mov_b64 exec, s[64:65]
    v_mov_b32 v114, s66
    v_mov_b32 v115, s67
    v_mov_b32 v116, s68
    v_mov_b32 v117, s69
    v_mov_b32 v118, s70
    v_mov_b32 v119, s71
    v_mov_b32 v120, s72
    v_mov_b32 v121, s73
    s_mov_b64 exec, -1
    s_pack_ll_b32_b16 s66, s29, s33
    s_pack_ll_b32_b16 s67, s37, s41
    s_pack_ll_b32_b16 s68, s45, s49
    s_pack_ll_b32_b16 s69, s53, s57
    s_pack_ll_b32_b16 s70, s31, s35
    s_pack_ll_b32_b16 s71, s39, s43
    s_pack_ll_b32_b16 s72, s47, s51
    s_pack_ll_b32_b16 s73, s55, s59
    s_mov_b32 s64, 1145324612
    s_mov_b32 s65, 1145324612
    s_mov_b64 exec, s[64:65]
    v_mov_b32 v114, s66
    v_mov_b32 v115, s67
    v_mov_b32 v116, s68
    v_mov_b32 v117, s69
    v_mov_b32 v118, s70
    v_mov_b32 v119, s71
    v_mov_b32 v120, s72
    v_mov_b32 v121, s73
    s_mov_b64 exec, -1
    s_pack_hh_b32_b16 s66, s29, s33
    s_pack_hh_b32_b16 s67, s37, s41
    s_pack_hh_b32_b16 s68, s45, s49
    s_pack_hh_b32_b16 s69, s53, s57
    s_pack_hh_b32_b16 s70, s31, s35
    s_pack_hh_b32_b16 s71, s39, s43
    s_pack_hh_b32_b16 s72, s47, s51
    s_pack_hh_b32_b16 s73, s55, s59
    s_mov_b32 s64, 2290649224
    s_mov_b32 s65, 2290649224
    s_mov_b64 exec, s[64:65]
    v_mov_b32 v114, s66
    v_mov_b32 v115, s67
    v_mov_b32 v116, s68
    v_mov_b32 v117, s69
    v_mov_b32 v118, s70
    v_mov_b32 v119, s71
    v_mov_b32 v120, s72
    v_mov_b32 v121, s73
    s_mov_b64 exec, -1
    s_lshr_b32 s89, s2, 3
    s_mul_i32 s89, s89, 196
    s_lshl_b32 s64, s22, 6
    s_add_u32 s89, s89, s64
    s_lshl_b32 s89, s89, 7
    s_mov_b32 s23, 0
    s_mov_b32 s81, 0
    s_cmp_lt_u32 s22, 7
    s_cbranch_scc0 gemnet_accum_kernel_nozc
    v_cmp_gt_u32 vcc, 6704, v111
    s_and_saveexec_b64 s[82:83], vcc
    ds_write_b128 v111, v[74:77] offset:0
    s_mov_b64 exec, s[82:83]
gemnet_accum_kernel_nozc:
    s_waitcnt vmcnt(0) lgkmcnt(0)
    s_barrier
    v_sub_u32_sdwa v90, v10, v6 dst_sel:DWORD dst_unused:UNUSED_PAD src0_sel:WORD_0 src1_sel:WORD_0
    v_and_b32 v91, 0xffff, v6
    v_mov_b32 v92, v90
    s_lshl_b32 s64, s22, 7
    v_lshlrev_b32 v94, 3, v1
    v_add_u32 v93, s64, v94
    v_mov_b32 v94, 0
    v_mov_b32 v95, 0
    s_mov_b64 exec, 0xffff
    ds_write_b64 v93, v[94:95] offset:6704
    s_mov_b64 exec, -1
    s_nop 1
    v_add_u32_dpp v92, v92, v92 row_shr:1 row_mask:0xf bank_mask:0xf
    s_nop 1
    v_add_u32_dpp v92, v92, v92 row_shr:2 row_mask:0xf bank_mask:0xf
    s_nop 1
    v_add_u32_dpp v92, v92, v92 row_shr:4 row_mask:0xf bank_mask:0xf
    s_nop 1
    v_add_u32_dpp v92, v92, v92 row_shr:8 row_mask:0xf bank_mask:0xf
    s_nop 1
    v_add_u32_dpp v92, v92, v92 row_bcast:15 row_mask:0xa bank_mask:0xf
    s_nop 1
    v_add_u32_dpp v92, v92, v92 row_bcast:31 row_mask:0xc bank_mask:0xf
    v_cmp_ne_u32 s[90:91], 0, v90
    s_nop 0
    v_readlane_b32 s88, v92, 63
    v_sub_u32 v92, v92, v90
    v_sub_u32 v91, v91, v92
    v_mul_i32_i24 v91, 6, v91
    v_add_u32 v91, v4, v91
    v_mbcnt_lo_u32_b32 v94, s90, 0
    v_mbcnt_hi_u32_b32 v94, s91, v94
    s_bcnt1_i32_b64 s65, s[90:91]
    v_sub_u32 v95, v1, v94
    v_add_u32 v95, s65, v95
    v_cndmask_b32 v94, v95, v94, s[90:91]
    v_lshlrev_b32 v94, 2, v94
    ds_permute_b32 v89, v94, v91
    v_cmp_ne_u32 vcc, 0, v92
    v_subrev_u32 v92, 1, v92
    s_and_b64 s[62:63], vcc, s[90:91]
    v_lshlrev_b32 v95, v92, v3
    v_lshrrev_b32 v92, 3, v92
    v_and_b32 v92, 0x7c, v92
    v_add_u32 v92, s64, v92
    s_cmp_eq_u64 s[62:63], 0
    s_cbranch_scc1 gemnet_accum_kernel_nomarkpro
    s_mov_b64 exec, s[62:63]
    ds_or_b32 v92, v95 offset:6704
    s_mov_b64 exec, -1
gemnet_accum_kernel_nomarkpro:
    ds_read_b32 v127, v93 offset:6704
    ds_read_b32 v0, v93 offset:6708
    s_add_u32 s72, s88, 63
    s_lshr_b32 s72, s72, 6
    s_sub_u32 s73, s72, 1
    s_lshr_b32 s68, s88, 6
    s_and_b32 s65, s88, 63
    s_bfm_b64 s[74:75], s65, 0
    s_cmp_eq_u32 s65, 0
    s_cselect_b64 s[74:75], -1, s[74:75]
    s_mov_b32 s24, 0
    s_waitcnt lgkmcnt(0)
    v_readlane_b32 s62, v127, 0
    v_readlane_b32 s63, v0, 0
    s_nop 1
    v_mbcnt_lo_u32_b32 v126, s62, 0
    v_mbcnt_hi_u32_b32 v126, s63, v126
    v_add_lshl_u32 v126, v126, s24, 2
    s_bcnt1_i32_b64 s65, s[62:63]
    ds_bpermute_b32 v14, v126, v89
    s_add_u32 s24, s24, s65
gemnet_accum_kernel_fapro_0:
    v_readlane_b32 s62, v127, 1
    v_readlane_b32 s63, v0, 1
    s_nop 1
    v_mbcnt_lo_u32_b32 v126, s62, 0
    v_mbcnt_hi_u32_b32 v126, s63, v126
    v_add_lshl_u32 v126, v126, s24, 2
    s_bcnt1_i32_b64 s65, s[62:63]
    ds_bpermute_b32 v16, v126, v89
    s_add_u32 s24, s24, s65
gemnet_accum_kernel_fapro_1:
    v_readlane_b32 s62, v127, 2
    v_readlane_b32 s63, v0, 2
    s_nop 1
    v_mbcnt_lo_u32_b32 v126, s62, 0
    v_mbcnt_hi_u32_b32 v126, s63, v126
    v_add_lshl_u32 v126, v126, s24, 2
    s_bcnt1_i32_b64 s65, s[62:63]
    ds_bpermute_b32 v18, v126, v89
    s_add_u32 s24, s24, s65
gemnet_accum_kernel_fapro_2:
    v_readlane_b32 s62, v127, 3
    v_readlane_b32 s63, v0, 3
    s_nop 1
    v_mbcnt_lo_u32_b32 v126, s62, 0
    v_mbcnt_hi_u32_b32 v126, s63, v126
    v_add_lshl_u32 v126, v126, s24, 2
    s_bcnt1_i32_b64 s65, s[62:63]
    ds_bpermute_b32 v20, v126, v89
    s_add_u32 s24, s24, s65
gemnet_accum_kernel_fapro_3:
    v_readlane_b32 s62, v127, 4
    v_readlane_b32 s63, v0, 4
    s_nop 1
    v_mbcnt_lo_u32_b32 v126, s62, 0
    v_mbcnt_hi_u32_b32 v126, s63, v126
    v_add_lshl_u32 v126, v126, s24, 2
    s_bcnt1_i32_b64 s65, s[62:63]
    ds_bpermute_b32 v22, v126, v89
    s_add_u32 s24, s24, s65
gemnet_accum_kernel_fapro_4:
    v_readlane_b32 s62, v127, 5
    v_readlane_b32 s63, v0, 5
    s_nop 1
    v_mbcnt_lo_u32_b32 v126, s62, 0
    v_mbcnt_hi_u32_b32 v126, s63, v126
    v_add_lshl_u32 v126, v126, s24, 2
    s_bcnt1_i32_b64 s65, s[62:63]
    ds_bpermute_b32 v24, v126, v89
    s_add_u32 s24, s24, s65
gemnet_accum_kernel_fapro_5:
    v_readlane_b32 s62, v127, 6
    v_readlane_b32 s63, v0, 6
    s_nop 1
    v_mbcnt_lo_u32_b32 v126, s62, 0
    v_mbcnt_hi_u32_b32 v126, s63, v126
    v_add_lshl_u32 v126, v126, s24, 2
    s_bcnt1_i32_b64 s65, s[62:63]
    ds_bpermute_b32 v26, v126, v89
    s_add_u32 s24, s24, s65
gemnet_accum_kernel_fapro_6:
    v_readlane_b32 s62, v127, 7
    v_readlane_b32 s63, v0, 7
    s_nop 1
    v_mbcnt_lo_u32_b32 v126, s62, 0
    v_mbcnt_hi_u32_b32 v126, s63, v126
    v_add_lshl_u32 v126, v126, s24, 2
    s_bcnt1_i32_b64 s65, s[62:63]
    ds_bpermute_b32 v28, v126, v89
    s_add_u32 s24, s24, s65
gemnet_accum_kernel_fapro_7:
    v_readlane_b32 s62, v127, 8
    v_readlane_b32 s63, v0, 8
    s_nop 1
    v_mbcnt_lo_u32_b32 v126, s62, 0
    v_mbcnt_hi_u32_b32 v126, s63, v126
    v_add_lshl_u32 v126, v126, s24, 2
    s_bcnt1_i32_b64 s65, s[62:63]
    ds_bpermute_b32 v30, v126, v89
    s_add_u32 s24, s24, s65
gemnet_accum_kernel_fapro_8:
    v_readlane_b32 s62, v127, 9
    v_readlane_b32 s63, v0, 9
    s_nop 1
    v_mbcnt_lo_u32_b32 v126, s62, 0
    v_mbcnt_hi_u32_b32 v126, s63, v126
    v_add_lshl_u32 v126, v126, s24, 2
    s_bcnt1_i32_b64 s65, s[62:63]
    ds_bpermute_b32 v32, v126, v89
    s_add_u32 s24, s24, s65
gemnet_accum_kernel_fapro_9:
    v_readlane_b32 s62, v127, 10
    v_readlane_b32 s63, v0, 10
    s_nop 1
    v_mbcnt_lo_u32_b32 v126, s62, 0
    v_mbcnt_hi_u32_b32 v126, s63, v126
    v_add_lshl_u32 v126, v126, s24, 2
    s_bcnt1_i32_b64 s65, s[62:63]
    ds_bpermute_b32 v34, v126, v89
    s_add_u32 s24, s24, s65
gemnet_accum_kernel_fapro_10:
    v_readlane_b32 s62, v127, 11
    v_readlane_b32 s63, v0, 11
    s_nop 1
    v_mbcnt_lo_u32_b32 v126, s62, 0
    v_mbcnt_hi_u32_b32 v126, s63, v126
    v_add_lshl_u32 v126, v126, s24, 2
    s_bcnt1_i32_b64 s65, s[62:63]
    ds_bpermute_b32 v36, v126, v89
    s_add_u32 s24, s24, s65
gemnet_accum_kernel_fapro_11:
    v_readlane_b32 s62, v127, 12
    v_readlane_b32 s63, v0, 12
    s_nop 1
    v_mbcnt_lo_u32_b32 v126, s62, 0
    v_mbcnt_hi_u32_b32 v126, s63, v126
    v_add_lshl_u32 v126, v126, s24, 2
    s_bcnt1_i32_b64 s65, s[62:63]
    ds_bpermute_b32 v38, v126, v89
    s_add_u32 s24, s24, s65
gemnet_accum_kernel_fapro_12:
    s_cmp_gt_u32 s72, 13
    s_cbranch_scc0 gemnet_accum_kernel_fapro_13
    v_readlane_b32 s62, v127, 13
    v_readlane_b32 s63, v0, 13
    s_nop 1
    v_mbcnt_lo_u32_b32 v126, s62, 0
    v_mbcnt_hi_u32_b32 v126, s63, v126
    v_add_lshl_u32 v126, v126, s24, 2
    s_bcnt1_i32_b64 s65, s[62:63]
    ds_bpermute_b32 v40, v126, v89
    s_add_u32 s24, s24, s65
gemnet_accum_kernel_fapro_13:
    s_cmp_gt_u32 s72, 14
    s_cbranch_scc0 gemnet_accum_kernel_fapro_14
    v_readlane_b32 s62, v127, 14
    v_readlane_b32 s63, v0, 14
    s_nop 1
    v_mbcnt_lo_u32_b32 v126, s62, 0
    v_mbcnt_hi_u32_b32 v126, s63, v126
    v_add_lshl_u32 v126, v126, s24, 2
    s_bcnt1_i32_b64 s65, s[62:63]
    ds_bpermute_b32 v42, v126, v89
    s_add_u32 s24, s24, s65
gemnet_accum_kernel_fapro_14:
    s_waitcnt lgkmcnt(0)
    s_cmp_gt_u32 s72, 0
    s_cbranch_scc0 gemnet_accum_kernel_fbpro_0
    s_movk_i32 s25, 0
    v_add3_u32 v15, v14, v2, s25
    v_and_b32 v14, -4, v15
    v_cmp_ne_u32 s[28:29], v14, v15
    s_cmp_eq_u32 s73, 0
    s_cselect_b64 exec, s[74:75], -1
    buffer_load_dwordx2 v[14:15], v14, s[8:11], 0 offen
    s_mov_b64 exec, -1
gemnet_accum_kernel_fbpro_0:
    s_cmp_gt_u32 s72, 1
    s_cbranch_scc0 gemnet_accum_kernel_fbpro_1
    s_movk_i32 s25, 384
    v_add3_u32 v17, v16, v2, s25
    v_and_b32 v16, -4, v17
    v_cmp_ne_u32 s[30:31], v16, v17
    s_cmp_eq_u32 s73, 1
    s_cselect_b64 exec, s[74:75], -1
    buffer_load_dwordx2 v[16:17], v16, s[8:11], 0 offen
    s_mov_b64 exec, -1
gemnet_accum_kernel_fbpro_1:
    s_cmp_gt_u32 s72, 2
    s_cbranch_scc0 gemnet_accum_kernel_fbpro_2
    s_movk_i32 s25, 768
    v_add3_u32 v19, v18, v2, s25
    v_and_b32 v18, -4, v19
    v_cmp_ne_u32 s[32:33], v18, v19
    s_cmp_eq_u32 s73, 2
    s_cselect_b64 exec, s[74:75], -1
    buffer_load_dwordx2 v[18:19], v18, s[8:11], 0 offen
    s_mov_b64 exec, -1
gemnet_accum_kernel_fbpro_2:
    s_cmp_gt_u32 s72, 3
    s_cbranch_scc0 gemnet_accum_kernel_fbpro_3
    s_movk_i32 s25, 1152
    v_add3_u32 v21, v20, v2, s25
    v_and_b32 v20, -4, v21
    v_cmp_ne_u32 s[34:35], v20, v21
    s_cmp_eq_u32 s73, 3
    s_cselect_b64 exec, s[74:75], -1
    buffer_load_dwordx2 v[20:21], v20, s[8:11], 0 offen
    s_mov_b64 exec, -1
gemnet_accum_kernel_fbpro_3:
    s_cmp_gt_u32 s72, 4
    s_cbranch_scc0 gemnet_accum_kernel_fbpro_4
    s_movk_i32 s25, 1536
    v_add3_u32 v23, v22, v2, s25
    v_and_b32 v22, -4, v23
    v_cmp_ne_u32 s[36:37], v22, v23
    s_cmp_eq_u32 s73, 4
    s_cselect_b64 exec, s[74:75], -1
    buffer_load_dwordx2 v[22:23], v22, s[8:11], 0 offen
    s_mov_b64 exec, -1
gemnet_accum_kernel_fbpro_4:
    s_cmp_gt_u32 s72, 5
    s_cbranch_scc0 gemnet_accum_kernel_fbpro_5
    s_movk_i32 s25, 1920
    v_add3_u32 v25, v24, v2, s25
    v_and_b32 v24, -4, v25
    v_cmp_ne_u32 s[38:39], v24, v25
    s_cmp_eq_u32 s73, 5
    s_cselect_b64 exec, s[74:75], -1
    buffer_load_dwordx2 v[24:25], v24, s[8:11], 0 offen
    s_mov_b64 exec, -1
gemnet_accum_kernel_fbpro_5:
    s_cmp_gt_u32 s72, 6
    s_cbranch_scc0 gemnet_accum_kernel_fbpro_6
    s_movk_i32 s25, 2304
    v_add3_u32 v27, v26, v2, s25
    v_and_b32 v26, -4, v27
    v_cmp_ne_u32 s[40:41], v26, v27
    s_cmp_eq_u32 s73, 6
    s_cselect_b64 exec, s[74:75], -1
    buffer_load_dwordx2 v[26:27], v26, s[8:11], 0 offen
    s_mov_b64 exec, -1
gemnet_accum_kernel_fbpro_6:
    s_cmp_gt_u32 s72, 7
    s_cbranch_scc0 gemnet_accum_kernel_fbpro_7
    s_movk_i32 s25, 2688
    v_add3_u32 v29, v28, v2, s25
    v_and_b32 v28, -4, v29
    v_cmp_ne_u32 s[42:43], v28, v29
    s_cmp_eq_u32 s73, 7
    s_cselect_b64 exec, s[74:75], -1
    buffer_load_dwordx2 v[28:29], v28, s[8:11], 0 offen
    s_mov_b64 exec, -1
gemnet_accum_kernel_fbpro_7:
    s_cmp_gt_u32 s72, 8
    s_cbranch_scc0 gemnet_accum_kernel_fbpro_8
    s_movk_i32 s25, 3072
    v_add3_u32 v31, v30, v2, s25
    v_and_b32 v30, -4, v31
    v_cmp_ne_u32 s[44:45], v30, v31
    s_cmp_eq_u32 s73, 8
    s_cselect_b64 exec, s[74:75], -1
    buffer_load_dwordx2 v[30:31], v30, s[8:11], 0 offen
    s_mov_b64 exec, -1
gemnet_accum_kernel_fbpro_8:
    s_cmp_gt_u32 s72, 9
    s_cbranch_scc0 gemnet_accum_kernel_fbpro_9
    s_movk_i32 s25, 3456
    v_add3_u32 v33, v32, v2, s25
    v_and_b32 v32, -4, v33
    v_cmp_ne_u32 s[46:47], v32, v33
    s_cmp_eq_u32 s73, 9
    s_cselect_b64 exec, s[74:75], -1
    buffer_load_dwordx2 v[32:33], v32, s[8:11], 0 offen
    s_mov_b64 exec, -1
gemnet_accum_kernel_fbpro_9:
    s_cmp_gt_u32 s72, 10
    s_cbranch_scc0 gemnet_accum_kernel_fbpro_10
    s_movk_i32 s25, 3840
    v_add3_u32 v35, v34, v2, s25
    v_and_b32 v34, -4, v35
    v_cmp_ne_u32 s[48:49], v34, v35
    s_cmp_eq_u32 s73, 10
    s_cselect_b64 exec, s[74:75], -1
    buffer_load_dwordx2 v[34:35], v34, s[8:11], 0 offen
    s_mov_b64 exec, -1
gemnet_accum_kernel_fbpro_10:
    s_cmp_gt_u32 s72, 11
    s_cbranch_scc0 gemnet_accum_kernel_fbpro_11
    s_movk_i32 s25, 4224
    v_add3_u32 v37, v36, v2, s25
    v_and_b32 v36, -4, v37
    v_cmp_ne_u32 s[50:51], v36, v37
    s_cmp_eq_u32 s73, 11
    s_cselect_b64 exec, s[74:75], -1
    buffer_load_dwordx2 v[36:37], v36, s[8:11], 0 offen
    s_mov_b64 exec, -1
gemnet_accum_kernel_fbpro_11:
    s_cmp_gt_u32 s72, 12
    s_cbranch_scc0 gemnet_accum_kernel_fbpro_12
    s_movk_i32 s25, 4608
    v_add3_u32 v39, v38, v2, s25
    v_and_b32 v38, -4, v39
    v_cmp_ne_u32 s[52:53], v38, v39
    s_cmp_eq_u32 s73, 12
    s_cselect_b64 exec, s[74:75], -1
    buffer_load_dwordx2 v[38:39], v38, s[8:11], 0 offen
    s_mov_b64 exec, -1
gemnet_accum_kernel_fbpro_12:
    s_cmp_gt_u32 s72, 13
    s_cbranch_scc0 gemnet_accum_kernel_fbpro_13
    s_movk_i32 s25, 4992
    v_add3_u32 v41, v40, v2, s25
    v_and_b32 v40, -4, v41
    v_cmp_ne_u32 s[54:55], v40, v41
    s_cmp_eq_u32 s73, 13
    s_cselect_b64 exec, s[74:75], -1
    buffer_load_dwordx2 v[40:41], v40, s[8:11], 0 offen
    s_mov_b64 exec, -1
gemnet_accum_kernel_fbpro_13:
    s_cmp_gt_u32 s72, 14
    s_cbranch_scc0 gemnet_accum_kernel_fbpro_14
    s_movk_i32 s25, 5376
    v_add3_u32 v43, v42, v2, s25
    v_and_b32 v42, -4, v43
    v_cmp_ne_u32 s[56:57], v42, v43
    s_cmp_eq_u32 s73, 14
    s_cselect_b64 exec, s[74:75], -1
    buffer_load_dwordx2 v[42:43], v42, s[8:11], 0 offen
    s_mov_b64 exec, -1
gemnet_accum_kernel_fbpro_14:
    v_lshlrev_b32 v106, 16, v106
    v_subrev_f32 v44, s92, v106
    v_subrev_f32 v45, s93, v106
    v_subrev_f32 v46, s94, v106
    v_subrev_f32 v47, s95, v106
    v_subrev_f32 v48, s96, v106
    v_subrev_f32 v49, s97, v106
    v_subrev_f32 v50, s98, v106
    v_subrev_f32 v51, s99, v106
    v_mul_f32 v44, v44, v44
    v_mul_f32 v45, v45, v45
    v_mul_f32 v46, v46, v46
    v_mul_f32 v47, v47, v47
    v_mul_f32 v48, v48, v48
    v_mul_f32 v49, v49, v49
    v_mul_f32 v50, v50, v50
    v_mul_f32 v51, v51, v51
    v_mul_f32 v44, 0xc166d4ca, v44
    v_mul_f32 v45, 0xc166d4ca, v45
    v_mul_f32 v46, 0xc166d4ca, v46
    v_mul_f32 v47, 0xc166d4ca, v47
    v_mul_f32 v48, 0xc166d4ca, v48
    v_mul_f32 v49, 0xc166d4ca, v49
    v_mul_f32 v50, 0xc166d4ca, v50
    v_mul_f32 v51, 0xc166d4ca, v51
    v_exp_f32 v44, v44
    v_exp_f32 v45, v45
    v_exp_f32 v46, v46
    v_exp_f32 v47, v47
    v_exp_f32 v48, v48
    v_exp_f32 v49, v49
    v_exp_f32 v50, v50
    v_exp_f32 v51, v51
    s_nop 0
    v_cvt_pk_bf16_f32 v52, v44, v45
    v_cvt_pk_bf16_f32 v53, v46, v47
    v_cvt_pk_bf16_f32 v54, v48, v49
    v_cvt_pk_bf16_f32 v55, v50, v51
    s_nop 1
    v_mfma_f32_4x4x4_16b_bf16 v[56:59], v[114:115], v[52:53], 0
    v_mfma_f32_4x4x4_16b_bf16 v[60:63], v[118:119], v[52:53], 0
    s_nop 1
    v_mfma_f32_4x4x4_16b_bf16 v[56:59], v[116:117], v[54:55], v[56:59]
    v_mfma_f32_4x4x4_16b_bf16 v[60:63], v[120:121], v[54:55], v[60:63]
    v_lshrrev_b32 v69, 1, v111
    v_mov_b32 v68, v111
    s_nop 3
    v_cvt_pk_bf16_f32 v64, v56, v60
    v_cvt_pk_bf16_f32 v65, v57, v61
    v_cvt_pk_bf16_f32 v66, v58, v62
    v_cvt_pk_bf16_f32 v67, v59, v63
    ds_write_b128 v68, v[64:67] offset:33760
    ds_write_b64 v69, v[74:75] offset:8752
    v_lshlrev_b32 v107, 16, v107
    v_subrev_f32 v44, s92, v107
    v_subrev_f32 v45, s93, v107
    v_subrev_f32 v46, s94, v107
    v_subrev_f32 v47, s95, v107
    v_subrev_f32 v48, s96, v107
    v_subrev_f32 v49, s97, v107
    v_subrev_f32 v50, s98, v107
    v_subrev_f32 v51, s99, v107
    v_mul_f32 v44, v44, v44
    v_mul_f32 v45, v45, v45
    v_mul_f32 v46, v46, v46
    v_mul_f32 v47, v47, v47
    v_mul_f32 v48, v48, v48
    v_mul_f32 v49, v49, v49
    v_mul_f32 v50, v50, v50
    v_mul_f32 v51, v51, v51
    v_mul_f32 v44, 0xc166d4ca, v44
    v_mul_f32 v45, 0xc166d4ca, v45
    v_mul_f32 v46, 0xc166d4ca, v46
    v_mul_f32 v47, 0xc166d4ca, v47
    v_mul_f32 v48, 0xc166d4ca, v48
    v_mul_f32 v49, 0xc166d4ca, v49
    v_mul_f32 v50, 0xc166d4ca, v50
    v_mul_f32 v51, 0xc166d4ca, v51
    v_exp_f32 v44, v44
    v_exp_f32 v45, v45
    v_exp_f32 v46, v46
    v_exp_f32 v47, v47
    v_exp_f32 v48, v48
    v_exp_f32 v49, v49
    v_exp_f32 v50, v50
    v_exp_f32 v51, v51
    s_nop 0
    v_cvt_pk_bf16_f32 v52, v44, v45
    v_cvt_pk_bf16_f32 v53, v46, v47
    v_cvt_pk_bf16_f32 v54, v48, v49
    v_cvt_pk_bf16_f32 v55, v50, v51
    s_nop 1
    v_mfma_f32_4x4x4_16b_bf16 v[56:59], v[114:115], v[52:53], 0
    v_mfma_f32_4x4x4_16b_bf16 v[60:63], v[118:119], v[52:53], 0
    s_nop 1
    v_mfma_f32_4x4x4_16b_bf16 v[56:59], v[116:117], v[54:55], v[56:59]
    v_mfma_f32_4x4x4_16b_bf16 v[60:63], v[120:121], v[54:55], v[60:63]
    v_lshrrev_b32 v69, 1, v111
    v_add_u32 v68, 16384, v111
    s_nop 3
    v_cvt_pk_bf16_f32 v64, v56, v60
    v_cvt_pk_bf16_f32 v65, v57, v61
    v_cvt_pk_bf16_f32 v66, v58, v62
    v_cvt_pk_bf16_f32 v67, v59, v63
    ds_write_b128 v68, v[64:67] offset:33760
    ds_write_b64 v69, v[74:75] offset:16944
    v_lshlrev_b32 v108, 16, v108
    v_subrev_f32 v44, s92, v108
    v_subrev_f32 v45, s93, v108
    v_subrev_f32 v46, s94, v108
    v_subrev_f32 v47, s95, v108
    v_subrev_f32 v48, s96, v108
    v_subrev_f32 v49, s97, v108
    v_subrev_f32 v50, s98, v108
    v_subrev_f32 v51, s99, v108
    v_mul_f32 v44, v44, v44
    v_mul_f32 v45, v45, v45
    v_mul_f32 v46, v46, v46
    v_mul_f32 v47, v47, v47
    v_mul_f32 v48, v48, v48
    v_mul_f32 v49, v49, v49
    v_mul_f32 v50, v50, v50
    v_mul_f32 v51, v51, v51
    v_mul_f32 v44, 0xc166d4ca, v44
    v_mul_f32 v45, 0xc166d4ca, v45
    v_mul_f32 v46, 0xc166d4ca, v46
    v_mul_f32 v47, 0xc166d4ca, v47
    v_mul_f32 v48, 0xc166d4ca, v48
    v_mul_f32 v49, 0xc166d4ca, v49
    v_mul_f32 v50, 0xc166d4ca, v50
    v_mul_f32 v51, 0xc166d4ca, v51
    v_exp_f32 v44, v44
    v_exp_f32 v45, v45
    v_exp_f32 v46, v46
    v_exp_f32 v47, v47
    v_exp_f32 v48, v48
    v_exp_f32 v49, v49
    v_exp_f32 v50, v50
    v_exp_f32 v51, v51
    s_nop 0
    v_cvt_pk_bf16_f32 v52, v44, v45
    v_cvt_pk_bf16_f32 v53, v46, v47
    v_cvt_pk_bf16_f32 v54, v48, v49
    v_cvt_pk_bf16_f32 v55, v50, v51
    s_nop 1
    v_mfma_f32_4x4x4_16b_bf16 v[56:59], v[114:115], v[52:53], 0
    v_mfma_f32_4x4x4_16b_bf16 v[60:63], v[118:119], v[52:53], 0
    s_nop 1
    v_mfma_f32_4x4x4_16b_bf16 v[56:59], v[116:117], v[54:55], v[56:59]
    v_mfma_f32_4x4x4_16b_bf16 v[60:63], v[120:121], v[54:55], v[60:63]
    v_lshrrev_b32 v69, 1, v111
    v_add_u32 v68, 32768, v111
    s_nop 3
    v_cvt_pk_bf16_f32 v64, v56, v60
    v_cvt_pk_bf16_f32 v65, v57, v61
    v_cvt_pk_bf16_f32 v66, v58, v62
    v_cvt_pk_bf16_f32 v67, v59, v63
    ds_write_b128 v68, v[64:67] offset:33760
    ds_write_b64 v69, v[74:75] offset:25136
    s_cmp_eq_u32 s22, 0
    s_cbranch_scc0 gemnet_accum_kernel_noa3
    v_cmp_gt_u32 vcc, 848, v111
    s_and_saveexec_b64 s[82:83], vcc
    v_lshlrev_b32 v109, 16, v109
    v_subrev_f32 v44, s92, v109
    v_subrev_f32 v45, s93, v109
    v_subrev_f32 v46, s94, v109
    v_subrev_f32 v47, s95, v109
    v_subrev_f32 v48, s96, v109
    v_subrev_f32 v49, s97, v109
    v_subrev_f32 v50, s98, v109
    v_subrev_f32 v51, s99, v109
    v_mul_f32 v44, v44, v44
    v_mul_f32 v45, v45, v45
    v_mul_f32 v46, v46, v46
    v_mul_f32 v47, v47, v47
    v_mul_f32 v48, v48, v48
    v_mul_f32 v49, v49, v49
    v_mul_f32 v50, v50, v50
    v_mul_f32 v51, v51, v51
    v_mul_f32 v44, 0xc166d4ca, v44
    v_mul_f32 v45, 0xc166d4ca, v45
    v_mul_f32 v46, 0xc166d4ca, v46
    v_mul_f32 v47, 0xc166d4ca, v47
    v_mul_f32 v48, 0xc166d4ca, v48
    v_mul_f32 v49, 0xc166d4ca, v49
    v_mul_f32 v50, 0xc166d4ca, v50
    v_mul_f32 v51, 0xc166d4ca, v51
    v_exp_f32 v44, v44
    v_exp_f32 v45, v45
    v_exp_f32 v46, v46
    v_exp_f32 v47, v47
    v_exp_f32 v48, v48
    v_exp_f32 v49, v49
    v_exp_f32 v50, v50
    v_exp_f32 v51, v51
    s_nop 0
    v_cvt_pk_bf16_f32 v52, v44, v45
    v_cvt_pk_bf16_f32 v53, v46, v47
    v_cvt_pk_bf16_f32 v54, v48, v49
    v_cvt_pk_bf16_f32 v55, v50, v51
    s_nop 1
    v_mfma_f32_4x4x4_16b_bf16 v[56:59], v[114:115], v[52:53], 0
    v_mfma_f32_4x4x4_16b_bf16 v[60:63], v[118:119], v[52:53], 0
    s_nop 1
    v_mfma_f32_4x4x4_16b_bf16 v[56:59], v[116:117], v[54:55], v[56:59]
    v_mfma_f32_4x4x4_16b_bf16 v[60:63], v[120:121], v[54:55], v[60:63]
    v_lshrrev_b32 v69, 1, v111
    v_add_u32 v68, 49152, v111
    s_nop 3
    v_cvt_pk_bf16_f32 v64, v56, v60
    v_cvt_pk_bf16_f32 v65, v57, v61
    v_cvt_pk_bf16_f32 v66, v58, v62
    v_cvt_pk_bf16_f32 v67, v59, v63
    ds_write_b128 v68, v[64:67] offset:33760
    ds_write_b64 v69, v[74:75] offset:33328
    s_mov_b64 exec, s[82:83]
gemnet_accum_kernel_noa3:
    s_load_dwordx2 s[92:93], s[0:1], 24
    s_load_dwordx2 s[94:95], s[0:1], 40
    s_load_dwordx4 s[96:99], s[0:1], 80
    s_load_dwordx2 s[100:101], s[0:1], 56
    v_sub_u32_sdwa v90, v10, v6 dst_sel:DWORD dst_unused:UNUSED_PAD src0_sel:WORD_1 src1_sel:WORD_1
    v_lshrrev_b32 v91, 16, v6
    v_mov_b32 v92, v90
    s_lshl_b32 s64, s22, 7
    v_lshlrev_b32 v94, 3, v1
    v_add_u32 v93, s64, v94
    v_mov_b32 v94, 0
    v_mov_b32 v95, 0
    s_mov_b64 exec, 0xffff
    ds_write_b64 v93, v[94:95] offset:6704
    s_mov_b64 exec, -1
    s_nop 1
    v_add_u32_dpp v92, v92, v92 row_shr:1 row_mask:0xf bank_mask:0xf
    s_nop 1
    v_add_u32_dpp v92, v92, v92 row_shr:2 row_mask:0xf bank_mask:0xf
    s_nop 1
    v_add_u32_dpp v92, v92, v92 row_shr:4 row_mask:0xf bank_mask:0xf
    s_nop 1
    v_add_u32_dpp v92, v92, v92 row_shr:8 row_mask:0xf bank_mask:0xf
    s_nop 1
    v_add_u32_dpp v92, v92, v92 row_bcast:15 row_mask:0xa bank_mask:0xf
    s_nop 1
    v_add_u32_dpp v92, v92, v92 row_bcast:31 row_mask:0xc bank_mask:0xf
    v_cmp_ne_u32 s[90:91], 0, v90
    s_nop 0
    v_readlane_b32 s88, v92, 63
    v_sub_u32 v92, v92, v90
    v_sub_u32 v91, v91, v92
    v_mul_i32_i24 v91, 6, v91
    v_add_u32 v91, v4, v91
    v_mbcnt_lo_u32_b32 v94, s90, 0
    v_mbcnt_hi_u32_b32 v94, s91, v94
    s_bcnt1_i32_b64 s65, s[90:91]
    v_sub_u32 v95, v1, v94
    v_add_u32 v95, s65, v95
    v_cndmask_b32 v94, v95, v94, s[90:91]
    v_lshlrev_b32 v94, 2, v94
    ds_permute_b32 v89, v94, v91
    v_cmp_ne_u32 vcc, 0, v92
    v_subrev_u32 v92, 1, v92
    s_and_b64 s[62:63], vcc, s[90:91]
    v_lshlrev_b32 v95, v92, v3
    v_lshrrev_b32 v92, 3, v92
    v_and_b32 v92, 0x7c, v92
    v_add_u32 v92, s64, v92
    s_cmp_eq_u64 s[62:63], 0
    s_cbranch_scc1 gemnet_accum_kernel_nomarkpr2
    s_mov_b64 exec, s[62:63]
    ds_or_b32 v92, v95 offset:6704
    s_mov_b64 exec, -1
gemnet_accum_kernel_nomarkpr2:
    ds_read_b32 v127, v93 offset:6704
    ds_read_b32 v0, v93 offset:6708
    s_add_u32 s76, s88, 63
    s_lshr_b32 s76, s76, 6
    s_sub_u32 s77, s76, 1
    s_lshr_b32 s69, s88, 6
    s_and_b32 s65, s88, 63
    s_bfm_b64 s[78:79], s65, 0
    s_cmp_eq_u32 s65, 0
    s_cselect_b64 s[78:79], -1, s[78:79]
    s_mov_b32 s24, 0
    v_sub_u32_sdwa v106, v10, v6 dst_sel:DWORD dst_unused:UNUSED_PAD src0_sel:WORD_0 src1_sel:WORD_0
    v_sub_u32_sdwa v107, v10, v6 dst_sel:DWORD dst_unused:UNUSED_PAD src0_sel:WORD_1 src1_sel:WORD_1
    v_sub_u32_sdwa v108, v11, v7 dst_sel:DWORD dst_unused:UNUSED_PAD src0_sel:WORD_0 src1_sel:WORD_0
    v_sub_u32_sdwa v109, v11, v7 dst_sel:DWORD dst_unused:UNUSED_PAD src0_sel:WORD_1 src1_sel:WORD_1
    v_sub_u32_sdwa v110, v12, v8 dst_sel:DWORD dst_unused:UNUSED_PAD src0_sel:WORD_0 src1_sel:WORD_0
    v_sub_u32_sdwa v111, v12, v8 dst_sel:DWORD dst_unused:UNUSED_PAD src0_sel:WORD_1 src1_sel:WORD_1
    v_sub_u32_sdwa v112, v13, v9 dst_sel:DWORD dst_unused:UNUSED_PAD src0_sel:WORD_0 src1_sel:WORD_0
    v_sub_u32_sdwa v113, v13, v9 dst_sel:DWORD dst_unused:UNUSED_PAD src0_sel:WORD_1 src1_sel:WORD_1
    s_nop 1
    v_add_u32_dpp v106, v106, v106 row_shr:1 row_mask:0xf bank_mask:0xf
    v_add_u32_dpp v107, v107, v107 row_shr:1 row_mask:0xf bank_mask:0xf
    v_add_u32_dpp v108, v108, v108 row_shr:1 row_mask:0xf bank_mask:0xf
    v_add_u32_dpp v109, v109, v109 row_shr:1 row_mask:0xf bank_mask:0xf
    v_add_u32_dpp v110, v110, v110 row_shr:1 row_mask:0xf bank_mask:0xf
    v_add_u32_dpp v111, v111, v111 row_shr:1 row_mask:0xf bank_mask:0xf
    v_add_u32_dpp v112, v112, v112 row_shr:1 row_mask:0xf bank_mask:0xf
    v_add_u32_dpp v113, v113, v113 row_shr:1 row_mask:0xf bank_mask:0xf
    s_nop 1
    v_add_u32_dpp v106, v106, v106 row_shr:2 row_mask:0xf bank_mask:0xf
    v_add_u32_dpp v107, v107, v107 row_shr:2 row_mask:0xf bank_mask:0xf
    v_add_u32_dpp v108, v108, v108 row_shr:2 row_mask:0xf bank_mask:0xf
    v_add_u32_dpp v109, v109, v109 row_shr:2 row_mask:0xf bank_mask:0xf
    v_add_u32_dpp v110, v110, v110 row_shr:2 row_mask:0xf bank_mask:0xf
    v_add_u32_dpp v111, v111, v111 row_shr:2 row_mask:0xf bank_mask:0xf
    v_add_u32_dpp v112, v112, v112 row_shr:2 row_mask:0xf bank_mask:0xf
    v_add_u32_dpp v113, v113, v113 row_shr:2 row_mask:0xf bank_mask:0xf
    s_nop 1
    v_add_u32_dpp v106, v106, v106 row_shr:4 row_mask:0xf bank_mask:0xf
    v_add_u32_dpp v107, v107, v107 row_shr:4 row_mask:0xf bank_mask:0xf
    v_add_u32_dpp v108, v108, v108 row_shr:4 row_mask:0xf bank_mask:0xf
    v_add_u32_dpp v109, v109, v109 row_shr:4 row_mask:0xf bank_mask:0xf
    v_add_u32_dpp v110, v110, v110 row_shr:4 row_mask:0xf bank_mask:0xf
    v_add_u32_dpp v111, v111, v111 row_shr:4 row_mask:0xf bank_mask:0xf
    v_add_u32_dpp v112, v112, v112 row_shr:4 row_mask:0xf bank_mask:0xf
    v_add_u32_dpp v113, v113, v113 row_shr:4 row_mask:0xf bank_mask:0xf
    s_nop 1
    v_add_u32_dpp v106, v106, v106 row_shr:8 row_mask:0xf bank_mask:0xf
    v_add_u32_dpp v107, v107, v107 row_shr:8 row_mask:0xf bank_mask:0xf
    v_add_u32_dpp v108, v108, v108 row_shr:8 row_mask:0xf bank_mask:0xf
    v_add_u32_dpp v109, v109, v109 row_shr:8 row_mask:0xf bank_mask:0xf
    v_add_u32_dpp v110, v110, v110 row_shr:8 row_mask:0xf bank_mask:0xf
    v_add_u32_dpp v111, v111, v111 row_shr:8 row_mask:0xf bank_mask:0xf
    v_add_u32_dpp v112, v112, v112 row_shr:8 row_mask:0xf bank_mask:0xf
    v_add_u32_dpp v113, v113, v113 row_shr:8 row_mask:0xf bank_mask:0xf
    s_nop 1
    v_add_u32_dpp v106, v106, v106 row_bcast:15 row_mask:0xa bank_mask:0xf
    v_add_u32_dpp v107, v107, v107 row_bcast:15 row_mask:0xa bank_mask:0xf
    v_add_u32_dpp v108, v108, v108 row_bcast:15 row_mask:0xa bank_mask:0xf
    v_add_u32_dpp v109, v109, v109 row_bcast:15 row_mask:0xa bank_mask:0xf
    v_add_u32_dpp v110, v110, v110 row_bcast:15 row_mask:0xa bank_mask:0xf
    v_add_u32_dpp v111, v111, v111 row_bcast:15 row_mask:0xa bank_mask:0xf
    v_add_u32_dpp v112, v112, v112 row_bcast:15 row_mask:0xa bank_mask:0xf
    v_add_u32_dpp v113, v113, v113 row_bcast:15 row_mask:0xa bank_mask:0xf
    s_nop 1
    v_add_u32_dpp v106, v106, v106 row_bcast:31 row_mask:0xc bank_mask:0xf
    v_add_u32_dpp v107, v107, v107 row_bcast:31 row_mask:0xc bank_mask:0xf
    v_add_u32_dpp v108, v108, v108 row_bcast:31 row_mask:0xc bank_mask:0xf
    v_add_u32_dpp v109, v109, v109 row_bcast:31 row_mask:0xc bank_mask:0xf
    v_add_u32_dpp v110, v110, v110 row_bcast:31 row_mask:0xc bank_mask:0xf
    v_add_u32_dpp v111, v111, v111 row_bcast:31 row_mask:0xc bank_mask:0xf
    v_add_u32_dpp v112, v112, v112 row_bcast:31 row_mask:0xc bank_mask:0xf
    v_add_u32_dpp v113, v113, v113 row_bcast:31 row_mask:0xc bank_mask:0xf
    s_mov_b32 s60, 0
    s_mov_b32 s61, 0x80000000
    s_mov_b64 exec, s[60:61]
    v_mov_b32 v114, 0
    ds_add_u32 v114, v106 offset:6660
    ds_add_u32 v114, v107 offset:6664
    ds_add_u32 v114, v108 offset:6668
    ds_add_u32 v114, v109 offset:6672
    ds_add_u32 v114, v110 offset:6676
    ds_add_u32 v114, v111 offset:6680
    ds_add_u32 v114, v112 offset:6684
    ds_add_u32 v114, v113 offset:6688
    v_max_u32 v115, v106, v107
    v_max_u32 v115, v115, v108
    v_max_u32 v115, v115, v109
    v_max_u32 v115, v115, v110
    v_max_u32 v115, v115, v111
    v_max_u32 v115, v115, v112
    v_max_u32 v115, v115, v113
    ds_max_u32 v114, v115 offset:6692
    s_mov_b64 exec, -1
    s_waitcnt lgkmcnt(0)
    v_readlane_b32 s62, v127, 0
    v_readlane_b32 s63, v0, 0
    s_nop 1
    v_mbcnt_lo_u32_b32 v126, s62, 0
    v_mbcnt_hi_u32_b32 v126, s63, v126
    v_add_lshl_u32 v126, v126, s24, 2
    s_bcnt1_i32_b64 s65, s[62:63]
    ds_bpermute_b32 v44, v126, v89
    s_add_u32 s24, s24, s65
gemnet_accum_kernel_fapr2_0:
    v_readlane_b32 s62, v127, 1
    v_readlane_b32 s63, v0, 1
    s_nop 1
    v_mbcnt_lo_u32_b32 v126, s62, 0
    v_mbcnt_hi_u32_b32 v126, s63, v126
    v_add_lshl_u32 v126, v126, s24, 2
    s_bcnt1_i32_b64 s65, s[62:63]
    ds_bpermute_b32 v46, v126, v89
    s_add_u32 s24, s24, s65
gemnet_accum_kernel_fapr2_1:
    v_readlane_b32 s62, v127, 2
    v_readlane_b32 s63, v0, 2
    s_nop 1
    v_mbcnt_lo_u32_b32 v126, s62, 0
    v_mbcnt_hi_u32_b32 v126, s63, v126
    v_add_lshl_u32 v126, v126, s24, 2
    s_bcnt1_i32_b64 s65, s[62:63]
    ds_bpermute_b32 v48, v126, v89
    s_add_u32 s24, s24, s65
gemnet_accum_kernel_fapr2_2:
    v_readlane_b32 s62, v127, 3
    v_readlane_b32 s63, v0, 3
    s_nop 1
    v_mbcnt_lo_u32_b32 v126, s62, 0
    v_mbcnt_hi_u32_b32 v126, s63, v126
    v_add_lshl_u32 v126, v126, s24, 2
    s_bcnt1_i32_b64 s65, s[62:63]
    ds_bpermute_b32 v50, v126, v89
    s_add_u32 s24, s24, s65
gemnet_accum_kernel_fapr2_3:
    v_readlane_b32 s62, v127, 4
    v_readlane_b32 s63, v0, 4
    s_nop 1
    v_mbcnt_lo_u32_b32 v126, s62, 0
    v_mbcnt_hi_u32_b32 v126, s63, v126
    v_add_lshl_u32 v126, v126, s24, 2
    s_bcnt1_i32_b64 s65, s[62:63]
    ds_bpermute_b32 v52, v126, v89
    s_add_u32 s24, s24, s65
gemnet_accum_kernel_fapr2_4:
    v_readlane_b32 s62, v127, 5
    v_readlane_b32 s63, v0, 5
    s_nop 1
    v_mbcnt_lo_u32_b32 v126, s62, 0
    v_mbcnt_hi_u32_b32 v126, s63, v126
    v_add_lshl_u32 v126, v126, s24, 2
    s_bcnt1_i32_b64 s65, s[62:63]
    ds_bpermute_b32 v54, v126, v89
    s_add_u32 s24, s24, s65
gemnet_accum_kernel_fapr2_5:
    v_readlane_b32 s62, v127, 6
    v_readlane_b32 s63, v0, 6
    s_nop 1
    v_mbcnt_lo_u32_b32 v126, s62, 0
    v_mbcnt_hi_u32_b32 v126, s63, v126
    v_add_lshl_u32 v126, v126, s24, 2
    s_bcnt1_i32_b64 s65, s[62:63]
    ds_bpermute_b32 v56, v126, v89
    s_add_u32 s24, s24, s65
gemnet_accum_kernel_fapr2_6:
    v_readlane_b32 s62, v127, 7
    v_readlane_b32 s63, v0, 7
    s_nop 1
    v_mbcnt_lo_u32_b32 v126, s62, 0
    v_mbcnt_hi_u32_b32 v126, s63, v126
    v_add_lshl_u32 v126, v126, s24, 2
    s_bcnt1_i32_b64 s65, s[62:63]
    ds_bpermute_b32 v58, v126, v89
    s_add_u32 s24, s24, s65
gemnet_accum_kernel_fapr2_7:
    v_readlane_b32 s62, v127, 8
    v_readlane_b32 s63, v0, 8
    s_nop 1
    v_mbcnt_lo_u32_b32 v126, s62, 0
    v_mbcnt_hi_u32_b32 v126, s63, v126
    v_add_lshl_u32 v126, v126, s24, 2
    s_bcnt1_i32_b64 s65, s[62:63]
    ds_bpermute_b32 v60, v126, v89
    s_add_u32 s24, s24, s65
gemnet_accum_kernel_fapr2_8:
    v_readlane_b32 s62, v127, 9
    v_readlane_b32 s63, v0, 9
    s_nop 1
    v_mbcnt_lo_u32_b32 v126, s62, 0
    v_mbcnt_hi_u32_b32 v126, s63, v126
    v_add_lshl_u32 v126, v126, s24, 2
    s_bcnt1_i32_b64 s65, s[62:63]
    ds_bpermute_b32 v62, v126, v89
    s_add_u32 s24, s24, s65
gemnet_accum_kernel_fapr2_9:
    v_readlane_b32 s62, v127, 10
    v_readlane_b32 s63, v0, 10
    s_nop 1
    v_mbcnt_lo_u32_b32 v126, s62, 0
    v_mbcnt_hi_u32_b32 v126, s63, v126
    v_add_lshl_u32 v126, v126, s24, 2
    s_bcnt1_i32_b64 s65, s[62:63]
    ds_bpermute_b32 v64, v126, v89
    s_add_u32 s24, s24, s65
gemnet_accum_kernel_fapr2_10:
    v_readlane_b32 s62, v127, 11
    v_readlane_b32 s63, v0, 11
    s_nop 1
    v_mbcnt_lo_u32_b32 v126, s62, 0
    v_mbcnt_hi_u32_b32 v126, s63, v126
    v_add_lshl_u32 v126, v126, s24, 2
    s_bcnt1_i32_b64 s65, s[62:63]
    ds_bpermute_b32 v66, v126, v89
    s_add_u32 s24, s24, s65
gemnet_accum_kernel_fapr2_11:
    v_readlane_b32 s62, v127, 12
    v_readlane_b32 s63, v0, 12
    s_nop 1
    v_mbcnt_lo_u32_b32 v126, s62, 0
    v_mbcnt_hi_u32_b32 v126, s63, v126
    v_add_lshl_u32 v126, v126, s24, 2
    s_bcnt1_i32_b64 s65, s[62:63]
    ds_bpermute_b32 v68, v126, v89
    s_add_u32 s24, s24, s65
gemnet_accum_kernel_fapr2_12:
    s_cmp_gt_u32 s76, 13
    s_cbranch_scc0 gemnet_accum_kernel_fapr2_13
    v_readlane_b32 s62, v127, 13
    v_readlane_b32 s63, v0, 13
    s_nop 1
    v_mbcnt_lo_u32_b32 v126, s62, 0
    v_mbcnt_hi_u32_b32 v126, s63, v126
    v_add_lshl_u32 v126, v126, s24, 2
    s_bcnt1_i32_b64 s65, s[62:63]
    ds_bpermute_b32 v70, v126, v89
    s_add_u32 s24, s24, s65
gemnet_accum_kernel_fapr2_13:
    s_cmp_gt_u32 s76, 14
    s_cbranch_scc0 gemnet_accum_kernel_fapr2_14
    v_readlane_b32 s62, v127, 14
    v_readlane_b32 s63, v0, 14
    s_nop 1
    v_mbcnt_lo_u32_b32 v126, s62, 0
    v_mbcnt_hi_u32_b32 v126, s63, v126
    v_add_lshl_u32 v126, v126, s24, 2
    s_bcnt1_i32_b64 s65, s[62:63]
    ds_bpermute_b32 v72, v126, v89
    s_add_u32 s24, s24, s65
gemnet_accum_kernel_fapr2_14:
    s_waitcnt vmcnt(0) lgkmcnt(0)
    v_lshrrev_b32 v126, 16, v14
    v_cndmask_b32 v14, v14, v15, s[28:29]
    v_cndmask_b32 v15, v15, v126, s[28:29]
    v_lshrrev_b32 v126, 16, v16
    v_cndmask_b32 v16, v16, v17, s[30:31]
    v_cndmask_b32 v17, v17, v126, s[30:31]
    v_lshrrev_b32 v126, 16, v18
    v_cndmask_b32 v18, v18, v19, s[32:33]
    v_cndmask_b32 v19, v19, v126, s[32:33]
    v_lshrrev_b32 v126, 16, v20
    v_cndmask_b32 v20, v20, v21, s[34:35]
    v_cndmask_b32 v21, v21, v126, s[34:35]
    v_lshrrev_b32 v126, 16, v22
    v_cndmask_b32 v22, v22, v23, s[36:37]
    v_cndmask_b32 v23, v23, v126, s[36:37]
    v_lshrrev_b32 v126, 16, v24
    v_cndmask_b32 v24, v24, v25, s[38:39]
    v_cndmask_b32 v25, v25, v126, s[38:39]
    v_lshrrev_b32 v126, 16, v26
    v_cndmask_b32 v26, v26, v27, s[40:41]
    v_cndmask_b32 v27, v27, v126, s[40:41]
    v_lshrrev_b32 v126, 16, v28
    v_cndmask_b32 v28, v28, v29, s[42:43]
    v_cndmask_b32 v29, v29, v126, s[42:43]
    v_lshrrev_b32 v126, 16, v30
    v_cndmask_b32 v30, v30, v31, s[44:45]
    v_cndmask_b32 v31, v31, v126, s[44:45]
    v_lshrrev_b32 v126, 16, v32
    v_cndmask_b32 v32, v32, v33, s[46:47]
    v_cndmask_b32 v33, v33, v126, s[46:47]
    v_lshrrev_b32 v126, 16, v34
    v_cndmask_b32 v34, v34, v35, s[48:49]
    v_cndmask_b32 v35, v35, v126, s[48:49]
    v_lshrrev_b32 v126, 16, v36
    v_cndmask_b32 v36, v36, v37, s[50:51]
    v_cndmask_b32 v37, v37, v126, s[50:51]
    v_lshrrev_b32 v126, 16, v38
    v_cndmask_b32 v38, v38, v39, s[52:53]
    v_cndmask_b32 v39, v39, v126, s[52:53]
    s_cmp_gt_u32 s72, 13
    s_cbranch_scc0 gemnet_accum_kernel_decp
    v_lshrrev_b32 v126, 16, v40
    v_cndmask_b32 v40, v40, v41, s[54:55]
    v_cndmask_b32 v41, v41, v126, s[54:55]
    s_cmp_gt_u32 s72, 14
    s_cbranch_scc0 gemnet_accum_kernel_decp
    v_lshrrev_b32 v126, 16, v42
    v_cndmask_b32 v42, v42, v43, s[56:57]
    v_cndmask_b32 v43, v43, v126, s[56:57]
gemnet_accum_kernel_decp:
    s_cmp_gt_u32 s72, 0
    s_cbranch_scc0 gemnet_accum_kernel_hgp_0
    s_cmp_eq_u32 s73, 0
    s_cselect_b64 exec, s[74:75], -1
    v_lshrrev_b32 v126, 8, v14
    v_and_b32 v126, 4092, v126
    ds_add_rtn_u32 v74, v126, v3 offset:0
    s_mov_b64 exec, -1
gemnet_accum_kernel_hgp_0:
    s_cmp_gt_u32 s72, 1
    s_cbranch_scc0 gemnet_accum_kernel_hgp_1
    s_cmp_eq_u32 s73, 1
    s_cselect_b64 exec, s[74:75], -1
    v_lshrrev_b32 v126, 8, v16
    v_and_b32 v126, 4092, v126
    ds_add_rtn_u32 v75, v126, v3 offset:0
    s_mov_b64 exec, -1
gemnet_accum_kernel_hgp_1:
    s_cmp_gt_u32 s72, 2
    s_cbranch_scc0 gemnet_accum_kernel_hgp_2
    s_cmp_eq_u32 s73, 2
    s_cselect_b64 exec, s[74:75], -1
    v_lshrrev_b32 v126, 8, v18
    v_and_b32 v126, 4092, v126
    ds_add_rtn_u32 v76, v126, v3 offset:0
    s_mov_b64 exec, -1
gemnet_accum_kernel_hgp_2:
    s_cmp_gt_u32 s72, 3
    s_cbranch_scc0 gemnet_accum_kernel_hgp_3
    s_cmp_eq_u32 s73, 3
    s_cselect_b64 exec, s[74:75], -1
    v_lshrrev_b32 v126, 8, v20
    v_and_b32 v126, 4092, v126
    ds_add_rtn_u32 v77, v126, v3 offset:0
    s_mov_b64 exec, -1
gemnet_accum_kernel_hgp_3:
    s_cmp_gt_u32 s72, 4
    s_cbranch_scc0 gemnet_accum_kernel_hgp_4
    s_cmp_eq_u32 s73, 4
    s_cselect_b64 exec, s[74:75], -1
    v_lshrrev_b32 v126, 8, v22
    v_and_b32 v126, 4092, v126
    ds_add_rtn_u32 v78, v126, v3 offset:0
    s_mov_b64 exec, -1
gemnet_accum_kernel_hgp_4:
    s_cmp_gt_u32 s72, 5
    s_cbranch_scc0 gemnet_accum_kernel_hgp_5
    s_cmp_eq_u32 s73, 5
    s_cselect_b64 exec, s[74:75], -1
    v_lshrrev_b32 v126, 8, v24
    v_and_b32 v126, 4092, v126
    ds_add_rtn_u32 v79, v126, v3 offset:0
    s_mov_b64 exec, -1
gemnet_accum_kernel_hgp_5:
    s_cmp_gt_u32 s72, 6
    s_cbranch_scc0 gemnet_accum_kernel_hgp_6
    s_cmp_eq_u32 s73, 6
    s_cselect_b64 exec, s[74:75], -1
    v_lshrrev_b32 v126, 8, v26
    v_and_b32 v126, 4092, v126
    ds_add_rtn_u32 v80, v126, v3 offset:0
    s_mov_b64 exec, -1
gemnet_accum_kernel_hgp_6:
    s_cmp_gt_u32 s72, 7
    s_cbranch_scc0 gemnet_accum_kernel_hgp_7
    s_cmp_eq_u32 s73, 7
    s_cselect_b64 exec, s[74:75], -1
    v_lshrrev_b32 v126, 8, v28
    v_and_b32 v126, 4092, v126
    ds_add_rtn_u32 v81, v126, v3 offset:0
    s_mov_b64 exec, -1
gemnet_accum_kernel_hgp_7:
    s_cmp_gt_u32 s72, 8
    s_cbranch_scc0 gemnet_accum_kernel_hgp_8
    s_cmp_eq_u32 s73, 8
    s_cselect_b64 exec, s[74:75], -1
    v_lshrrev_b32 v126, 8, v30
    v_and_b32 v126, 4092, v126
    ds_add_rtn_u32 v82, v126, v3 offset:0
    s_mov_b64 exec, -1
gemnet_accum_kernel_hgp_8:
    s_cmp_gt_u32 s72, 9
    s_cbranch_scc0 gemnet_accum_kernel_hgp_9
    s_cmp_eq_u32 s73, 9
    s_cselect_b64 exec, s[74:75], -1
    v_lshrrev_b32 v126, 8, v32
    v_and_b32 v126, 4092, v126
    ds_add_rtn_u32 v83, v126, v3 offset:0
    s_mov_b64 exec, -1
gemnet_accum_kernel_hgp_9:
    s_cmp_gt_u32 s72, 10
    s_cbranch_scc0 gemnet_accum_kernel_hgp_10
    s_cmp_eq_u32 s73, 10
    s_cselect_b64 exec, s[74:75], -1
    v_lshrrev_b32 v126, 8, v34
    v_and_b32 v126, 4092, v126
    ds_add_rtn_u32 v84, v126, v3 offset:0
    s_mov_b64 exec, -1
gemnet_accum_kernel_hgp_10:
    s_cmp_gt_u32 s72, 11
    s_cbranch_scc0 gemnet_accum_kernel_hgp_11
    s_cmp_eq_u32 s73, 11
    s_cselect_b64 exec, s[74:75], -1
    v_lshrrev_b32 v126, 8, v36
    v_and_b32 v126, 4092, v126
    ds_add_rtn_u32 v85, v126, v3 offset:0
    s_mov_b64 exec, -1
gemnet_accum_kernel_hgp_11:
    s_cmp_gt_u32 s72, 12
    s_cbranch_scc0 gemnet_accum_kernel_hgp_12
    s_cmp_eq_u32 s73, 12
    s_cselect_b64 exec, s[74:75], -1
    v_lshrrev_b32 v126, 8, v38
    v_and_b32 v126, 4092, v126
    ds_add_rtn_u32 v86, v126, v3 offset:0
    s_mov_b64 exec, -1
gemnet_accum_kernel_hgp_12:
    s_cmp_gt_u32 s72, 13
    s_cbranch_scc0 gemnet_accum_kernel_hgp_13
    s_cmp_eq_u32 s73, 13
    s_cselect_b64 exec, s[74:75], -1
    v_lshrrev_b32 v126, 8, v40
    v_and_b32 v126, 4092, v126
    ds_add_rtn_u32 v87, v126, v3 offset:0
    s_mov_b64 exec, -1
gemnet_accum_kernel_hgp_13:
    s_cmp_gt_u32 s72, 14
    s_cbranch_scc0 gemnet_accum_kernel_hgp_14
    s_cmp_eq_u32 s73, 14
    s_cselect_b64 exec, s[74:75], -1
    v_lshrrev_b32 v126, 8, v42
    v_and_b32 v126, 4092, v126
    ds_add_rtn_u32 v88, v126, v3 offset:0
    s_mov_b64 exec, -1
gemnet_accum_kernel_hgp_14:
    s_movk_i32 s25, 0
    v_add3_u32 v45, v44, v2, s25
    v_and_b32 v44, -4, v45
    v_cmp_ne_u32 s[28:29], v44, v45
gemnet_accum_kernel_fbpr2_0:
    s_movk_i32 s25, 384
    v_add3_u32 v47, v46, v2, s25
    v_and_b32 v46, -4, v47
    v_cmp_ne_u32 s[30:31], v46, v47
gemnet_accum_kernel_fbpr2_1:
    s_movk_i32 s25, 768
    v_add3_u32 v49, v48, v2, s25
    v_and_b32 v48, -4, v49
    v_cmp_ne_u32 s[32:33], v48, v49
gemnet_accum_kernel_fbpr2_2:
    s_movk_i32 s25, 1152
    v_add3_u32 v51, v50, v2, s25
    v_and_b32 v50, -4, v51
    v_cmp_ne_u32 s[34:35], v50, v51
gemnet_accum_kernel_fbpr2_3:
    s_movk_i32 s25, 1536
    v_add3_u32 v53, v52, v2, s25
    v_and_b32 v52, -4, v53
    v_cmp_ne_u32 s[36:37], v52, v53
gemnet_accum_kernel_fbpr2_4:
    s_movk_i32 s25, 1920
    v_add3_u32 v55, v54, v2, s25
    v_and_b32 v54, -4, v55
    v_cmp_ne_u32 s[38:39], v54, v55
gemnet_accum_kernel_fbpr2_5:
    s_movk_i32 s25, 2304
    v_add3_u32 v57, v56, v2, s25
    v_and_b32 v56, -4, v57
    v_cmp_ne_u32 s[40:41], v56, v57
gemnet_accum_kernel_fbpr2_6:
    s_movk_i32 s25, 2688
    v_add3_u32 v59, v58, v2, s25
    v_and_b32 v58, -4, v59
    v_cmp_ne_u32 s[42:43], v58, v59
gemnet_accum_kernel_fbpr2_7:
    s_movk_i32 s25, 3072
    v_add3_u32 v61, v60, v2, s25
    v_and_b32 v60, -4, v61
    v_cmp_ne_u32 s[44:45], v60, v61
gemnet_accum_kernel_fbpr2_8:
    s_movk_i32 s25, 3456
    v_add3_u32 v63, v62, v2, s25
    v_and_b32 v62, -4, v63
    v_cmp_ne_u32 s[46:47], v62, v63
gemnet_accum_kernel_fbpr2_9:
    s_movk_i32 s25, 3840
    v_add3_u32 v65, v64, v2, s25
    v_and_b32 v64, -4, v65
    v_cmp_ne_u32 s[48:49], v64, v65
gemnet_accum_kernel_fbpr2_10:
    s_movk_i32 s25, 4224
    v_add3_u32 v67, v66, v2, s25
    v_and_b32 v66, -4, v67
    v_cmp_ne_u32 s[50:51], v66, v67
gemnet_accum_kernel_fbpr2_11:
    s_movk_i32 s25, 4608
    v_add3_u32 v69, v68, v2, s25
    v_and_b32 v68, -4, v69
    v_cmp_ne_u32 s[52:53], v68, v69
gemnet_accum_kernel_fbpr2_12:
    s_cmp_gt_u32 s76, 13
    s_cbranch_scc0 gemnet_accum_kernel_fbpr2_13
    s_movk_i32 s25, 4992
    v_add3_u32 v71, v70, v2, s25
    v_and_b32 v70, -4, v71
    v_cmp_ne_u32 s[54:55], v70, v71
gemnet_accum_kernel_fbpr2_13:
    s_cmp_gt_u32 s76, 14
    s_cbranch_scc0 gemnet_accum_kernel_fbpr2_14
    s_movk_i32 s25, 5376
    v_add3_u32 v73, v72, v2, s25
    v_and_b32 v72, -4, v73
    v_cmp_ne_u32 s[56:57], v72, v73
gemnet_accum_kernel_fbpr2_14:
    s_waitcnt vmcnt(0)
    s_cmp_lt_u32 s22, 4
    s_cbranch_scc0 gemnet_accum_kernel_nopfp
    v_lshlrev_b32 v5, 7, v1
    s_add_u32 s64, s23, s89
    buffer_load_dword v5, v5, s[4:7], s64 offen
gemnet_accum_kernel_nopfp:
    s_cmp_gt_u32 s76, 0
    s_cbranch_scc0 gemnet_accum_kernel_hnp_0
    s_cmp_eq_u32 s77, 0
    s_cselect_b64 exec, s[78:79], -1
    buffer_load_dwordx2 v[44:45], v44, s[8:11], 0 offen
    s_mov_b64 exec, -1
gemnet_accum_kernel_hnp_0:
    s_waitcnt lgkmcnt(0)
    s_barrier
    s_cmp_eq_u32 s22, 0
    s_cbranch_scc1 gemnet_accum_kernel_doscanp
    s_cmp_gt_u32 s76, 1
    s_cbranch_scc0 gemnet_accum_kernel_hmpo_1
    s_cmp_eq_u32 s77, 1
    s_cselect_b64 exec, s[78:79], -1
    buffer_load_dwordx2 v[46:47], v46, s[8:11], 0 offen
    s_mov_b64 exec, -1
gemnet_accum_kernel_hmpo_1:
    s_cmp_gt_u32 s76, 2
    s_cbranch_scc0 gemnet_accum_kernel_hmpo_2
    s_cmp_eq_u32 s77, 2
    s_cselect_b64 exec, s[78:79], -1
    buffer_load_dwordx2 v[48:49], v48, s[8:11], 0 offen
    s_mov_b64 exec, -1
gemnet_accum_kernel_hmpo_2:
    s_cmp_gt_u32 s76, 3
    s_cbranch_scc0 gemnet_accum_kernel_hmpo_3
    s_cmp_eq_u32 s77, 3
    s_cselect_b64 exec, s[78:79], -1
    buffer_load_dwordx2 v[50:51], v50, s[8:11], 0 offen
    s_mov_b64 exec, -1
gemnet_accum_kernel_hmpo_3:
    s_branch gemnet_accum_kernel_noscanp
gemnet_accum_kernel_doscanp:
    v_mul_u32_u24 v114, 52, v1
    ds_read_b32 v98, v114 offset:0
    ds_read_b32 v99, v114 offset:4
    ds_read_b32 v100, v114 offset:8
    ds_read_b32 v101, v114 offset:12
    ds_read_b32 v102, v114 offset:16
    ds_read_b32 v103, v114 offset:20
    ds_read_b32 v104, v114 offset:24
    ds_read_b32 v105, v114 offset:28
    ds_read_b32 v106, v114 offset:32
    ds_read_b32 v107, v114 offset:36
    ds_read_b32 v108, v114 offset:40
    ds_read_b32 v109, v114 offset:44
    ds_read_b32 v110, v114 offset:48
    s_waitcnt lgkmcnt(0)
    v_add_u32 v115, v98, v99
    v_add_u32 v115, v115, v100
    v_add_u32 v115, v115, v101
    v_add_u32 v115, v115, v102
    v_add_u32 v115, v115, v103
    v_add_u32 v115, v115, v104
    v_add_u32 v115, v115, v105
    v_add_u32 v115, v115, v106
    v_add_u32 v115, v115, v107
    v_add_u32 v115, v115, v108
    v_add_u32 v115, v115, v109
    v_add_u32 v115, v115, v110
    v_mov_b32 v116, v115
    s_nop 1
    v_add_u32_dpp v116, v116, v116 row_shr:1 row_mask:0xf bank_mask:0xf
    s_nop 1
    v_add_u32_dpp v116, v116, v116 row_shr:2 row_mask:0xf bank_mask:0xf
    s_nop 1
    v_add_u32_dpp v116, v116, v116 row_shr:4 row_mask:0xf bank_mask:0xf
    s_nop 1
    v_add_u32_dpp v116, v116, v116 row_shr:8 row_mask:0xf bank_mask:0xf
    s_nop 1
    v_add_u32_dpp v116, v116, v116 row_bcast:15 row_mask:0xa bank_mask:0xf
    s_nop 1
    v_add_u32_dpp v116, v116, v116 row_bcast:31 row_mask:0xc bank_mask:0xf
    s_mov_b32 s62, 0
    s_mov_b32 s63, 0x80000000
    s_mov_b64 exec, s[62:63]
    v_mov_b32 v90, 0
    ds_write_b32 v90, v116 offset:6656
    s_mov_b64 exec, -1
    v_sub_u32 v116, v116, v115
    v_add_u32 v116, 27596, v116
    ds_write_b32 v114, v116 offset:0
    v_add_u32 v116, v116, v98
    ds_write_b32 v114, v116 offset:4
    v_add_u32 v116, v116, v99
    ds_write_b32 v114, v116 offset:8
    v_add_u32 v116, v116, v100
    ds_write_b32 v114, v116 offset:12
    v_add_u32 v116, v116, v101
    ds_write_b32 v114, v116 offset:16
    v_add_u32 v116, v116, v102
    ds_write_b32 v114, v116 offset:20
    v_add_u32 v116, v116, v103
    ds_write_b32 v114, v116 offset:24
    v_add_u32 v116, v116, v104
    ds_write_b32 v114, v116 offset:28
    v_add_u32 v116, v116, v105
    ds_write_b32 v114, v116 offset:32
    v_add_u32 v116, v116, v106
    ds_write_b32 v114, v116 offset:36
    v_add_u32 v116, v116, v107
    ds_write_b32 v114, v116 offset:40
    v_add_u32 v116, v116, v108
    ds_write_b32 v114, v116 offset:44
    v_add_u32 v116, v116, v109
    ds_write_b32 v114, v116 offset:48
    s_cmp_gt_u32 s76, 1
    s_cbranch_scc0 gemnet_accum_kernel_hmps_1
    s_cmp_eq_u32 s77, 1
    s_cselect_b64 exec, s[78:79], -1
    buffer_load_dwordx2 v[46:47], v46, s[8:11], 0 offen
    s_mov_b64 exec, -1
gemnet_accum_kernel_hmps_1:
    s_cmp_gt_u32 s76, 2
    s_cbranch_scc0 gemnet_accum_kernel_hmps_2
    s_cmp_eq_u32 s77, 2
    s_cselect_b64 exec, s[78:79], -1
    buffer_load_dwordx2 v[48:49], v48, s[8:11], 0 offen
    s_mov_b64 exec, -1
gemnet_accum_kernel_hmps_2:
    s_cmp_gt_u32 s76, 3
    s_cbranch_scc0 gemnet_accum_kernel_hmps_3
    s_cmp_eq_u32 s77, 3
    s_cselect_b64 exec, s[78:79], -1
    buffer_load_dwordx2 v[50:51], v50, s[8:11], 0 offen
    s_mov_b64 exec, -1
gemnet_accum_kernel_hmps_3:
    s_waitcnt lgkmcnt(0)
gemnet_accum_kernel_noscanp:
    s_barrier
    v_mov_b32 v90, 0
    ds_read_b32 v91, v90 offset:6656
    s_min_u32 s64, s68, s69
    s_cmp_ge_u32 s64, 11
    s_cbranch_scc0 gemnet_accum_kernel_scgp
    v_lshrrev_b32 v98, 8, v14
    v_and_b32 v98, 4092, v98
    ds_read_b32 v98, v98 offset:0
    v_lshrrev_b32 v99, 8, v16
    v_and_b32 v99, 4092, v99
    ds_read_b32 v99, v99 offset:0
    v_lshrrev_b32 v100, 8, v18
    v_and_b32 v100, 4092, v100
    ds_read_b32 v100, v100 offset:0
    v_lshrrev_b32 v101, 8, v20
    v_and_b32 v101, 4092, v101
    ds_read_b32 v101, v101 offset:0
    v_lshrrev_b32 v102, 8, v22
    v_and_b32 v102, 4092, v102
    ds_read_b32 v102, v102 offset:0
    v_lshrrev_b32 v103, 8, v24
    v_and_b32 v103, 4092, v103
    ds_read_b32 v103, v103 offset:0
    v_lshrrev_b32 v104, 8, v26
    v_and_b32 v104, 4092, v104
    ds_read_b32 v104, v104 offset:0
    v_lshrrev_b32 v105, 8, v28
    v_and_b32 v105, 4092, v105
    ds_read_b32 v105, v105 offset:0
    v_lshrrev_b32 v106, 8, v30
    v_and_b32 v106, 4092, v106
    ds_read_b32 v106, v106 offset:0
    v_lshrrev_b32 v107, 8, v32
    v_and_b32 v107, 4092, v107
    ds_read_b32 v107, v107 offset:0
    v_lshrrev_b32 v108, 8, v34
    v_and_b32 v108, 4092, v108
    ds_read_b32 v108, v108 offset:0
    s_cmp_gt_u32 s72, 11
    s_cbranch_scc0 gemnet_accum_kernel_sapf
    s_cmp_eq_u32 s73, 11
    s_cselect_b64 exec, s[74:75], -1
    v_lshrrev_b32 v109, 8, v36
    v_and_b32 v109, 4092, v109
    ds_read_b32 v109, v109 offset:0
    s_cmp_gt_u32 s72, 12
    s_cbranch_scc0 gemnet_accum_kernel_sapf
    s_cmp_eq_u32 s73, 12
    s_cselect_b64 exec, s[74:75], -1
    v_lshrrev_b32 v110, 8, v38
    v_and_b32 v110, 4092, v110
    ds_read_b32 v110, v110 offset:0
    s_cmp_gt_u32 s72, 13
    s_cbranch_scc0 gemnet_accum_kernel_sapf
    s_cmp_eq_u32 s73, 13
    s_cselect_b64 exec, s[74:75], -1
    v_lshrrev_b32 v111, 8, v40
    v_and_b32 v111, 4092, v111
    ds_read_b32 v111, v111 offset:0
    s_cmp_gt_u32 s72, 14
    s_cbranch_scc0 gemnet_accum_kernel_sapf
    s_cmp_eq_u32 s73, 14
    s_cselect_b64 exec, s[74:75], -1
    v_lshrrev_b32 v112, 8, v42
    v_and_b32 v112, 4092, v112
    ds_read_b32 v112, v112 offset:0
gemnet_accum_kernel_sapf:
    s_mov_b64 exec, -1
    s_waitcnt lgkmcnt(0)
    v_readfirstlane_b32 s26, v91
    v_add_u32 v98, v98, v74
    v_lshlrev_b32 v74, 2, v98
    v_add_u32 v98, v98, v98
    ds_write_b32 v74, v14
    ds_write_b16 v98, v15 offset:28568
    v_add_u32 v99, v99, v75
    v_lshlrev_b32 v75, 2, v99
    v_add_u32 v99, v99, v99
    ds_write_b32 v75, v16
    ds_write_b16 v99, v17 offset:28568
    v_add_u32 v100, v100, v76
    v_lshlrev_b32 v76, 2, v100
    v_add_u32 v100, v100, v100
    ds_write_b32 v76, v18
    ds_write_b16 v100, v19 offset:28568
    v_add_u32 v101, v101, v77
    v_lshlrev_b32 v77, 2, v101
    v_add_u32 v101, v101, v101
    ds_write_b32 v77, v20
    ds_write_b16 v101, v21 offset:28568
    v_add_u32 v102, v102, v78
    v_lshlrev_b32 v78, 2, v102
    v_add_u32 v102, v102, v102
    ds_write_b32 v78, v22
    ds_write_b16 v102, v23 offset:28568
    buffer_load_dwordx2 v[52:53], v52, s[8:11], 0 offen
    v_add_u32 v103, v103, v79
    v_lshlrev_b32 v79, 2, v103
    v_add_u32 v103, v103, v103
    ds_write_b32 v79, v24
    ds_write_b16 v103, v25 offset:28568
    buffer_load_dwordx2 v[54:55], v54, s[8:11], 0 offen
    v_add_u32 v104, v104, v80
    v_lshlrev_b32 v80, 2, v104
    v_add_u32 v104, v104, v104
    ds_write_b32 v80, v26
    ds_write_b16 v104, v27 offset:28568
    buffer_load_dwordx2 v[56:57], v56, s[8:11], 0 offen
    v_add_u32 v105, v105, v81
    v_lshlrev_b32 v81, 2, v105
    v_add_u32 v105, v105, v105
    ds_write_b32 v81, v28
    ds_write_b16 v105, v29 offset:28568
    buffer_load_dwordx2 v[58:59], v58, s[8:11], 0 offen
    v_add_u32 v106, v106, v82
    v_lshlrev_b32 v82, 2, v106
    v_add_u32 v106, v106, v106
    ds_write_b32 v82, v30
    ds_write_b16 v106, v31 offset:28568
    buffer_load_dwordx2 v[60:61], v60, s[8:11], 0 offen
    v_add_u32 v107, v107, v83
    v_lshlrev_b32 v83, 2, v107
    v_add_u32 v107, v107, v107
    ds_write_b32 v83, v32
    ds_write_b16 v107, v33 offset:28568
    buffer_load_dwordx2 v[62:63], v62, s[8:11], 0 offen
    v_add_u32 v108, v108, v84
    v_lshlrev_b32 v84, 2, v108
    v_add_u32 v108, v108, v108
    ds_write_b32 v84, v34
    ds_write_b16 v108, v35 offset:28568
    buffer_load_dwordx2 v[64:65], v64, s[8:11], 0 offen
    s_cmp_gt_u32 s72, 11
    s_cbranch_scc0 gemnet_accum_kernel_sbpf_11
    s_cmp_eq_u32 s73, 11
    s_cselect_b64 exec, s[74:75], -1
    v_add_u32 v109, v109, v85
    v_lshlrev_b32 v85, 2, v109
    v_add_u32 v109, v109, v109
    ds_write_b32 v85, v36
    ds_write_b16 v109, v37 offset:28568
gemnet_accum_kernel_sbpf_11:
    s_cmp_gt_u32 s76, 11
    s_cbranch_scc0 gemnet_accum_kernel_snpf_11
    s_cmp_eq_u32 s77, 11
    s_cselect_b64 exec, s[78:79], -1
    buffer_load_dwordx2 v[66:67], v66, s[8:11], 0 offen
    s_mov_b64 exec, -1
gemnet_accum_kernel_snpf_11:
    s_cmp_gt_u32 s72, 12
    s_cbranch_scc0 gemnet_accum_kernel_sbpf_12
    s_cmp_eq_u32 s73, 12
    s_cselect_b64 exec, s[74:75], -1
    v_add_u32 v110, v110, v86
    v_lshlrev_b32 v86, 2, v110
    v_add_u32 v110, v110, v110
    ds_write_b32 v86, v38
    ds_write_b16 v110, v39 offset:28568
gemnet_accum_kernel_sbpf_12:
    s_cmp_gt_u32 s76, 12
    s_cbranch_scc0 gemnet_accum_kernel_snpf_12
    s_cmp_eq_u32 s77, 12
    s_cselect_b64 exec, s[78:79], -1
    buffer_load_dwordx2 v[68:69], v68, s[8:11], 0 offen
    s_mov_b64 exec, -1
gemnet_accum_kernel_snpf_12:
    s_cmp_gt_u32 s72, 13
    s_cbranch_scc0 gemnet_accum_kernel_sbpf_13
    s_cmp_eq_u32 s73, 13
    s_cselect_b64 exec, s[74:75], -1
    v_add_u32 v111, v111, v87
    v_lshlrev_b32 v87, 2, v111
    v_add_u32 v111, v111, v111
    ds_write_b32 v87, v40
    ds_write_b16 v111, v41 offset:28568
gemnet_accum_kernel_sbpf_13:
    s_cmp_gt_u32 s76, 13
    s_cbranch_scc0 gemnet_accum_kernel_snpf_13
    s_cmp_eq_u32 s77, 13
    s_cselect_b64 exec, s[78:79], -1
    buffer_load_dwordx2 v[70:71], v70, s[8:11], 0 offen
    s_mov_b64 exec, -1
gemnet_accum_kernel_snpf_13:
    s_cmp_gt_u32 s72, 14
    s_cbranch_scc0 gemnet_accum_kernel_sbpf_14
    s_cmp_eq_u32 s73, 14
    s_cselect_b64 exec, s[74:75], -1
    v_add_u32 v112, v112, v88
    v_lshlrev_b32 v88, 2, v112
    v_add_u32 v112, v112, v112
    ds_write_b32 v88, v42
    ds_write_b16 v112, v43 offset:28568
gemnet_accum_kernel_sbpf_14:
    s_cmp_gt_u32 s76, 14
    s_cbranch_scc0 gemnet_accum_kernel_snpf_14
    s_cmp_eq_u32 s77, 14
    s_cselect_b64 exec, s[78:79], -1
    buffer_load_dwordx2 v[72:73], v72, s[8:11], 0 offen
    s_mov_b64 exec, -1
gemnet_accum_kernel_snpf_14:
    s_branch gemnet_accum_kernel_scep
gemnet_accum_kernel_scgp:
    s_cmp_gt_u32 s72, 0
    s_cbranch_scc0 gemnet_accum_kernel_sapg
    s_cmp_eq_u32 s73, 0
    s_cselect_b64 exec, s[74:75], -1
    v_lshrrev_b32 v98, 8, v14
    v_and_b32 v98, 4092, v98
    ds_read_b32 v98, v98 offset:0
    s_cmp_gt_u32 s72, 1
    s_cbranch_scc0 gemnet_accum_kernel_sapg
    s_cmp_eq_u32 s73, 1
    s_cselect_b64 exec, s[74:75], -1
    v_lshrrev_b32 v99, 8, v16
    v_and_b32 v99, 4092, v99
    ds_read_b32 v99, v99 offset:0
    s_cmp_gt_u32 s72, 2
    s_cbranch_scc0 gemnet_accum_kernel_sapg
    s_cmp_eq_u32 s73, 2
    s_cselect_b64 exec, s[74:75], -1
    v_lshrrev_b32 v100, 8, v18
    v_and_b32 v100, 4092, v100
    ds_read_b32 v100, v100 offset:0
    s_cmp_gt_u32 s72, 3
    s_cbranch_scc0 gemnet_accum_kernel_sapg
    s_cmp_eq_u32 s73, 3
    s_cselect_b64 exec, s[74:75], -1
    v_lshrrev_b32 v101, 8, v20
    v_and_b32 v101, 4092, v101
    ds_read_b32 v101, v101 offset:0
    s_cmp_gt_u32 s72, 4
    s_cbranch_scc0 gemnet_accum_kernel_sapg
    s_cmp_eq_u32 s73, 4
    s_cselect_b64 exec, s[74:75], -1
    v_lshrrev_b32 v102, 8, v22
    v_and_b32 v102, 4092, v102
    ds_read_b32 v102, v102 offset:0
    s_cmp_gt_u32 s72, 5
    s_cbranch_scc0 gemnet_accum_kernel_sapg
    s_cmp_eq_u32 s73, 5
    s_cselect_b64 exec, s[74:75], -1
    v_lshrrev_b32 v103, 8, v24
    v_and_b32 v103, 4092, v103
    ds_read_b32 v103, v103 offset:0
    s_cmp_gt_u32 s72, 6
    s_cbranch_scc0 gemnet_accum_kernel_sapg
    s_cmp_eq_u32 s73, 6
    s_cselect_b64 exec, s[74:75], -1
    v_lshrrev_b32 v104, 8, v26
    v_and_b32 v104, 4092, v104
    ds_read_b32 v104, v104 offset:0
    s_cmp_gt_u32 s72, 7
    s_cbranch_scc0 gemnet_accum_kernel_sapg
    s_cmp_eq_u32 s73, 7
    s_cselect_b64 exec, s[74:75], -1
    v_lshrrev_b32 v105, 8, v28
    v_and_b32 v105, 4092, v105
    ds_read_b32 v105, v105 offset:0
    s_cmp_gt_u32 s72, 8
    s_cbranch_scc0 gemnet_accum_kernel_sapg
    s_cmp_eq_u32 s73, 8
    s_cselect_b64 exec, s[74:75], -1
    v_lshrrev_b32 v106, 8, v30
    v_and_b32 v106, 4092, v106
    ds_read_b32 v106, v106 offset:0
    s_cmp_gt_u32 s72, 9
    s_cbranch_scc0 gemnet_accum_kernel_sapg
    s_cmp_eq_u32 s73, 9
    s_cselect_b64 exec, s[74:75], -1
    v_lshrrev_b32 v107, 8, v32
    v_and_b32 v107, 4092, v107
    ds_read_b32 v107, v107 offset:0
    s_cmp_gt_u32 s72, 10
    s_cbranch_scc0 gemnet_accum_kernel_sapg
    s_cmp_eq_u32 s73, 10
    s_cselect_b64 exec, s[74:75], -1
    v_lshrrev_b32 v108, 8, v34
    v_and_b32 v108, 4092, v108
    ds_read_b32 v108, v108 offset:0
    s_cmp_gt_u32 s72, 11
    s_cbranch_scc0 gemnet_accum_kernel_sapg
    s_cmp_eq_u32 s73, 11
    s_cselect_b64 exec, s[74:75], -1
    v_lshrrev_b32 v109, 8, v36
    v_and_b32 v109, 4092, v109
    ds_read_b32 v109, v109 offset:0
    s_cmp_gt_u32 s72, 12
    s_cbranch_scc0 gemnet_accum_kernel_sapg
    s_cmp_eq_u32 s73, 12
    s_cselect_b64 exec, s[74:75], -1
    v_lshrrev_b32 v110, 8, v38
    v_and_b32 v110, 4092, v110
    ds_read_b32 v110, v110 offset:0
    s_cmp_gt_u32 s72, 13
    s_cbranch_scc0 gemnet_accum_kernel_sapg
    s_cmp_eq_u32 s73, 13
    s_cselect_b64 exec, s[74:75], -1
    v_lshrrev_b32 v111, 8, v40
    v_and_b32 v111, 4092, v111
    ds_read_b32 v111, v111 offset:0
    s_cmp_gt_u32 s72, 14
    s_cbranch_scc0 gemnet_accum_kernel_sapg
    s_cmp_eq_u32 s73, 14
    s_cselect_b64 exec, s[74:75], -1
    v_lshrrev_b32 v112, 8, v42
    v_and_b32 v112, 4092, v112
    ds_read_b32 v112, v112 offset:0
gemnet_accum_kernel_sapg:
    s_mov_b64 exec, -1
    s_waitcnt lgkmcnt(0)
    v_readfirstlane_b32 s26, v91
    s_cmp_gt_u32 s72, 0
    s_cbranch_scc0 gemnet_accum_kernel_sbpg_0
    s_cmp_eq_u32 s73, 0
    s_cselect_b64 exec, s[74:75], -1
    v_add_u32 v98, v98, v74
    v_lshlrev_b32 v74, 2, v98
    v_add_u32 v98, v98, v98
    ds_write_b32 v74, v14
    ds_write_b16 v98, v15 offset:28568
gemnet_accum_kernel_sbpg_0:
    s_cmp_gt_u32 s72, 1
    s_cbranch_scc0 gemnet_accum_kernel_sbpg_1
    s_cmp_eq_u32 s73, 1
    s_cselect_b64 exec, s[74:75], -1
    v_add_u32 v99, v99, v75
    v_lshlrev_b32 v75, 2, v99
    v_add_u32 v99, v99, v99
    ds_write_b32 v75, v16
    ds_write_b16 v99, v17 offset:28568
gemnet_accum_kernel_sbpg_1:
    s_cmp_gt_u32 s72, 2
    s_cbranch_scc0 gemnet_accum_kernel_sbpg_2
    s_cmp_eq_u32 s73, 2
    s_cselect_b64 exec, s[74:75], -1
    v_add_u32 v100, v100, v76
    v_lshlrev_b32 v76, 2, v100
    v_add_u32 v100, v100, v100
    ds_write_b32 v76, v18
    ds_write_b16 v100, v19 offset:28568
gemnet_accum_kernel_sbpg_2:
    s_cmp_gt_u32 s72, 3
    s_cbranch_scc0 gemnet_accum_kernel_sbpg_3
    s_cmp_eq_u32 s73, 3
    s_cselect_b64 exec, s[74:75], -1
    v_add_u32 v101, v101, v77
    v_lshlrev_b32 v77, 2, v101
    v_add_u32 v101, v101, v101
    ds_write_b32 v77, v20
    ds_write_b16 v101, v21 offset:28568
gemnet_accum_kernel_sbpg_3:
    s_cmp_gt_u32 s72, 4
    s_cbranch_scc0 gemnet_accum_kernel_sbpg_4
    s_cmp_eq_u32 s73, 4
    s_cselect_b64 exec, s[74:75], -1
    v_add_u32 v102, v102, v78
    v_lshlrev_b32 v78, 2, v102
    v_add_u32 v102, v102, v102
    ds_write_b32 v78, v22
    ds_write_b16 v102, v23 offset:28568
gemnet_accum_kernel_sbpg_4:
    s_cmp_gt_u32 s76, 4
    s_cbranch_scc0 gemnet_accum_kernel_snpg_4
    s_cmp_eq_u32 s77, 4
    s_cselect_b64 exec, s[78:79], -1
    buffer_load_dwordx2 v[52:53], v52, s[8:11], 0 offen
    s_mov_b64 exec, -1
gemnet_accum_kernel_snpg_4:
    s_cmp_gt_u32 s72, 5
    s_cbranch_scc0 gemnet_accum_kernel_sbpg_5
    s_cmp_eq_u32 s73, 5
    s_cselect_b64 exec, s[74:75], -1
    v_add_u32 v103, v103, v79
    v_lshlrev_b32 v79, 2, v103
    v_add_u32 v103, v103, v103
    ds_write_b32 v79, v24
    ds_write_b16 v103, v25 offset:28568
gemnet_accum_kernel_sbpg_5:
    s_cmp_gt_u32 s76, 5
    s_cbranch_scc0 gemnet_accum_kernel_snpg_5
    s_cmp_eq_u32 s77, 5
    s_cselect_b64 exec, s[78:79], -1
    buffer_load_dwordx2 v[54:55], v54, s[8:11], 0 offen
    s_mov_b64 exec, -1
gemnet_accum_kernel_snpg_5:
    s_cmp_gt_u32 s72, 6
    s_cbranch_scc0 gemnet_accum_kernel_sbpg_6
    s_cmp_eq_u32 s73, 6
    s_cselect_b64 exec, s[74:75], -1
    v_add_u32 v104, v104, v80
    v_lshlrev_b32 v80, 2, v104
    v_add_u32 v104, v104, v104
    ds_write_b32 v80, v26
    ds_write_b16 v104, v27 offset:28568
gemnet_accum_kernel_sbpg_6:
    s_cmp_gt_u32 s76, 6
    s_cbranch_scc0 gemnet_accum_kernel_snpg_6
    s_cmp_eq_u32 s77, 6
    s_cselect_b64 exec, s[78:79], -1
    buffer_load_dwordx2 v[56:57], v56, s[8:11], 0 offen
    s_mov_b64 exec, -1
gemnet_accum_kernel_snpg_6:
    s_cmp_gt_u32 s72, 7
    s_cbranch_scc0 gemnet_accum_kernel_sbpg_7
    s_cmp_eq_u32 s73, 7
    s_cselect_b64 exec, s[74:75], -1
    v_add_u32 v105, v105, v81
    v_lshlrev_b32 v81, 2, v105
    v_add_u32 v105, v105, v105
    ds_write_b32 v81, v28
    ds_write_b16 v105, v29 offset:28568
gemnet_accum_kernel_sbpg_7:
    s_cmp_gt_u32 s76, 7
    s_cbranch_scc0 gemnet_accum_kernel_snpg_7
    s_cmp_eq_u32 s77, 7
    s_cselect_b64 exec, s[78:79], -1
    buffer_load_dwordx2 v[58:59], v58, s[8:11], 0 offen
    s_mov_b64 exec, -1
gemnet_accum_kernel_snpg_7:
    s_cmp_gt_u32 s72, 8
    s_cbranch_scc0 gemnet_accum_kernel_sbpg_8
    s_cmp_eq_u32 s73, 8
    s_cselect_b64 exec, s[74:75], -1
    v_add_u32 v106, v106, v82
    v_lshlrev_b32 v82, 2, v106
    v_add_u32 v106, v106, v106
    ds_write_b32 v82, v30
    ds_write_b16 v106, v31 offset:28568
gemnet_accum_kernel_sbpg_8:
    s_cmp_gt_u32 s76, 8
    s_cbranch_scc0 gemnet_accum_kernel_snpg_8
    s_cmp_eq_u32 s77, 8
    s_cselect_b64 exec, s[78:79], -1
    buffer_load_dwordx2 v[60:61], v60, s[8:11], 0 offen
    s_mov_b64 exec, -1
gemnet_accum_kernel_snpg_8:
    s_cmp_gt_u32 s72, 9
    s_cbranch_scc0 gemnet_accum_kernel_sbpg_9
    s_cmp_eq_u32 s73, 9
    s_cselect_b64 exec, s[74:75], -1
    v_add_u32 v107, v107, v83
    v_lshlrev_b32 v83, 2, v107
    v_add_u32 v107, v107, v107
    ds_write_b32 v83, v32
    ds_write_b16 v107, v33 offset:28568
gemnet_accum_kernel_sbpg_9:
    s_cmp_gt_u32 s76, 9
    s_cbranch_scc0 gemnet_accum_kernel_snpg_9
    s_cmp_eq_u32 s77, 9
    s_cselect_b64 exec, s[78:79], -1
    buffer_load_dwordx2 v[62:63], v62, s[8:11], 0 offen
    s_mov_b64 exec, -1
gemnet_accum_kernel_snpg_9:
    s_cmp_gt_u32 s72, 10
    s_cbranch_scc0 gemnet_accum_kernel_sbpg_10
    s_cmp_eq_u32 s73, 10
    s_cselect_b64 exec, s[74:75], -1
    v_add_u32 v108, v108, v84
    v_lshlrev_b32 v84, 2, v108
    v_add_u32 v108, v108, v108
    ds_write_b32 v84, v34
    ds_write_b16 v108, v35 offset:28568
gemnet_accum_kernel_sbpg_10:
    s_cmp_gt_u32 s76, 10
    s_cbranch_scc0 gemnet_accum_kernel_snpg_10
    s_cmp_eq_u32 s77, 10
    s_cselect_b64 exec, s[78:79], -1
    buffer_load_dwordx2 v[64:65], v64, s[8:11], 0 offen
    s_mov_b64 exec, -1
gemnet_accum_kernel_snpg_10:
    s_cmp_gt_u32 s72, 11
    s_cbranch_scc0 gemnet_accum_kernel_sbpg_11
    s_cmp_eq_u32 s73, 11
    s_cselect_b64 exec, s[74:75], -1
    v_add_u32 v109, v109, v85
    v_lshlrev_b32 v85, 2, v109
    v_add_u32 v109, v109, v109
    ds_write_b32 v85, v36
    ds_write_b16 v109, v37 offset:28568
gemnet_accum_kernel_sbpg_11:
    s_cmp_gt_u32 s76, 11
    s_cbranch_scc0 gemnet_accum_kernel_snpg_11
    s_cmp_eq_u32 s77, 11
    s_cselect_b64 exec, s[78:79], -1
    buffer_load_dwordx2 v[66:67], v66, s[8:11], 0 offen
    s_mov_b64 exec, -1
gemnet_accum_kernel_snpg_11:
    s_cmp_gt_u32 s72, 12
    s_cbranch_scc0 gemnet_accum_kernel_sbpg_12
    s_cmp_eq_u32 s73, 12
    s_cselect_b64 exec, s[74:75], -1
    v_add_u32 v110, v110, v86
    v_lshlrev_b32 v86, 2, v110
    v_add_u32 v110, v110, v110
    ds_write_b32 v86, v38
    ds_write_b16 v110, v39 offset:28568
gemnet_accum_kernel_sbpg_12:
    s_cmp_gt_u32 s76, 12
    s_cbranch_scc0 gemnet_accum_kernel_snpg_12
    s_cmp_eq_u32 s77, 12
    s_cselect_b64 exec, s[78:79], -1
    buffer_load_dwordx2 v[68:69], v68, s[8:11], 0 offen
    s_mov_b64 exec, -1
gemnet_accum_kernel_snpg_12:
    s_cmp_gt_u32 s72, 13
    s_cbranch_scc0 gemnet_accum_kernel_sbpg_13
    s_cmp_eq_u32 s73, 13
    s_cselect_b64 exec, s[74:75], -1
    v_add_u32 v111, v111, v87
    v_lshlrev_b32 v87, 2, v111
    v_add_u32 v111, v111, v111
    ds_write_b32 v87, v40
    ds_write_b16 v111, v41 offset:28568
gemnet_accum_kernel_sbpg_13:
    s_cmp_gt_u32 s76, 13
    s_cbranch_scc0 gemnet_accum_kernel_snpg_13
    s_cmp_eq_u32 s77, 13
    s_cselect_b64 exec, s[78:79], -1
    buffer_load_dwordx2 v[70:71], v70, s[8:11], 0 offen
    s_mov_b64 exec, -1
gemnet_accum_kernel_snpg_13:
    s_cmp_gt_u32 s72, 14
    s_cbranch_scc0 gemnet_accum_kernel_sbpg_14
    s_cmp_eq_u32 s73, 14
    s_cselect_b64 exec, s[74:75], -1
    v_add_u32 v112, v112, v88
    v_lshlrev_b32 v88, 2, v112
    v_add_u32 v112, v112, v112
    ds_write_b32 v88, v42
    ds_write_b16 v112, v43 offset:28568
gemnet_accum_kernel_sbpg_14:
    s_cmp_gt_u32 s76, 14
    s_cbranch_scc0 gemnet_accum_kernel_snpg_14
    s_cmp_eq_u32 s77, 14
    s_cselect_b64 exec, s[78:79], -1
    buffer_load_dwordx2 v[72:73], v72, s[8:11], 0 offen
    s_mov_b64 exec, -1
gemnet_accum_kernel_snpg_14:
gemnet_accum_kernel_scep:
    s_mov_b64 exec, -1
    s_waitcnt lgkmcnt(0)
    s_barrier
    v_mov_b32 v114, 0
    ds_read_b128 v[106:109], v114 offset:6656
    ds_read_b128 v[110:113], v114 offset:6672
    ds_read_b64 v[116:117], v114 offset:6688
    s_waitcnt lgkmcnt(0)
    v_max3_u32 v107, v107, v108, v109
    v_max3_u32 v110, v110, v111, v112
    v_max3_u32 v107, v107, v110, v113
    v_max_u32 v107, v107, v116
    s_nop 0
    v_readfirstlane_b32 s60, v107
    v_readfirstlane_b32 s61, v117
    s_cmp_gt_u32 s60, 13312
    s_cbranch_scc1 gemnet_accum_kernel_slow
    s_cmp_gt_u32 s61, 960
    s_cbranch_scc1 gemnet_accum_kernel_slow
    v_mov_b32 v106, s20
    v_add_f32 v106, v106, v106
    v_cmp_eq_f32 vcc, s21, v106
    s_nop 0
    s_cmp_eq_u64 vcc, 0
    s_cbranch_scc1 gemnet_accum_kernel_slow
gemnet_accum_kernel_loop:
    s_cmp_lt_u32 s22, 13
    s_cbranch_scc0 gemnet_accum_kernel_nza
    v_mov_b32 v91, 0
    s_lshl_b32 s64, s22, 8
    v_lshlrev_b32 v90, 2, v1
    v_add_u32 v90, s64, v90
    ds_write_b32 v90, v91 offset:0
gemnet_accum_kernel_nza:
    s_mul_i32 s64, s22, 832
    v_add_u32 v90, s64, v1
    v_add_u32 v91, v90, v90
    v_lshlrev_b32 v90, 2, v90
    v_add_u32 v90, 110384, v90
    v_add_u32 v91, 83760, v91
    ds_read_b32 v74, v90 offset:0
    ds_read_b32 v75, v90 offset:256
    s_sub_i32 s65, s26, s64
    s_max_i32 s65, s65, 0
    s_min_i32 s65, s65, 832
    s_lshr_b32 s27, s65, 6
    s_and_b32 s66, s65, 63
    s_bfm_b64 s[58:59], s66, 0
    s_cmp_lg_u32 s66, 0
    s_cselect_b64 s[60:61], s[58:59], 1
    s_addc_u32 s80, s27, 0
    v_mov_b32 v22, 0
    v_mov_b32 v23, 0
    v_mov_b32 v24, 0
    v_mov_b32 v25, 0
    v_mov_b32 v26, 0
    v_mov_b32 v27, 0
    v_mov_b32 v28, 0
    v_mov_b32 v29, 0
    v_mov_b32 v30, 0
    v_mov_b32 v31, 0
    v_mov_b32 v32, 0
    v_mov_b32 v33, 0
    v_mov_b32 v34, 0
    s_waitcnt lgkmcnt(0)
    s_cmp_eq_u32 s27, 0
    s_cselect_b64 s[62:63], s[60:61], 1
    v_and_b32 v35, 0xffff8, v74
    s_cmp_gt_u32 s27, 0
    s_cselect_b64 exec, -1, s[62:63]
    buffer_load_dwordx2 v[36:37], v35, s[4:7], s23 offen
    s_mov_b64 exec, -1
    s_cmp_eq_u32 s27, 1
    s_cselect_b64 s[62:63], s[60:61], 1
    v_and_b32 v35, 0xffff8, v75
    s_cmp_gt_u32 s27, 1
    s_cselect_b64 exec, -1, s[62:63]
    buffer_load_dwordx2 v[38:39], v35, s[4:7], s23 offen
    s_mov_b64 exec, -1
    ds_read_u16_d16_hi v22, v91 offset:0
    ds_read_u16_d16_hi v23, v91 offset:128
    ds_read_b32 v76, v90 offset:512
    ds_read_u16_d16_hi v24, v91 offset:256
    ds_read_b32 v77, v90 offset:768
    ds_read_u16_d16_hi v25, v91 offset:384
    ds_read_b32 v78, v90 offset:1024
    ds_read_u16_d16_hi v26, v91 offset:512
    ds_read_b32 v79, v90 offset:1280
    ds_read_u16_d16_hi v27, v91 offset:640
    ds_read_b32 v80, v90 offset:1536
    ds_read_u16_d16_hi v28, v91 offset:768
    ds_read_b32 v81, v90 offset:1792
    ds_read_u16_d16_hi v29, v91 offset:896
    ds_read_b32 v82, v90 offset:2048
    ds_read_u16_d16_hi v30, v91 offset:1024
    ds_read_b32 v83, v90 offset:2304
    ds_read_u16_d16_hi v31, v91 offset:1152
    ds_read_b32 v84, v90 offset:2560
    ds_read_u16_d16_hi v32, v91 offset:1280
    ds_read_b32 v85, v90 offset:2816
    ds_read_u16_d16_hi v33, v91 offset:1408
    ds_read_b32 v86, v90 offset:3072
    ds_read_u16_d16_hi v34, v91 offset:1536
    s_cmp_eq_u32 s81, 3
    s_cbranch_scc1 gemnet_accum_kernel_nofla
    v_sub_u32_sdwa v106, v11, v7 dst_sel:DWORD dst_unused:UNUSED_PAD src0_sel:WORD_0 src1_sel:WORD_0
    v_and_b32 v107, 0xffff, v7
    v_mov_b32 v108, v106
    s_lshl_b32 s64, s22, 7
    v_lshlrev_b32 v110, 3, v1
    v_add_u32 v109, s64, v110
    v_mov_b32 v110, 0
    v_mov_b32 v111, 0
    s_mov_b64 exec, 0xffff
    ds_write_b64 v109, v[110:111] offset:6704
    s_mov_b64 exec, -1
    s_nop 1
    v_add_u32_dpp v108, v108, v108 row_shr:1 row_mask:0xf bank_mask:0xf
    s_nop 1
    v_add_u32_dpp v108, v108, v108 row_shr:2 row_mask:0xf bank_mask:0xf
    s_nop 1
    v_add_u32_dpp v108, v108, v108 row_shr:4 row_mask:0xf bank_mask:0xf
    s_nop 1
    v_add_u32_dpp v108, v108, v108 row_shr:8 row_mask:0xf bank_mask:0xf
    s_nop 1
    v_add_u32_dpp v108, v108, v108 row_bcast:15 row_mask:0xa bank_mask:0xf
    s_nop 1
    v_add_u32_dpp v108, v108, v108 row_bcast:31 row_mask:0xc bank_mask:0xf
    v_cmp_ne_u32 s[90:91], 0, v106
    s_nop 0
    v_readlane_b32 s88, v108, 63
    v_sub_u32 v108, v108, v106
    v_sub_u32 v107, v107, v108
    v_mul_i32_i24 v107, 6, v107
    v_add_u32 v107, v4, v107
    v_mbcnt_lo_u32_b32 v110, s90, 0
    v_mbcnt_hi_u32_b32 v110, s91, v110
    s_bcnt1_i32_b64 s65, s[90:91]
    v_sub_u32 v111, v1, v110
    v_add_u32 v111, s65, v111
    v_cndmask_b32 v110, v111, v110, s[90:91]
    v_lshlrev_b32 v110, 2, v110
    ds_permute_b32 v89, v110, v107
    v_cmp_ne_u32 vcc, 0, v108
    v_subrev_u32 v108, 1, v108
    s_and_b64 s[62:63], vcc, s[90:91]
    v_lshlrev_b32 v111, v108, v3
    v_lshrrev_b32 v108, 3, v108
    v_and_b32 v108, 0x7c, v108
    v_add_u32 v108, s64, v108
    s_cmp_eq_u64 s[62:63], 0
    s_cbranch_scc1 gemnet_accum_kernel_nomarka
    s_mov_b64 exec, s[62:63]
    ds_or_b32 v108, v111 offset:6704
    s_mov_b64 exec, -1
gemnet_accum_kernel_nomarka:
    ds_read_b32 v127, v109 offset:6704
    ds_read_b32 v0, v109 offset:6708
    s_add_u32 s72, s88, 63
    s_lshr_b32 s72, s72, 6
    s_sub_u32 s73, s72, 1
    s_lshr_b32 s68, s88, 6
    s_and_b32 s65, s88, 63
    s_bfm_b64 s[74:75], s65, 0
    s_cmp_eq_u32 s65, 0
    s_cselect_b64 s[74:75], -1, s[74:75]
    s_mov_b32 s24, 0
    s_branch gemnet_accum_kernel_flda
gemnet_accum_kernel_nofla:
    s_mov_b32 s72, 0
    s_mov_b32 s68, 0
gemnet_accum_kernel_flda:
    s_waitcnt lgkmcnt(0)
    s_cmp_ge_u32 s27, 2
    s_cbranch_scc0 gemnet_accum_kernel_taila_0
    s_setprio 3
    s_cmp_ge_u32 s27, 4
    s_cbranch_scc0 gemnet_accum_kernel_g2sa_0
    v_and_b32 v35, 0xffff8, v76
    buffer_load_dwordx2 v[40:41], v35, s[4:7], s23 offen
    v_and_b32 v35, 0xffff8, v77
    buffer_load_dwordx2 v[42:43], v35, s[4:7], s23 offen
    s_branch gemnet_accum_kernel_g2ea_0
gemnet_accum_kernel_g2sa_0:
    s_cmp_eq_u32 s27, 2
    s_cselect_b64 s[62:63], s[60:61], 1
    v_and_b32 v35, 0xffff8, v76
    s_cmp_gt_u32 s27, 2
    s_cselect_b64 exec, -1, s[62:63]
    buffer_load_dwordx2 v[40:41], v35, s[4:7], s23 offen
    s_mov_b64 exec, -1
    s_cmp_eq_u32 s27, 3
    s_cselect_b64 s[62:63], s[60:61], 1
    v_and_b32 v35, 0xffff8, v77
    s_cmp_gt_u32 s27, 3
    s_cselect_b64 exec, -1, s[62:63]
    buffer_load_dwordx2 v[42:43], v35, s[4:7], s23 offen
    s_mov_b64 exec, -1
gemnet_accum_kernel_g2ea_0:
    v_lshrrev_b32 v94, 16, v74
    v_lshrrev_b32 v110, 16, v75
    v_and_b32 v94, 0xfff0, v94
    v_and_b32 v110, 0xfff0, v110
    ds_read_b128 v[90:93], v94 offset:33760
    ds_read_b128 v[106:109], v110 offset:33760
    v_lshrrev_b32 v74, 1, v94
    v_lshrrev_b32 v75, 1, v110
    v_mul_f32 v94, s20, v22
    v_mul_f32 v110, s20, v23
    v_fract_f32 v94, v94
    v_fract_f32 v110, v110
    v_cos_f32 v94, v94
    v_cos_f32 v110, v110
    v_add_f32 v95, v94, v94
    v_add_f32 v111, v110, v110
    v_fma_f32 v95, v95, v94, -1.0
    v_fma_f32 v111, v111, v110, -1.0
    v_cvt_pk_bf16_f32 v95, v94, v95
    v_cvt_pk_bf16_f32 v111, v110, v111
    s_waitcnt vmcnt(2)
    v_mfma_f32_4x4x4_16b_bf16 v[96:99], v[122:123], v[36:37], 0
    v_mfma_f32_4x4x4_16b_bf16 v[112:115], v[122:123], v[38:39], 0
    s_waitcnt lgkmcnt(0)
    ds_read_b64 v[104:105], v74 offset:8752
    ds_read_b64 v[120:121], v75 offset:8752
    v_dot2_f32_bf16 v100, v90, v95, 0
    v_dot2_f32_bf16 v116, v106, v111, 0
    v_dot2_f32_bf16 v101, v91, v95, 0
    v_dot2_f32_bf16 v117, v107, v111, 0
    v_dot2_f32_bf16 v102, v92, v95, 0
    v_dot2_f32_bf16 v118, v108, v111, 0
    v_dot2_f32_bf16 v103, v93, v95, 0
    v_dot2_f32_bf16 v119, v109, v111, 0
    v_pk_mul_f32 v[96:97], v[96:97], v[100:101]
    v_pk_mul_f32 v[112:113], v[112:113], v[116:117]
    v_pk_mul_f32 v[98:99], v[98:99], v[102:103]
    v_pk_mul_f32 v[114:115], v[114:115], v[118:119]
    s_waitcnt lgkmcnt(0)
    s_nop 0
    v_mfma_f32_4x4x4_16b_bf16 v[100:103], v[124:125], v[104:105], v[96:99]
    v_mfma_f32_4x4x4_16b_bf16 v[116:119], v[124:125], v[120:121], v[112:115]
    s_nop 3
    v_cvt_pk_bf16_f32 v90, v100, v101
    v_cvt_pk_bf16_f32 v91, v102, v103
    ds_cmpst_rtn_b64 v[92:93], v74, v[104:105], v[90:91] offset:8752
    v_cvt_pk_bf16_f32 v106, v116, v117
    v_cvt_pk_bf16_f32 v107, v118, v119
    ds_cmpst_rtn_b64 v[108:109], v75, v[120:121], v[106:107] offset:8752
    s_waitcnt lgkmcnt(0)
    v_cmp_ne_u64 vcc, v[92:93], v[104:105]
    s_mov_b64 s[70:71], vcc
    v_cmp_ne_u64 vcc, v[108:109], v[120:121]
    s_mov_b64 s[90:91], vcc
    s_or_b64 s[62:63], s[70:71], vcc
    s_cbranch_scc0 gemnet_accum_kernel_poka_0
    s_bcnt1_i32_b64 s65, s[70:71]
    s_bcnt1_i32_b64 s66, s[90:91]
    s_add_u32 s65, s65, s66
    s_cmp_le_u32 s65, 6
    s_cbranch_scc1 gemnet_accum_kernel_ppka_0
gemnet_accum_kernel_prta_0:
    v_mfma_f32_4x4x4_16b_bf16 v[100:103], v[124:125], v[92:93], v[96:99]
    v_mfma_f32_4x4x4_16b_bf16 v[116:119], v[124:125], v[108:109], v[112:115]
    s_mov_b64 exec, s[70:71]
    s_nop 2
    v_cvt_pk_bf16_f32 v90, v100, v101
    v_cvt_pk_bf16_f32 v91, v102, v103
    ds_cmpst_rtn_b64 v[104:105], v74, v[92:93], v[90:91] offset:8752
    s_mov_b64 exec, s[90:91]
    v_cvt_pk_bf16_f32 v106, v116, v117
    v_cvt_pk_bf16_f32 v107, v118, v119
    ds_cmpst_rtn_b64 v[120:121], v75, v[108:109], v[106:107] offset:8752
    s_waitcnt lgkmcnt(0)
    v_cmp_ne_u64 vcc, v[108:109], v[120:121]
    s_mov_b64 s[90:91], vcc
    s_mov_b64 exec, s[70:71]
    v_cmp_ne_u64 vcc, v[92:93], v[104:105]
    s_mov_b64 s[70:71], vcc
    s_or_b64 s[62:63], s[90:91], vcc
    s_cbranch_scc0 gemnet_accum_kernel_pfina_0
gemnet_accum_kernel_ppka_0:
    s_mov_b64 exec, s[70:71]
    s_cbranch_execz gemnet_accum_kernel_pkaa_0
    v_cvt_pk_bf16_f32 v90, v96, v97
    v_cvt_pk_bf16_f32 v91, v98, v99
    ds_pk_add_bf16 v74, v90 offset:8752
    ds_pk_add_bf16 v74, v91 offset:8756
gemnet_accum_kernel_pkaa_0:
    s_mov_b64 exec, s[90:91]
    s_cbranch_execz gemnet_accum_kernel_pfina_0
    v_cvt_pk_bf16_f32 v106, v112, v113
    v_cvt_pk_bf16_f32 v107, v114, v115
    ds_pk_add_bf16 v75, v106 offset:8752
    ds_pk_add_bf16 v75, v107 offset:8756
gemnet_accum_kernel_pfina_0:
    s_mov_b64 exec, -1
gemnet_accum_kernel_poka_0:
    v_lshrrev_b32 v126, 16, v44
    v_cndmask_b32 v44, v44, v45, s[28:29]
    v_cndmask_b32 v45, v45, v126, s[28:29]
    v_lshrrev_b32 v126, 16, v46
    v_cndmask_b32 v46, v46, v47, s[30:31]
    v_cndmask_b32 v47, v47, v126, s[30:31]
    v_lshrrev_b32 v126, 16, v48
    v_cndmask_b32 v48, v48, v49, s[32:33]
    v_cndmask_b32 v49, v49, v126, s[32:33]
    v_lshrrev_b32 v126, 16, v50
    v_cndmask_b32 v50, v50, v51, s[34:35]
    v_cndmask_b32 v51, v51, v126, s[34:35]
    v_lshrrev_b32 v126, 16, v52
    v_cndmask_b32 v52, v52, v53, s[36:37]
    v_cndmask_b32 v53, v53, v126, s[36:37]
    v_lshrrev_b32 v126, 16, v54
    v_cndmask_b32 v54, v54, v55, s[38:39]
    v_cndmask_b32 v55, v55, v126, s[38:39]
    v_lshrrev_b32 v126, 16, v56
    v_cndmask_b32 v56, v56, v57, s[40:41]
    v_cndmask_b32 v57, v57, v126, s[40:41]
    v_lshrrev_b32 v126, 16, v58
    v_cndmask_b32 v58, v58, v59, s[42:43]
    v_cndmask_b32 v59, v59, v126, s[42:43]
    v_lshrrev_b32 v126, 16, v60
    v_cndmask_b32 v60, v60, v61, s[44:45]
    v_cndmask_b32 v61, v61, v126, s[44:45]
    v_lshrrev_b32 v126, 16, v62
    v_cndmask_b32 v62, v62, v63, s[46:47]
    v_cndmask_b32 v63, v63, v126, s[46:47]
    v_lshrrev_b32 v126, 16, v64
    v_cndmask_b32 v64, v64, v65, s[48:49]
    v_cndmask_b32 v65, v65, v126, s[48:49]
    v_lshrrev_b32 v126, 16, v66
    v_cndmask_b32 v66, v66, v67, s[50:51]
    v_cndmask_b32 v67, v67, v126, s[50:51]
    v_lshrrev_b32 v126, 16, v68
    v_cndmask_b32 v68, v68, v69, s[52:53]
    v_cndmask_b32 v69, v69, v126, s[52:53]
    s_cmp_gt_u32 s76, 13
    s_cbranch_scc0 gemnet_accum_kernel_decan
    v_lshrrev_b32 v126, 16, v70
    v_cndmask_b32 v70, v70, v71, s[54:55]
    v_cndmask_b32 v71, v71, v126, s[54:55]
    s_cmp_gt_u32 s76, 14
    s_cbranch_scc0 gemnet_accum_kernel_decan
    v_lshrrev_b32 v126, 16, v72
    v_cndmask_b32 v72, v72, v73, s[56:57]
    v_cndmask_b32 v73, v73, v126, s[56:57]
gemnet_accum_kernel_decan:
    s_cmp_ge_u32 s69, 2
    s_cbranch_scc0 gemnet_accum_kernel_h2san_0
    v_lshrrev_b32 v126, 8, v44
    v_and_b32 v126, 4092, v126
    ds_add_rtn_u32 v74, v126, v3 offset:3328
    v_lshrrev_b32 v126, 8, v46
    v_and_b32 v126, 4092, v126
    ds_add_rtn_u32 v75, v126, v3 offset:3328
    s_branch gemnet_accum_kernel_h2ean_0
gemnet_accum_kernel_h2san_0:
    s_cmp_gt_u32 s76, 0
    s_cbranch_scc0 gemnet_accum_kernel_hgan_0
    s_cmp_eq_u32 s77, 0
    s_cselect_b64 exec, s[78:79], -1
    v_lshrrev_b32 v126, 8, v44
    v_and_b32 v126, 4092, v126
    ds_add_rtn_u32 v74, v126, v3 offset:3328
    s_mov_b64 exec, -1
gemnet_accum_kernel_hgan_0:
    s_cmp_gt_u32 s76, 1
    s_cbranch_scc0 gemnet_accum_kernel_hgan_1
    s_cmp_eq_u32 s77, 1
    s_cselect_b64 exec, s[78:79], -1
    v_lshrrev_b32 v126, 8, v46
    v_and_b32 v126, 4092, v126
    ds_add_rtn_u32 v75, v126, v3 offset:3328
    s_mov_b64 exec, -1
gemnet_accum_kernel_hgan_1:
gemnet_accum_kernel_h2ean_0:
    v_readlane_b32 s62, v127, 0
    v_readlane_b32 s63, v0, 0
    s_nop 1
    v_mbcnt_lo_u32_b32 v126, s62, 0
    v_mbcnt_hi_u32_b32 v126, s63, v126
    v_add_lshl_u32 v126, v126, s24, 2
    s_bcnt1_i32_b64 s65, s[62:63]
    ds_bpermute_b32 v14, v126, v89
    s_add_u32 s24, s24, s65
gemnet_accum_kernel_faan_0:
    v_readlane_b32 s62, v127, 1
    v_readlane_b32 s63, v0, 1
    s_nop 1
    v_mbcnt_lo_u32_b32 v126, s62, 0
    v_mbcnt_hi_u32_b32 v126, s63, v126
    v_add_lshl_u32 v126, v126, s24, 2
    s_bcnt1_i32_b64 s65, s[62:63]
    ds_bpermute_b32 v16, v126, v89
    s_add_u32 s24, s24, s65
gemnet_accum_kernel_faan_1:
    v_readlane_b32 s62, v127, 2
    v_readlane_b32 s63, v0, 2
    s_nop 1
    v_mbcnt_lo_u32_b32 v126, s62, 0
    v_mbcnt_hi_u32_b32 v126, s63, v126
    v_add_lshl_u32 v126, v126, s24, 2
    s_bcnt1_i32_b64 s65, s[62:63]
    ds_bpermute_b32 v18, v126, v89
    s_add_u32 s24, s24, s65
gemnet_accum_kernel_faan_2:
    v_readlane_b32 s62, v127, 3
    v_readlane_b32 s63, v0, 3
    s_nop 1
    v_mbcnt_lo_u32_b32 v126, s62, 0
    v_mbcnt_hi_u32_b32 v126, s63, v126
    v_add_lshl_u32 v126, v126, s24, 2
    s_bcnt1_i32_b64 s65, s[62:63]
    ds_bpermute_b32 v20, v126, v89
    s_add_u32 s24, s24, s65
gemnet_accum_kernel_faan_3:
    v_readlane_b32 s62, v127, 4
    v_readlane_b32 s63, v0, 4
    s_nop 1
    v_mbcnt_lo_u32_b32 v126, s62, 0
    v_mbcnt_hi_u32_b32 v126, s63, v126
    v_add_lshl_u32 v126, v126, s24, 2
    s_bcnt1_i32_b64 s65, s[62:63]
    ds_bpermute_b32 v22, v126, v89
    s_add_u32 s24, s24, s65
gemnet_accum_kernel_faan_4:
    s_cmp_ge_u32 s27, 4
    s_cbranch_scc0 gemnet_accum_kernel_taila_2
    s_setprio 3
    s_cmp_ge_u32 s27, 6
    s_cbranch_scc0 gemnet_accum_kernel_g2sa_1
    v_and_b32 v35, 0xffff8, v78
    buffer_load_dwordx2 v[36:37], v35, s[4:7], s23 offen
    v_and_b32 v35, 0xffff8, v79
    buffer_load_dwordx2 v[38:39], v35, s[4:7], s23 offen
    s_branch gemnet_accum_kernel_g2ea_1
gemnet_accum_kernel_g2sa_1:
    s_cmp_eq_u32 s27, 4
    s_cselect_b64 s[62:63], s[60:61], 1
    v_and_b32 v35, 0xffff8, v78
    s_cmp_gt_u32 s27, 4
    s_cselect_b64 exec, -1, s[62:63]
    buffer_load_dwordx2 v[36:37], v35, s[4:7], s23 offen
    s_mov_b64 exec, -1
    s_cmp_eq_u32 s27, 5
    s_cselect_b64 s[62:63], s[60:61], 1
    v_and_b32 v35, 0xffff8, v79
    s_cmp_gt_u32 s27, 5
    s_cselect_b64 exec, -1, s[62:63]
    buffer_load_dwordx2 v[38:39], v35, s[4:7], s23 offen
    s_mov_b64 exec, -1
gemnet_accum_kernel_g2ea_1:
    v_lshrrev_b32 v94, 16, v76
    v_lshrrev_b32 v110, 16, v77
    v_and_b32 v94, 0xfff0, v94
    v_and_b32 v110, 0xfff0, v110
    ds_read_b128 v[90:93], v94 offset:33760
    ds_read_b128 v[106:109], v110 offset:33760
    v_lshrrev_b32 v76, 1, v94
    v_lshrrev_b32 v77, 1, v110
    v_mul_f32 v94, s20, v24
    v_mul_f32 v110, s20, v25
    v_fract_f32 v94, v94
    v_fract_f32 v110, v110
    v_cos_f32 v94, v94
    v_cos_f32 v110, v110
    v_add_f32 v95, v94, v94
    v_add_f32 v111, v110, v110
    v_fma_f32 v95, v95, v94, -1.0
    v_fma_f32 v111, v111, v110, -1.0
    v_cvt_pk_bf16_f32 v95, v94, v95
    v_cvt_pk_bf16_f32 v111, v110, v111
    s_waitcnt vmcnt(2)
    v_mfma_f32_4x4x4_16b_bf16 v[96:99], v[122:123], v[40:41], 0
    v_mfma_f32_4x4x4_16b_bf16 v[112:115], v[122:123], v[42:43], 0
    s_waitcnt lgkmcnt(0)
    ds_read_b64 v[104:105], v76 offset:8752
    ds_read_b64 v[120:121], v77 offset:8752
    v_dot2_f32_bf16 v100, v90, v95, 0
    v_dot2_f32_bf16 v116, v106, v111, 0
    v_dot2_f32_bf16 v101, v91, v95, 0
    v_dot2_f32_bf16 v117, v107, v111, 0
    v_dot2_f32_bf16 v102, v92, v95, 0
    v_dot2_f32_bf16 v118, v108, v111, 0
    v_dot2_f32_bf16 v103, v93, v95, 0
    v_dot2_f32_bf16 v119, v109, v111, 0
    v_pk_mul_f32 v[96:97], v[96:97], v[100:101]
    v_pk_mul_f32 v[112:113], v[112:113], v[116:117]
    v_pk_mul_f32 v[98:99], v[98:99], v[102:103]
    v_pk_mul_f32 v[114:115], v[114:115], v[118:119]
    s_waitcnt lgkmcnt(0)
    s_nop 0
    v_mfma_f32_4x4x4_16b_bf16 v[100:103], v[124:125], v[104:105], v[96:99]
    v_mfma_f32_4x4x4_16b_bf16 v[116:119], v[124:125], v[120:121], v[112:115]
    s_nop 3
    v_cvt_pk_bf16_f32 v90, v100, v101
    v_cvt_pk_bf16_f32 v91, v102, v103
    ds_cmpst_rtn_b64 v[92:93], v76, v[104:105], v[90:91] offset:8752
    v_cvt_pk_bf16_f32 v106, v116, v117
    v_cvt_pk_bf16_f32 v107, v118, v119
    ds_cmpst_rtn_b64 v[108:109], v77, v[120:121], v[106:107] offset:8752
    s_waitcnt lgkmcnt(0)
    v_cmp_ne_u64 vcc, v[92:93], v[104:105]
    s_mov_b64 s[70:71], vcc
    v_cmp_ne_u64 vcc, v[108:109], v[120:121]
    s_mov_b64 s[90:91], vcc
    s_or_b64 s[62:63], s[70:71], vcc
    s_cbranch_scc0 gemnet_accum_kernel_poka_1
    s_bcnt1_i32_b64 s65, s[70:71]
    s_bcnt1_i32_b64 s66, s[90:91]
    s_add_u32 s65, s65, s66
    s_cmp_le_u32 s65, 6
    s_cbranch_scc1 gemnet_accum_kernel_ppka_1
gemnet_accum_kernel_prta_1:
    v_mfma_f32_4x4x4_16b_bf16 v[100:103], v[124:125], v[92:93], v[96:99]
    v_mfma_f32_4x4x4_16b_bf16 v[116:119], v[124:125], v[108:109], v[112:115]
    s_mov_b64 exec, s[70:71]
    s_nop 2
    v_cvt_pk_bf16_f32 v90, v100, v101
    v_cvt_pk_bf16_f32 v91, v102, v103
    ds_cmpst_rtn_b64 v[104:105], v76, v[92:93], v[90:91] offset:8752
    s_mov_b64 exec, s[90:91]
    v_cvt_pk_bf16_f32 v106, v116, v117
    v_cvt_pk_bf16_f32 v107, v118, v119
    ds_cmpst_rtn_b64 v[120:121], v77, v[108:109], v[106:107] offset:8752
    s_waitcnt lgkmcnt(0)
    v_cmp_ne_u64 vcc, v[108:109], v[120:121]
    s_mov_b64 s[90:91], vcc
    s_mov_b64 exec, s[70:71]
    v_cmp_ne_u64 vcc, v[92:93], v[104:105]
    s_mov_b64 s[70:71], vcc
    s_or_b64 s[62:63], s[90:91], vcc
    s_cbranch_scc0 gemnet_accum_kernel_pfina_1
gemnet_accum_kernel_ppka_1:
    s_mov_b64 exec, s[70:71]
    s_cbranch_execz gemnet_accum_kernel_pkaa_1
    v_cvt_pk_bf16_f32 v90, v96, v97
    v_cvt_pk_bf16_f32 v91, v98, v99
    ds_pk_add_bf16 v76, v90 offset:8752
    ds_pk_add_bf16 v76, v91 offset:8756
gemnet_accum_kernel_pkaa_1:
    s_mov_b64 exec, s[90:91]
    s_cbranch_execz gemnet_accum_kernel_pfina_1
    v_cvt_pk_bf16_f32 v106, v112, v113
    v_cvt_pk_bf16_f32 v107, v114, v115
    ds_pk_add_bf16 v77, v106 offset:8752
    ds_pk_add_bf16 v77, v107 offset:8756
gemnet_accum_kernel_pfina_1:
    s_mov_b64 exec, -1
gemnet_accum_kernel_poka_1:
    s_cmp_ge_u32 s69, 4
    s_cbranch_scc0 gemnet_accum_kernel_h2san_2
    v_lshrrev_b32 v126, 8, v48
    v_and_b32 v126, 4092, v126
    ds_add_rtn_u32 v76, v126, v3 offset:3328
    v_lshrrev_b32 v126, 8, v50
    v_and_b32 v126, 4092, v126
    ds_add_rtn_u32 v77, v126, v3 offset:3328
    s_branch gemnet_accum_kernel_h2ean_2
gemnet_accum_kernel_h2san_2:
    s_cmp_gt_u32 s76, 2
    s_cbranch_scc0 gemnet_accum_kernel_hgan_2
    s_cmp_eq_u32 s77, 2
    s_cselect_b64 exec, s[78:79], -1
    v_lshrrev_b32 v126, 8, v48
    v_and_b32 v126, 4092, v126
    ds_add_rtn_u32 v76, v126, v3 offset:3328
    s_mov_b64 exec, -1
gemnet_accum_kernel_hgan_2:
    s_cmp_gt_u32 s76, 3
    s_cbranch_scc0 gemnet_accum_kernel_hgan_3
    s_cmp_eq_u32 s77, 3
    s_cselect_b64 exec, s[78:79], -1
    v_lshrrev_b32 v126, 8, v50
    v_and_b32 v126, 4092, v126
    ds_add_rtn_u32 v77, v126, v3 offset:3328
    s_mov_b64 exec, -1
gemnet_accum_kernel_hgan_3:
gemnet_accum_kernel_h2ean_2:
    s_movk_i32 s25, 0
    v_add3_u32 v15, v14, v2, s25
    v_and_b32 v14, -4, v15
    v_cmp_ne_u32 s[28:29], v14, v15
gemnet_accum_kernel_fban_0:
    s_movk_i32 s25, 384
    v_add3_u32 v17, v16, v2, s25
    v_and_b32 v16, -4, v17
    v_cmp_ne_u32 s[30:31], v16, v17
gemnet_accum_kernel_fban_1:
    s_movk_i32 s25, 768
    v_add3_u32 v19, v18, v2, s25
    v_and_b32 v18, -4, v19
    v_cmp_ne_u32 s[32:33], v18, v19
gemnet_accum_kernel_fban_2:
    s_movk_i32 s25, 1152
    v_add3_u32 v21, v20, v2, s25
    v_and_b32 v20, -4, v21
    v_cmp_ne_u32 s[34:35], v20, v21
gemnet_accum_kernel_fban_3:
    s_movk_i32 s25, 1536
    v_add3_u32 v23, v22, v2, s25
    v_and_b32 v22, -4, v23
    v_cmp_ne_u32 s[36:37], v22, v23
gemnet_accum_kernel_fban_4:
    v_readlane_b32 s62, v127, 5
    v_readlane_b32 s63, v0, 5
    s_nop 1
    v_mbcnt_lo_u32_b32 v126, s62, 0
    v_mbcnt_hi_u32_b32 v126, s63, v126
    v_add_lshl_u32 v126, v126, s24, 2
    s_bcnt1_i32_b64 s65, s[62:63]
    ds_bpermute_b32 v24, v126, v89
    s_add_u32 s24, s24, s65
gemnet_accum_kernel_faan_5:
    s_cmp_ge_u32 s27, 6
    s_cbranch_scc0 gemnet_accum_kernel_taila_4
    s_setprio 2
    s_cmp_ge_u32 s27, 8
    s_cbranch_scc0 gemnet_accum_kernel_g2sa_2
    v_and_b32 v35, 0xffff8, v80
    buffer_load_dwordx2 v[40:41], v35, s[4:7], s23 offen
    v_and_b32 v35, 0xffff8, v81
    buffer_load_dwordx2 v[42:43], v35, s[4:7], s23 offen
    s_branch gemnet_accum_kernel_g2ea_2
gemnet_accum_kernel_g2sa_2:
    s_cmp_eq_u32 s27, 6
    s_cselect_b64 s[62:63], s[60:61], 1
    v_and_b32 v35, 0xffff8, v80
    s_cmp_gt_u32 s27, 6
    s_cselect_b64 exec, -1, s[62:63]
    buffer_load_dwordx2 v[40:41], v35, s[4:7], s23 offen
    s_mov_b64 exec, -1
    s_cmp_eq_u32 s27, 7
    s_cselect_b64 s[62:63], s[60:61], 1
    v_and_b32 v35, 0xffff8, v81
    s_cmp_gt_u32 s27, 7
    s_cselect_b64 exec, -1, s[62:63]
    buffer_load_dwordx2 v[42:43], v35, s[4:7], s23 offen
    s_mov_b64 exec, -1
gemnet_accum_kernel_g2ea_2:
    v_lshrrev_b32 v94, 16, v78
    v_lshrrev_b32 v110, 16, v79
    v_and_b32 v94, 0xfff0, v94
    v_and_b32 v110, 0xfff0, v110
    ds_read_b128 v[90:93], v94 offset:33760
    ds_read_b128 v[106:109], v110 offset:33760
    v_lshrrev_b32 v78, 1, v94
    v_lshrrev_b32 v79, 1, v110
    v_mul_f32 v94, s20, v26
    v_mul_f32 v110, s20, v27
    v_fract_f32 v94, v94
    v_fract_f32 v110, v110
    v_cos_f32 v94, v94
    v_cos_f32 v110, v110
    v_add_f32 v95, v94, v94
    v_add_f32 v111, v110, v110
    v_fma_f32 v95, v95, v94, -1.0
    v_fma_f32 v111, v111, v110, -1.0
    v_cvt_pk_bf16_f32 v95, v94, v95
    v_cvt_pk_bf16_f32 v111, v110, v111
    s_waitcnt vmcnt(2)
    v_mfma_f32_4x4x4_16b_bf16 v[96:99], v[122:123], v[36:37], 0
    v_mfma_f32_4x4x4_16b_bf16 v[112:115], v[122:123], v[38:39], 0
    s_waitcnt lgkmcnt(0)
    ds_read_b64 v[104:105], v78 offset:8752
    ds_read_b64 v[120:121], v79 offset:8752
    v_dot2_f32_bf16 v100, v90, v95, 0
    v_dot2_f32_bf16 v116, v106, v111, 0
    v_dot2_f32_bf16 v101, v91, v95, 0
    v_dot2_f32_bf16 v117, v107, v111, 0
    v_dot2_f32_bf16 v102, v92, v95, 0
    v_dot2_f32_bf16 v118, v108, v111, 0
    v_dot2_f32_bf16 v103, v93, v95, 0
    v_dot2_f32_bf16 v119, v109, v111, 0
    v_pk_mul_f32 v[96:97], v[96:97], v[100:101]
    v_pk_mul_f32 v[112:113], v[112:113], v[116:117]
    v_pk_mul_f32 v[98:99], v[98:99], v[102:103]
    v_pk_mul_f32 v[114:115], v[114:115], v[118:119]
    s_waitcnt lgkmcnt(0)
    s_nop 0
    v_mfma_f32_4x4x4_16b_bf16 v[100:103], v[124:125], v[104:105], v[96:99]
    v_mfma_f32_4x4x4_16b_bf16 v[116:119], v[124:125], v[120:121], v[112:115]
    s_nop 3
    v_cvt_pk_bf16_f32 v90, v100, v101
    v_cvt_pk_bf16_f32 v91, v102, v103
    ds_cmpst_rtn_b64 v[92:93], v78, v[104:105], v[90:91] offset:8752
    v_cvt_pk_bf16_f32 v106, v116, v117
    v_cvt_pk_bf16_f32 v107, v118, v119
    ds_cmpst_rtn_b64 v[108:109], v79, v[120:121], v[106:107] offset:8752
    s_waitcnt lgkmcnt(0)
    v_cmp_ne_u64 vcc, v[92:93], v[104:105]
    s_mov_b64 s[70:71], vcc
    v_cmp_ne_u64 vcc, v[108:109], v[120:121]
    s_mov_b64 s[90:91], vcc
    s_or_b64 s[62:63], s[70:71], vcc
    s_cbranch_scc0 gemnet_accum_kernel_poka_2
    s_bcnt1_i32_b64 s65, s[70:71]
    s_bcnt1_i32_b64 s66, s[90:91]
    s_add_u32 s65, s65, s66
    s_cmp_le_u32 s65, 6
    s_cbranch_scc1 gemnet_accum_kernel_ppka_2
gemnet_accum_kernel_prta_2:
    v_mfma_f32_4x4x4_16b_bf16 v[100:103], v[124:125], v[92:93], v[96:99]
    v_mfma_f32_4x4x4_16b_bf16 v[116:119], v[124:125], v[108:109], v[112:115]
    s_mov_b64 exec, s[70:71]
    s_nop 2
    v_cvt_pk_bf16_f32 v90, v100, v101
    v_cvt_pk_bf16_f32 v91, v102, v103
    ds_cmpst_rtn_b64 v[104:105], v78, v[92:93], v[90:91] offset:8752
    s_mov_b64 exec, s[90:91]
    v_cvt_pk_bf16_f32 v106, v116, v117
    v_cvt_pk_bf16_f32 v107, v118, v119
    ds_cmpst_rtn_b64 v[120:121], v79, v[108:109], v[106:107] offset:8752
    s_waitcnt lgkmcnt(0)
    v_cmp_ne_u64 vcc, v[108:109], v[120:121]
    s_mov_b64 s[90:91], vcc
    s_mov_b64 exec, s[70:71]
    v_cmp_ne_u64 vcc, v[92:93], v[104:105]
    s_mov_b64 s[70:71], vcc
    s_or_b64 s[62:63], s[90:91], vcc
    s_cbranch_scc0 gemnet_accum_kernel_pfina_2
gemnet_accum_kernel_ppka_2:
    s_mov_b64 exec, s[70:71]
    s_cbranch_execz gemnet_accum_kernel_pkaa_2
    v_cvt_pk_bf16_f32 v90, v96, v97
    v_cvt_pk_bf16_f32 v91, v98, v99
    ds_pk_add_bf16 v78, v90 offset:8752
    ds_pk_add_bf16 v78, v91 offset:8756
gemnet_accum_kernel_pkaa_2:
    s_mov_b64 exec, s[90:91]
    s_cbranch_execz gemnet_accum_kernel_pfina_2
    v_cvt_pk_bf16_f32 v106, v112, v113
    v_cvt_pk_bf16_f32 v107, v114, v115
    ds_pk_add_bf16 v79, v106 offset:8752
    ds_pk_add_bf16 v79, v107 offset:8756
gemnet_accum_kernel_pfina_2:
    s_mov_b64 exec, -1
gemnet_accum_kernel_poka_2:
    s_cmp_ge_u32 s69, 6
    s_cbranch_scc0 gemnet_accum_kernel_h2san_4
    v_lshrrev_b32 v126, 8, v52
    v_and_b32 v126, 4092, v126
    ds_add_rtn_u32 v78, v126, v3 offset:3328
    v_lshrrev_b32 v126, 8, v54
    v_and_b32 v126, 4092, v126
    ds_add_rtn_u32 v79, v126, v3 offset:3328
    s_branch gemnet_accum_kernel_h2ean_4
gemnet_accum_kernel_h2san_4:
    s_cmp_gt_u32 s76, 4
    s_cbranch_scc0 gemnet_accum_kernel_hgan_4
    s_cmp_eq_u32 s77, 4
    s_cselect_b64 exec, s[78:79], -1
    v_lshrrev_b32 v126, 8, v52
    v_and_b32 v126, 4092, v126
    ds_add_rtn_u32 v78, v126, v3 offset:3328
    s_mov_b64 exec, -1
gemnet_accum_kernel_hgan_4:
    s_cmp_gt_u32 s76, 5
    s_cbranch_scc0 gemnet_accum_kernel_hgan_5
    s_cmp_eq_u32 s77, 5
    s_cselect_b64 exec, s[78:79], -1
    v_lshrrev_b32 v126, 8, v54
    v_and_b32 v126, 4092, v126
    ds_add_rtn_u32 v79, v126, v3 offset:3328
    s_mov_b64 exec, -1
gemnet_accum_kernel_hgan_5:
gemnet_accum_kernel_h2ean_4:
    s_movk_i32 s25, 1920
    v_add3_u32 v25, v24, v2, s25
    v_and_b32 v24, -4, v25
    v_cmp_ne_u32 s[38:39], v24, v25
gemnet_accum_kernel_fban_5:
    v_readlane_b32 s62, v127, 6
    v_readlane_b32 s63, v0, 6
    s_nop 1
    v_mbcnt_lo_u32_b32 v126, s62, 0
    v_mbcnt_hi_u32_b32 v126, s63, v126
    v_add_lshl_u32 v126, v126, s24, 2
    s_bcnt1_i32_b64 s65, s[62:63]
    ds_bpermute_b32 v26, v126, v89
    s_add_u32 s24, s24, s65
gemnet_accum_kernel_faan_6:
    s_cmp_ge_u32 s27, 8
    s_cbranch_scc0 gemnet_accum_kernel_taila_6
    s_setprio 2
    s_cmp_ge_u32 s27, 10
    s_cbranch_scc0 gemnet_accum_kernel_g2sa_3
    v_and_b32 v35, 0xffff8, v82
    buffer_load_dwordx2 v[36:37], v35, s[4:7], s23 offen
    v_and_b32 v35, 0xffff8, v83
    buffer_load_dwordx2 v[38:39], v35, s[4:7], s23 offen
    s_branch gemnet_accum_kernel_g2ea_3
gemnet_accum_kernel_g2sa_3:
    s_cmp_eq_u32 s27, 8
    s_cselect_b64 s[62:63], s[60:61], 1
    v_and_b32 v35, 0xffff8, v82
    s_cmp_gt_u32 s27, 8
    s_cselect_b64 exec, -1, s[62:63]
    buffer_load_dwordx2 v[36:37], v35, s[4:7], s23 offen
    s_mov_b64 exec, -1
    s_cmp_eq_u32 s27, 9
    s_cselect_b64 s[62:63], s[60:61], 1
    v_and_b32 v35, 0xffff8, v83
    s_cmp_gt_u32 s27, 9
    s_cselect_b64 exec, -1, s[62:63]
    buffer_load_dwordx2 v[38:39], v35, s[4:7], s23 offen
    s_mov_b64 exec, -1
gemnet_accum_kernel_g2ea_3:
    v_lshrrev_b32 v94, 16, v80
    v_lshrrev_b32 v110, 16, v81
    v_and_b32 v94, 0xfff0, v94
    v_and_b32 v110, 0xfff0, v110
    ds_read_b128 v[90:93], v94 offset:33760
    ds_read_b128 v[106:109], v110 offset:33760
    v_lshrrev_b32 v80, 1, v94
    v_lshrrev_b32 v81, 1, v110
    v_mul_f32 v94, s20, v28
    v_mul_f32 v110, s20, v29
    v_fract_f32 v94, v94
    v_fract_f32 v110, v110
    v_cos_f32 v94, v94
    v_cos_f32 v110, v110
    v_add_f32 v95, v94, v94
    v_add_f32 v111, v110, v110
    v_fma_f32 v95, v95, v94, -1.0
    v_fma_f32 v111, v111, v110, -1.0
    v_cvt_pk_bf16_f32 v95, v94, v95
    v_cvt_pk_bf16_f32 v111, v110, v111
    s_waitcnt vmcnt(2)
    v_mfma_f32_4x4x4_16b_bf16 v[96:99], v[122:123], v[40:41], 0
    v_mfma_f32_4x4x4_16b_bf16 v[112:115], v[122:123], v[42:43], 0
    s_waitcnt lgkmcnt(0)
    ds_read_b64 v[104:105], v80 offset:8752
    ds_read_b64 v[120:121], v81 offset:8752
    v_dot2_f32_bf16 v100, v90, v95, 0
    v_dot2_f32_bf16 v116, v106, v111, 0
    v_dot2_f32_bf16 v101, v91, v95, 0
    v_dot2_f32_bf16 v117, v107, v111, 0
    v_dot2_f32_bf16 v102, v92, v95, 0
    v_dot2_f32_bf16 v118, v108, v111, 0
    v_dot2_f32_bf16 v103, v93, v95, 0
    v_dot2_f32_bf16 v119, v109, v111, 0
    v_pk_mul_f32 v[96:97], v[96:97], v[100:101]
    v_pk_mul_f32 v[112:113], v[112:113], v[116:117]
    v_pk_mul_f32 v[98:99], v[98:99], v[102:103]
    v_pk_mul_f32 v[114:115], v[114:115], v[118:119]
    s_waitcnt lgkmcnt(0)
    s_nop 0
    v_mfma_f32_4x4x4_16b_bf16 v[100:103], v[124:125], v[104:105], v[96:99]
    v_mfma_f32_4x4x4_16b_bf16 v[116:119], v[124:125], v[120:121], v[112:115]
    s_nop 3
    v_cvt_pk_bf16_f32 v90, v100, v101
    v_cvt_pk_bf16_f32 v91, v102, v103
    ds_cmpst_rtn_b64 v[92:93], v80, v[104:105], v[90:91] offset:8752
    v_cvt_pk_bf16_f32 v106, v116, v117
    v_cvt_pk_bf16_f32 v107, v118, v119
    ds_cmpst_rtn_b64 v[108:109], v81, v[120:121], v[106:107] offset:8752
    s_waitcnt lgkmcnt(0)
    v_cmp_ne_u64 vcc, v[92:93], v[104:105]
    s_mov_b64 s[70:71], vcc
    v_cmp_ne_u64 vcc, v[108:109], v[120:121]
    s_mov_b64 s[90:91], vcc
    s_or_b64 s[62:63], s[70:71], vcc
    s_cbranch_scc0 gemnet_accum_kernel_poka_3
    s_bcnt1_i32_b64 s65, s[70:71]
    s_bcnt1_i32_b64 s66, s[90:91]
    s_add_u32 s65, s65, s66
    s_cmp_le_u32 s65, 6
    s_cbranch_scc1 gemnet_accum_kernel_ppka_3
gemnet_accum_kernel_prta_3:
    v_mfma_f32_4x4x4_16b_bf16 v[100:103], v[124:125], v[92:93], v[96:99]
    v_mfma_f32_4x4x4_16b_bf16 v[116:119], v[124:125], v[108:109], v[112:115]
    s_mov_b64 exec, s[70:71]
    s_nop 2
    v_cvt_pk_bf16_f32 v90, v100, v101
    v_cvt_pk_bf16_f32 v91, v102, v103
    ds_cmpst_rtn_b64 v[104:105], v80, v[92:93], v[90:91] offset:8752
    s_mov_b64 exec, s[90:91]
    v_cvt_pk_bf16_f32 v106, v116, v117
    v_cvt_pk_bf16_f32 v107, v118, v119
    ds_cmpst_rtn_b64 v[120:121], v81, v[108:109], v[106:107] offset:8752
    s_waitcnt lgkmcnt(0)
    v_cmp_ne_u64 vcc, v[108:109], v[120:121]
    s_mov_b64 s[90:91], vcc
    s_mov_b64 exec, s[70:71]
    v_cmp_ne_u64 vcc, v[92:93], v[104:105]
    s_mov_b64 s[70:71], vcc
    s_or_b64 s[62:63], s[90:91], vcc
    s_cbranch_scc0 gemnet_accum_kernel_pfina_3
gemnet_accum_kernel_ppka_3:
    s_mov_b64 exec, s[70:71]
    s_cbranch_execz gemnet_accum_kernel_pkaa_3
    v_cvt_pk_bf16_f32 v90, v96, v97
    v_cvt_pk_bf16_f32 v91, v98, v99
    ds_pk_add_bf16 v80, v90 offset:8752
    ds_pk_add_bf16 v80, v91 offset:8756
gemnet_accum_kernel_pkaa_3:
    s_mov_b64 exec, s[90:91]
    s_cbranch_execz gemnet_accum_kernel_pfina_3
    v_cvt_pk_bf16_f32 v106, v112, v113
    v_cvt_pk_bf16_f32 v107, v114, v115
    ds_pk_add_bf16 v81, v106 offset:8752
    ds_pk_add_bf16 v81, v107 offset:8756
gemnet_accum_kernel_pfina_3:
    s_mov_b64 exec, -1
gemnet_accum_kernel_poka_3:
    s_cmp_ge_u32 s69, 8
    s_cbranch_scc0 gemnet_accum_kernel_h2san_6
    v_lshrrev_b32 v126, 8, v56
    v_and_b32 v126, 4092, v126
    ds_add_rtn_u32 v80, v126, v3 offset:3328
    v_lshrrev_b32 v126, 8, v58
    v_and_b32 v126, 4092, v126
    ds_add_rtn_u32 v81, v126, v3 offset:3328
    s_branch gemnet_accum_kernel_h2ean_6
gemnet_accum_kernel_h2san_6:
    s_cmp_gt_u32 s76, 6
    s_cbranch_scc0 gemnet_accum_kernel_hgan_6
    s_cmp_eq_u32 s77, 6
    s_cselect_b64 exec, s[78:79], -1
    v_lshrrev_b32 v126, 8, v56
    v_and_b32 v126, 4092, v126
    ds_add_rtn_u32 v80, v126, v3 offset:3328
    s_mov_b64 exec, -1
gemnet_accum_kernel_hgan_6:
    s_cmp_gt_u32 s76, 7
    s_cbranch_scc0 gemnet_accum_kernel_hgan_7
    s_cmp_eq_u32 s77, 7
    s_cselect_b64 exec, s[78:79], -1
    v_lshrrev_b32 v126, 8, v58
    v_and_b32 v126, 4092, v126
    ds_add_rtn_u32 v81, v126, v3 offset:3328
    s_mov_b64 exec, -1
gemnet_accum_kernel_hgan_7:
gemnet_accum_kernel_h2ean_6:
    s_movk_i32 s25, 2304
    v_add3_u32 v27, v26, v2, s25
    v_and_b32 v26, -4, v27
    v_cmp_ne_u32 s[40:41], v26, v27
gemnet_accum_kernel_fban_6:
    v_readlane_b32 s62, v127, 7
    v_readlane_b32 s63, v0, 7
    s_nop 1
    v_mbcnt_lo_u32_b32 v126, s62, 0
    v_mbcnt_hi_u32_b32 v126, s63, v126
    v_add_lshl_u32 v126, v126, s24, 2
    s_bcnt1_i32_b64 s65, s[62:63]
    ds_bpermute_b32 v28, v126, v89
    s_add_u32 s24, s24, s65
gemnet_accum_kernel_faan_7:
    s_cmp_ge_u32 s27, 10
    s_cbranch_scc0 gemnet_accum_kernel_taila_8
    s_setprio 1
    s_cmp_ge_u32 s27, 12
    s_cbranch_scc0 gemnet_accum_kernel_g2sa_4
    v_and_b32 v35, 0xffff8, v84
    buffer_load_dwordx2 v[40:41], v35, s[4:7], s23 offen
    v_and_b32 v35, 0xffff8, v85
    buffer_load_dwordx2 v[42:43], v35, s[4:7], s23 offen
    s_branch gemnet_accum_kernel_g2ea_4
gemnet_accum_kernel_g2sa_4:
    s_cmp_eq_u32 s27, 10
    s_cselect_b64 s[62:63], s[60:61], 1
    v_and_b32 v35, 0xffff8, v84
    s_cmp_gt_u32 s27, 10
    s_cselect_b64 exec, -1, s[62:63]
    buffer_load_dwordx2 v[40:41], v35, s[4:7], s23 offen
    s_mov_b64 exec, -1
    s_cmp_eq_u32 s27, 11
    s_cselect_b64 s[62:63], s[60:61], 1
    v_and_b32 v35, 0xffff8, v85
    s_cmp_gt_u32 s27, 11
    s_cselect_b64 exec, -1, s[62:63]
    buffer_load_dwordx2 v[42:43], v35, s[4:7], s23 offen
    s_mov_b64 exec, -1
gemnet_accum_kernel_g2ea_4:
    v_lshrrev_b32 v94, 16, v82
    v_lshrrev_b32 v110, 16, v83
    v_and_b32 v94, 0xfff0, v94
    v_and_b32 v110, 0xfff0, v110
    ds_read_b128 v[90:93], v94 offset:33760
    ds_read_b128 v[106:109], v110 offset:33760
    v_lshrrev_b32 v82, 1, v94
    v_lshrrev_b32 v83, 1, v110
    v_mul_f32 v94, s20, v30
    v_mul_f32 v110, s20, v31
    v_fract_f32 v94, v94
    v_fract_f32 v110, v110
    v_cos_f32 v94, v94
    v_cos_f32 v110, v110
    v_add_f32 v95, v94, v94
    v_add_f32 v111, v110, v110
    v_fma_f32 v95, v95, v94, -1.0
    v_fma_f32 v111, v111, v110, -1.0
    v_cvt_pk_bf16_f32 v95, v94, v95
    v_cvt_pk_bf16_f32 v111, v110, v111
    s_waitcnt vmcnt(2)
    v_mfma_f32_4x4x4_16b_bf16 v[96:99], v[122:123], v[36:37], 0
    v_mfma_f32_4x4x4_16b_bf16 v[112:115], v[122:123], v[38:39], 0
    s_waitcnt lgkmcnt(0)
    ds_read_b64 v[104:105], v82 offset:8752
    ds_read_b64 v[120:121], v83 offset:8752
    v_dot2_f32_bf16 v100, v90, v95, 0
    v_dot2_f32_bf16 v116, v106, v111, 0
    v_dot2_f32_bf16 v101, v91, v95, 0
    v_dot2_f32_bf16 v117, v107, v111, 0
    v_dot2_f32_bf16 v102, v92, v95, 0
    v_dot2_f32_bf16 v118, v108, v111, 0
    v_dot2_f32_bf16 v103, v93, v95, 0
    v_dot2_f32_bf16 v119, v109, v111, 0
    v_pk_mul_f32 v[96:97], v[96:97], v[100:101]
    v_pk_mul_f32 v[112:113], v[112:113], v[116:117]
    v_pk_mul_f32 v[98:99], v[98:99], v[102:103]
    v_pk_mul_f32 v[114:115], v[114:115], v[118:119]
    s_waitcnt lgkmcnt(0)
    s_nop 0
    v_mfma_f32_4x4x4_16b_bf16 v[100:103], v[124:125], v[104:105], v[96:99]
    v_mfma_f32_4x4x4_16b_bf16 v[116:119], v[124:125], v[120:121], v[112:115]
    s_nop 3
    v_cvt_pk_bf16_f32 v90, v100, v101
    v_cvt_pk_bf16_f32 v91, v102, v103
    ds_cmpst_rtn_b64 v[92:93], v82, v[104:105], v[90:91] offset:8752
    v_cvt_pk_bf16_f32 v106, v116, v117
    v_cvt_pk_bf16_f32 v107, v118, v119
    ds_cmpst_rtn_b64 v[108:109], v83, v[120:121], v[106:107] offset:8752
    s_waitcnt lgkmcnt(0)
    v_cmp_ne_u64 vcc, v[92:93], v[104:105]
    s_mov_b64 s[70:71], vcc
    v_cmp_ne_u64 vcc, v[108:109], v[120:121]
    s_mov_b64 s[90:91], vcc
    s_or_b64 s[62:63], s[70:71], vcc
    s_cbranch_scc0 gemnet_accum_kernel_poka_4
    s_bcnt1_i32_b64 s65, s[70:71]
    s_bcnt1_i32_b64 s66, s[90:91]
    s_add_u32 s65, s65, s66
    s_cmp_le_u32 s65, 6
    s_cbranch_scc1 gemnet_accum_kernel_ppka_4
gemnet_accum_kernel_prta_4:
    v_mfma_f32_4x4x4_16b_bf16 v[100:103], v[124:125], v[92:93], v[96:99]
    v_mfma_f32_4x4x4_16b_bf16 v[116:119], v[124:125], v[108:109], v[112:115]
    s_mov_b64 exec, s[70:71]
    s_nop 2
    v_cvt_pk_bf16_f32 v90, v100, v101
    v_cvt_pk_bf16_f32 v91, v102, v103
    ds_cmpst_rtn_b64 v[104:105], v82, v[92:93], v[90:91] offset:8752
    s_mov_b64 exec, s[90:91]
    v_cvt_pk_bf16_f32 v106, v116, v117
    v_cvt_pk_bf16_f32 v107, v118, v119
    ds_cmpst_rtn_b64 v[120:121], v83, v[108:109], v[106:107] offset:8752
    s_waitcnt lgkmcnt(0)
    v_cmp_ne_u64 vcc, v[108:109], v[120:121]
    s_mov_b64 s[90:91], vcc
    s_mov_b64 exec, s[70:71]
    v_cmp_ne_u64 vcc, v[92:93], v[104:105]
    s_mov_b64 s[70:71], vcc
    s_or_b64 s[62:63], s[90:91], vcc
    s_cbranch_scc0 gemnet_accum_kernel_pfina_4
gemnet_accum_kernel_ppka_4:
    s_mov_b64 exec, s[70:71]
    s_cbranch_execz gemnet_accum_kernel_pkaa_4
    v_cvt_pk_bf16_f32 v90, v96, v97
    v_cvt_pk_bf16_f32 v91, v98, v99
    ds_pk_add_bf16 v82, v90 offset:8752
    ds_pk_add_bf16 v82, v91 offset:8756
gemnet_accum_kernel_pkaa_4:
    s_mov_b64 exec, s[90:91]
    s_cbranch_execz gemnet_accum_kernel_pfina_4
    v_cvt_pk_bf16_f32 v106, v112, v113
    v_cvt_pk_bf16_f32 v107, v114, v115
    ds_pk_add_bf16 v83, v106 offset:8752
    ds_pk_add_bf16 v83, v107 offset:8756
gemnet_accum_kernel_pfina_4:
    s_mov_b64 exec, -1
gemnet_accum_kernel_poka_4:
    s_cmp_ge_u32 s69, 10
    s_cbranch_scc0 gemnet_accum_kernel_h2san_8
    v_lshrrev_b32 v126, 8, v60
    v_and_b32 v126, 4092, v126
    ds_add_rtn_u32 v82, v126, v3 offset:3328
    v_lshrrev_b32 v126, 8, v62
    v_and_b32 v126, 4092, v126
    ds_add_rtn_u32 v83, v126, v3 offset:3328
    s_branch gemnet_accum_kernel_h2ean_8
gemnet_accum_kernel_h2san_8:
    s_cmp_gt_u32 s76, 8
    s_cbranch_scc0 gemnet_accum_kernel_hgan_8
    s_cmp_eq_u32 s77, 8
    s_cselect_b64 exec, s[78:79], -1
    v_lshrrev_b32 v126, 8, v60
    v_and_b32 v126, 4092, v126
    ds_add_rtn_u32 v82, v126, v3 offset:3328
    s_mov_b64 exec, -1
gemnet_accum_kernel_hgan_8:
    s_cmp_gt_u32 s76, 9
    s_cbranch_scc0 gemnet_accum_kernel_hgan_9
    s_cmp_eq_u32 s77, 9
    s_cselect_b64 exec, s[78:79], -1
    v_lshrrev_b32 v126, 8, v62
    v_and_b32 v126, 4092, v126
    ds_add_rtn_u32 v83, v126, v3 offset:3328
    s_mov_b64 exec, -1
gemnet_accum_kernel_hgan_9:
gemnet_accum_kernel_h2ean_8:
    s_movk_i32 s25, 2688
    v_add3_u32 v29, v28, v2, s25
    v_and_b32 v28, -4, v29
    v_cmp_ne_u32 s[42:43], v28, v29
gemnet_accum_kernel_fban_7:
    v_readlane_b32 s62, v127, 8
    v_readlane_b32 s63, v0, 8
    s_nop 1
    v_mbcnt_lo_u32_b32 v126, s62, 0
    v_mbcnt_hi_u32_b32 v126, s63, v126
    v_add_lshl_u32 v126, v126, s24, 2
    s_bcnt1_i32_b64 s65, s[62:63]
    ds_bpermute_b32 v30, v126, v89
    s_add_u32 s24, s24, s65
gemnet_accum_kernel_faan_8:
    s_cmp_ge_u32 s27, 12
    s_cbranch_scc0 gemnet_accum_kernel_taila_10
    s_setprio 0
    s_cmp_eq_u32 s27, 12
    s_cselect_b64 s[62:63], s[60:61], 1
    v_and_b32 v35, 0xffff8, v86
    s_cmp_gt_u32 s27, 12
    s_cselect_b64 exec, -1, s[62:63]
    buffer_load_dwordx2 v[36:37], v35, s[4:7], s23 offen
    s_mov_b64 exec, -1
    v_lshrrev_b32 v94, 16, v84
    v_lshrrev_b32 v110, 16, v85
    v_and_b32 v94, 0xfff0, v94
    v_and_b32 v110, 0xfff0, v110
    ds_read_b128 v[90:93], v94 offset:33760
    ds_read_b128 v[106:109], v110 offset:33760
    v_lshrrev_b32 v84, 1, v94
    v_lshrrev_b32 v85, 1, v110
    v_mul_f32 v94, s20, v32
    v_mul_f32 v110, s20, v33
    v_fract_f32 v94, v94
    v_fract_f32 v110, v110
    v_cos_f32 v94, v94
    v_cos_f32 v110, v110
    v_add_f32 v95, v94, v94
    v_add_f32 v111, v110, v110
    v_fma_f32 v95, v95, v94, -1.0
    v_fma_f32 v111, v111, v110, -1.0
    v_cvt_pk_bf16_f32 v95, v94, v95
    v_cvt_pk_bf16_f32 v111, v110, v111
    s_waitcnt vmcnt(1)
    v_mfma_f32_4x4x4_16b_bf16 v[96:99], v[122:123], v[40:41], 0
    v_mfma_f32_4x4x4_16b_bf16 v[112:115], v[122:123], v[42:43], 0
    s_waitcnt lgkmcnt(0)
    ds_read_b64 v[104:105], v84 offset:8752
    ds_read_b64 v[120:121], v85 offset:8752
    v_dot2_f32_bf16 v100, v90, v95, 0
    v_dot2_f32_bf16 v116, v106, v111, 0
    v_dot2_f32_bf16 v101, v91, v95, 0
    v_dot2_f32_bf16 v117, v107, v111, 0
    v_dot2_f32_bf16 v102, v92, v95, 0
    v_dot2_f32_bf16 v118, v108, v111, 0
    v_dot2_f32_bf16 v103, v93, v95, 0
    v_dot2_f32_bf16 v119, v109, v111, 0
    v_pk_mul_f32 v[96:97], v[96:97], v[100:101]
    v_pk_mul_f32 v[112:113], v[112:113], v[116:117]
    v_pk_mul_f32 v[98:99], v[98:99], v[102:103]
    v_pk_mul_f32 v[114:115], v[114:115], v[118:119]
    s_waitcnt lgkmcnt(0)
    s_nop 0
    v_mfma_f32_4x4x4_16b_bf16 v[100:103], v[124:125], v[104:105], v[96:99]
    v_mfma_f32_4x4x4_16b_bf16 v[116:119], v[124:125], v[120:121], v[112:115]
    s_nop 3
    v_cvt_pk_bf16_f32 v90, v100, v101
    v_cvt_pk_bf16_f32 v91, v102, v103
    ds_cmpst_rtn_b64 v[92:93], v84, v[104:105], v[90:91] offset:8752
    v_cvt_pk_bf16_f32 v106, v116, v117
    v_cvt_pk_bf16_f32 v107, v118, v119
    ds_cmpst_rtn_b64 v[108:109], v85, v[120:121], v[106:107] offset:8752
    s_waitcnt lgkmcnt(0)
    v_cmp_ne_u64 vcc, v[92:93], v[104:105]
    s_mov_b64 s[70:71], vcc
    v_cmp_ne_u64 vcc, v[108:109], v[120:121]
    s_mov_b64 s[90:91], vcc
    s_or_b64 s[62:63], s[70:71], vcc
    s_cbranch_scc0 gemnet_accum_kernel_poka_5
    s_bcnt1_i32_b64 s65, s[70:71]
    s_bcnt1_i32_b64 s66, s[90:91]
    s_add_u32 s65, s65, s66
    s_cmp_le_u32 s65, 6
    s_cbranch_scc1 gemnet_accum_kernel_ppka_5
gemnet_accum_kernel_prta_5:
    v_mfma_f32_4x4x4_16b_bf16 v[100:103], v[124:125], v[92:93], v[96:99]
    v_mfma_f32_4x4x4_16b_bf16 v[116:119], v[124:125], v[108:109], v[112:115]
    s_mov_b64 exec, s[70:71]
    s_nop 2
    v_cvt_pk_bf16_f32 v90, v100, v101
    v_cvt_pk_bf16_f32 v91, v102, v103
    ds_cmpst_rtn_b64 v[104:105], v84, v[92:93], v[90:91] offset:8752
    s_mov_b64 exec, s[90:91]
    v_cvt_pk_bf16_f32 v106, v116, v117
    v_cvt_pk_bf16_f32 v107, v118, v119
    ds_cmpst_rtn_b64 v[120:121], v85, v[108:109], v[106:107] offset:8752
    s_waitcnt lgkmcnt(0)
    v_cmp_ne_u64 vcc, v[108:109], v[120:121]
    s_mov_b64 s[90:91], vcc
    s_mov_b64 exec, s[70:71]
    v_cmp_ne_u64 vcc, v[92:93], v[104:105]
    s_mov_b64 s[70:71], vcc
    s_or_b64 s[62:63], s[90:91], vcc
    s_cbranch_scc0 gemnet_accum_kernel_pfina_5
gemnet_accum_kernel_ppka_5:
    s_mov_b64 exec, s[70:71]
    s_cbranch_execz gemnet_accum_kernel_pkaa_5
    v_cvt_pk_bf16_f32 v90, v96, v97
    v_cvt_pk_bf16_f32 v91, v98, v99
    ds_pk_add_bf16 v84, v90 offset:8752
    ds_pk_add_bf16 v84, v91 offset:8756
gemnet_accum_kernel_pkaa_5:
    s_mov_b64 exec, s[90:91]
    s_cbranch_execz gemnet_accum_kernel_pfina_5
    v_cvt_pk_bf16_f32 v106, v112, v113
    v_cvt_pk_bf16_f32 v107, v114, v115
    ds_pk_add_bf16 v85, v106 offset:8752
    ds_pk_add_bf16 v85, v107 offset:8756
gemnet_accum_kernel_pfina_5:
    s_mov_b64 exec, -1
gemnet_accum_kernel_poka_5:
    s_cmp_ge_u32 s69, 12
    s_cbranch_scc0 gemnet_accum_kernel_h2san_10
    v_lshrrev_b32 v126, 8, v64
    v_and_b32 v126, 4092, v126
    ds_add_rtn_u32 v84, v126, v3 offset:3328
    v_lshrrev_b32 v126, 8, v66
    v_and_b32 v126, 4092, v126
    ds_add_rtn_u32 v85, v126, v3 offset:3328
    s_branch gemnet_accum_kernel_h2ean_10
gemnet_accum_kernel_h2san_10:
    s_cmp_gt_u32 s76, 10
    s_cbranch_scc0 gemnet_accum_kernel_hgan_10
    s_cmp_eq_u32 s77, 10
    s_cselect_b64 exec, s[78:79], -1
    v_lshrrev_b32 v126, 8, v64
    v_and_b32 v126, 4092, v126
    ds_add_rtn_u32 v84, v126, v3 offset:3328
    s_mov_b64 exec, -1
gemnet_accum_kernel_hgan_10:
    s_cmp_gt_u32 s76, 11
    s_cbranch_scc0 gemnet_accum_kernel_hgan_11
    s_cmp_eq_u32 s77, 11
    s_cselect_b64 exec, s[78:79], -1
    v_lshrrev_b32 v126, 8, v66
    v_and_b32 v126, 4092, v126
    ds_add_rtn_u32 v85, v126, v3 offset:3328
    s_mov_b64 exec, -1
gemnet_accum_kernel_hgan_11:
gemnet_accum_kernel_h2ean_10:
    s_movk_i32 s25, 3072
    v_add3_u32 v31, v30, v2, s25
    v_and_b32 v30, -4, v31
    v_cmp_ne_u32 s[44:45], v30, v31
gemnet_accum_kernel_fban_8:
    v_readlane_b32 s62, v127, 9
    v_readlane_b32 s63, v0, 9
    s_nop 1
    v_mbcnt_lo_u32_b32 v126, s62, 0
    v_mbcnt_hi_u32_b32 v126, s63, v126
    v_add_lshl_u32 v126, v126, s24, 2
    s_bcnt1_i32_b64 s65, s[62:63]
    ds_bpermute_b32 v32, v126, v89
    s_add_u32 s24, s24, s65
gemnet_accum_kernel_faan_9:
    s_cmp_gt_u32 s80, 12
    s_cbranch_scc0 gemnet_accum_kernel_nolasta
    s_cmp_gt_u32 s27, 12
    s_cselect_b64 exec, -1, s[58:59]
    v_lshrrev_b32 v94, 16, v86
    v_and_b32 v94, 0xfff0, v94
    ds_read_b128 v[90:93], v94 offset:33760
    v_lshrrev_b32 v86, 1, v94
    v_mul_f32 v94, s20, v34
    v_fract_f32 v94, v94
    v_cos_f32 v94, v94
    s_nop 0
    v_add_f32 v95, v94, v94
    v_fma_f32 v95, v95, v94, -1.0
    v_cvt_pk_bf16_f32 v95, v94, v95
    s_waitcnt vmcnt(0)
    v_mfma_f32_4x4x4_16b_bf16 v[96:99], v[122:123], v[36:37], 0
    s_waitcnt lgkmcnt(0)
    v_dot2_f32_bf16 v100, v90, v95, 0
    v_dot2_f32_bf16 v101, v91, v95, 0
    v_dot2_f32_bf16 v102, v92, v95, 0
    v_dot2_f32_bf16 v103, v93, v95, 0
    s_nop 2
    v_pk_mul_f32 v[96:97], v[96:97], v[100:101]
    v_pk_mul_f32 v[98:99], v[98:99], v[102:103]
    ds_read_b64 v[104:105], v86 offset:8752
    s_waitcnt lgkmcnt(0)
    s_nop 1
    v_mfma_f32_4x4x4_16b_bf16 v[100:103], v[124:125], v[104:105], v[96:99]
    s_nop 4
    v_cvt_pk_bf16_f32 v90, v100, v101
    v_cvt_pk_bf16_f32 v91, v102, v103
    ds_cmpst_rtn_b64 v[92:93], v86, v[104:105], v[90:91] offset:8752
    s_waitcnt lgkmcnt(0)
    v_cmp_ne_u64 vcc, v[92:93], v[104:105]
    v_mov_b32 v104, v92
    v_mov_b32 v105, v93
    s_and_b64 exec, exec, vcc
    s_cbranch_execz gemnet_accum_kernel_sgea_last
    s_nop 1
    v_mfma_f32_4x4x4_16b_bf16 v[100:103], v[124:125], v[104:105], v[96:99]
    s_nop 4
    v_cvt_pk_bf16_f32 v90, v100, v101
    v_cvt_pk_bf16_f32 v91, v102, v103
    ds_cmpst_rtn_b64 v[92:93], v86, v[104:105], v[90:91] offset:8752
    s_waitcnt lgkmcnt(0)
    v_cmp_ne_u64 vcc, v[92:93], v[104:105]
    v_mov_b32 v104, v92
    v_mov_b32 v105, v93
    s_and_b64 exec, exec, vcc
    s_cbranch_execz gemnet_accum_kernel_sgea_last
    v_cvt_pk_bf16_f32 v90, v96, v97
    v_cvt_pk_bf16_f32 v91, v98, v99
    ds_pk_add_bf16 v86, v90 offset:8752
    ds_pk_add_bf16 v86, v91 offset:8756
gemnet_accum_kernel_sgea_last:
gemnet_accum_kernel_nolasta:
    s_mov_b64 exec, -1
    s_cmp_gt_u32 s76, 12
    s_cbranch_scc0 gemnet_accum_kernel_hgan_12
    s_cmp_eq_u32 s77, 12
    s_cselect_b64 exec, s[78:79], -1
    v_lshrrev_b32 v126, 8, v68
    v_and_b32 v126, 4092, v126
    ds_add_rtn_u32 v86, v126, v3 offset:3328
    s_mov_b64 exec, -1
gemnet_accum_kernel_hgan_12:
    s_branch gemnet_accum_kernel_pda
gemnet_accum_kernel_taila_0:
    s_mov_b64 exec, -1
    s_waitcnt vmcnt(0)
    s_cmp_gt_u32 s80, 0
    s_cbranch_scc0 gemnet_accum_kernel_tskipa_0
    s_cmp_gt_u32 s27, 0
    s_cselect_b64 exec, -1, s[58:59]
    v_and_b32 v35, 0xffff8, v74
    buffer_load_dwordx2 v[36:37], v35, s[4:7], s23 offen
    v_lshrrev_b32 v94, 16, v74
    v_and_b32 v94, 0xfff0, v94
    ds_read_b128 v[90:93], v94 offset:33760
    v_lshrrev_b32 v74, 1, v94
    v_mul_f32 v94, s20, v22
    v_fract_f32 v94, v94
    v_cos_f32 v94, v94
    s_nop 0
    v_add_f32 v95, v94, v94
    v_fma_f32 v95, v95, v94, -1.0
    v_cvt_pk_bf16_f32 v95, v94, v95
    s_waitcnt vmcnt(0)
    v_mfma_f32_4x4x4_16b_bf16 v[96:99], v[122:123], v[36:37], 0
    s_waitcnt lgkmcnt(0)
    v_dot2_f32_bf16 v100, v90, v95, 0
    v_dot2_f32_bf16 v101, v91, v95, 0
    v_dot2_f32_bf16 v102, v92, v95, 0
    v_dot2_f32_bf16 v103, v93, v95, 0
    s_nop 2
    v_pk_mul_f32 v[96:97], v[96:97], v[100:101]
    v_pk_mul_f32 v[98:99], v[98:99], v[102:103]
    ds_read_b64 v[104:105], v74 offset:8752
    s_waitcnt lgkmcnt(0)
gemnet_accum_kernel_sga_t0:
    s_nop 1
    v_mfma_f32_4x4x4_16b_bf16 v[100:103], v[124:125], v[104:105], v[96:99]
    s_nop 4
    v_cvt_pk_bf16_f32 v90, v100, v101
    v_cvt_pk_bf16_f32 v91, v102, v103
    ds_cmpst_rtn_b64 v[92:93], v74, v[104:105], v[90:91] offset:8752
    s_waitcnt lgkmcnt(0)
    v_cmp_ne_u64 vcc, v[92:93], v[104:105]
    v_mov_b32 v104, v92
    v_mov_b32 v105, v93
    s_and_b64 exec, exec, vcc
    s_cbranch_execnz gemnet_accum_kernel_sga_t0
gemnet_accum_kernel_tskipa_0:
    s_mov_b64 exec, -1
    s_mov_b64 exec, -1
    s_waitcnt vmcnt(0)
    s_cmp_gt_u32 s80, 1
    s_cbranch_scc0 gemnet_accum_kernel_tskipa_1
    s_cmp_gt_u32 s27, 1
    s_cselect_b64 exec, -1, s[58:59]
    v_and_b32 v35, 0xffff8, v75
    buffer_load_dwordx2 v[38:39], v35, s[4:7], s23 offen
    v_lshrrev_b32 v94, 16, v75
    v_and_b32 v94, 0xfff0, v94
    ds_read_b128 v[90:93], v94 offset:33760
    v_lshrrev_b32 v75, 1, v94
    v_mul_f32 v94, s20, v23
    v_fract_f32 v94, v94
    v_cos_f32 v94, v94
    s_nop 0
    v_add_f32 v95, v94, v94
    v_fma_f32 v95, v95, v94, -1.0
    v_cvt_pk_bf16_f32 v95, v94, v95
    s_waitcnt vmcnt(0)
    v_mfma_f32_4x4x4_16b_bf16 v[96:99], v[122:123], v[38:39], 0
    s_waitcnt lgkmcnt(0)
    v_dot2_f32_bf16 v100, v90, v95, 0
    v_dot2_f32_bf16 v101, v91, v95, 0
    v_dot2_f32_bf16 v102, v92, v95, 0
    v_dot2_f32_bf16 v103, v93, v95, 0
    s_nop 2
    v_pk_mul_f32 v[96:97], v[96:97], v[100:101]
    v_pk_mul_f32 v[98:99], v[98:99], v[102:103]
    ds_read_b64 v[104:105], v75 offset:8752
    s_waitcnt lgkmcnt(0)
gemnet_accum_kernel_sga_t1:
    s_nop 1
    v_mfma_f32_4x4x4_16b_bf16 v[100:103], v[124:125], v[104:105], v[96:99]
    s_nop 4
    v_cvt_pk_bf16_f32 v90, v100, v101
    v_cvt_pk_bf16_f32 v91, v102, v103
    ds_cmpst_rtn_b64 v[92:93], v75, v[104:105], v[90:91] offset:8752
    s_waitcnt lgkmcnt(0)
    v_cmp_ne_u64 vcc, v[92:93], v[104:105]
    v_mov_b32 v104, v92
    v_mov_b32 v105, v93
    s_and_b64 exec, exec, vcc
    s_cbranch_execnz gemnet_accum_kernel_sga_t1
gemnet_accum_kernel_tskipa_1:
    s_mov_b64 exec, -1
    s_waitcnt lgkmcnt(0)
    v_lshrrev_b32 v126, 16, v44
    v_cndmask_b32 v44, v44, v45, s[28:29]
    v_cndmask_b32 v45, v45, v126, s[28:29]
    v_lshrrev_b32 v126, 16, v46
    v_cndmask_b32 v46, v46, v47, s[30:31]
    v_cndmask_b32 v47, v47, v126, s[30:31]
    v_lshrrev_b32 v126, 16, v48
    v_cndmask_b32 v48, v48, v49, s[32:33]
    v_cndmask_b32 v49, v49, v126, s[32:33]
    v_lshrrev_b32 v126, 16, v50
    v_cndmask_b32 v50, v50, v51, s[34:35]
    v_cndmask_b32 v51, v51, v126, s[34:35]
    v_lshrrev_b32 v126, 16, v52
    v_cndmask_b32 v52, v52, v53, s[36:37]
    v_cndmask_b32 v53, v53, v126, s[36:37]
    v_lshrrev_b32 v126, 16, v54
    v_cndmask_b32 v54, v54, v55, s[38:39]
    v_cndmask_b32 v55, v55, v126, s[38:39]
    v_lshrrev_b32 v126, 16, v56
    v_cndmask_b32 v56, v56, v57, s[40:41]
    v_cndmask_b32 v57, v57, v126, s[40:41]
    v_lshrrev_b32 v126, 16, v58
    v_cndmask_b32 v58, v58, v59, s[42:43]
    v_cndmask_b32 v59, v59, v126, s[42:43]
    v_lshrrev_b32 v126, 16, v60
    v_cndmask_b32 v60, v60, v61, s[44:45]
    v_cndmask_b32 v61, v61, v126, s[44:45]
    v_lshrrev_b32 v126, 16, v62
    v_cndmask_b32 v62, v62, v63, s[46:47]
    v_cndmask_b32 v63, v63, v126, s[46:47]
    v_lshrrev_b32 v126, 16, v64
    v_cndmask_b32 v64, v64, v65, s[48:49]
    v_cndmask_b32 v65, v65, v126, s[48:49]
    v_lshrrev_b32 v126, 16, v66
    v_cndmask_b32 v66, v66, v67, s[50:51]
    v_cndmask_b32 v67, v67, v126, s[50:51]
    v_lshrrev_b32 v126, 16, v68
    v_cndmask_b32 v68, v68, v69, s[52:53]
    v_cndmask_b32 v69, v69, v126, s[52:53]
    s_cmp_gt_u32 s76, 13
    s_cbranch_scc0 gemnet_accum_kernel_decat
    v_lshrrev_b32 v126, 16, v70
    v_cndmask_b32 v70, v70, v71, s[54:55]
    v_cndmask_b32 v71, v71, v126, s[54:55]
    s_cmp_gt_u32 s76, 14
    s_cbranch_scc0 gemnet_accum_kernel_decat
    v_lshrrev_b32 v126, 16, v72
    v_cndmask_b32 v72, v72, v73, s[56:57]
    v_cndmask_b32 v73, v73, v126, s[56:57]
gemnet_accum_kernel_decat:
    s_cmp_ge_u32 s69, 2
    s_cbranch_scc0 gemnet_accum_kernel_h2sat_0
    v_lshrrev_b32 v126, 8, v44
    v_and_b32 v126, 4092, v126
    ds_add_rtn_u32 v74, v126, v3 offset:3328
    v_lshrrev_b32 v126, 8, v46
    v_and_b32 v126, 4092, v126
    ds_add_rtn_u32 v75, v126, v3 offset:3328
    s_branch gemnet_accum_kernel_h2eat_0
gemnet_accum_kernel_h2sat_0:
    s_cmp_gt_u32 s76, 0
    s_cbranch_scc0 gemnet_accum_kernel_hgat_0
    s_cmp_eq_u32 s77, 0
    s_cselect_b64 exec, s[78:79], -1
    v_lshrrev_b32 v126, 8, v44
    v_and_b32 v126, 4092, v126
    ds_add_rtn_u32 v74, v126, v3 offset:3328
    s_mov_b64 exec, -1
gemnet_accum_kernel_hgat_0:
    s_cmp_gt_u32 s76, 1
    s_cbranch_scc0 gemnet_accum_kernel_hgat_1
    s_cmp_eq_u32 s77, 1
    s_cselect_b64 exec, s[78:79], -1
    v_lshrrev_b32 v126, 8, v46
    v_and_b32 v126, 4092, v126
    ds_add_rtn_u32 v75, v126, v3 offset:3328
    s_mov_b64 exec, -1
gemnet_accum_kernel_hgat_1:
gemnet_accum_kernel_h2eat_0:
    v_readlane_b32 s62, v127, 0
    v_readlane_b32 s63, v0, 0
    s_nop 1
    v_mbcnt_lo_u32_b32 v126, s62, 0
    v_mbcnt_hi_u32_b32 v126, s63, v126
    v_add_lshl_u32 v126, v126, s24, 2
    s_bcnt1_i32_b64 s65, s[62:63]
    ds_bpermute_b32 v14, v126, v89
    s_add_u32 s24, s24, s65
gemnet_accum_kernel_faat_0:
    v_readlane_b32 s62, v127, 1
    v_readlane_b32 s63, v0, 1
    s_nop 1
    v_mbcnt_lo_u32_b32 v126, s62, 0
    v_mbcnt_hi_u32_b32 v126, s63, v126
    v_add_lshl_u32 v126, v126, s24, 2
    s_bcnt1_i32_b64 s65, s[62:63]
    ds_bpermute_b32 v16, v126, v89
    s_add_u32 s24, s24, s65
gemnet_accum_kernel_faat_1:
    v_readlane_b32 s62, v127, 2
    v_readlane_b32 s63, v0, 2
    s_nop 1
    v_mbcnt_lo_u32_b32 v126, s62, 0
    v_mbcnt_hi_u32_b32 v126, s63, v126
    v_add_lshl_u32 v126, v126, s24, 2
    s_bcnt1_i32_b64 s65, s[62:63]
    ds_bpermute_b32 v18, v126, v89
    s_add_u32 s24, s24, s65
gemnet_accum_kernel_faat_2:
    v_readlane_b32 s62, v127, 3
    v_readlane_b32 s63, v0, 3
    s_nop 1
    v_mbcnt_lo_u32_b32 v126, s62, 0
    v_mbcnt_hi_u32_b32 v126, s63, v126
    v_add_lshl_u32 v126, v126, s24, 2
    s_bcnt1_i32_b64 s65, s[62:63]
    ds_bpermute_b32 v20, v126, v89
    s_add_u32 s24, s24, s65
gemnet_accum_kernel_faat_3:
    v_readlane_b32 s62, v127, 4
    v_readlane_b32 s63, v0, 4
    s_nop 1
    v_mbcnt_lo_u32_b32 v126, s62, 0
    v_mbcnt_hi_u32_b32 v126, s63, v126
    v_add_lshl_u32 v126, v126, s24, 2
    s_bcnt1_i32_b64 s65, s[62:63]
    ds_bpermute_b32 v22, v126, v89
    s_add_u32 s24, s24, s65
gemnet_accum_kernel_faat_4:
gemnet_accum_kernel_taila_2:
    s_mov_b64 exec, -1
    s_waitcnt vmcnt(0)
    s_cmp_gt_u32 s80, 2
    s_cbranch_scc0 gemnet_accum_kernel_tskipa_2
    s_cmp_gt_u32 s27, 2
    s_cselect_b64 exec, -1, s[58:59]
    v_and_b32 v35, 0xffff8, v76
    buffer_load_dwordx2 v[40:41], v35, s[4:7], s23 offen
    v_lshrrev_b32 v94, 16, v76
    v_and_b32 v94, 0xfff0, v94
    ds_read_b128 v[90:93], v94 offset:33760
    v_lshrrev_b32 v76, 1, v94
    v_mul_f32 v94, s20, v24
    v_fract_f32 v94, v94
    v_cos_f32 v94, v94
    s_nop 0
    v_add_f32 v95, v94, v94
    v_fma_f32 v95, v95, v94, -1.0
    v_cvt_pk_bf16_f32 v95, v94, v95
    s_waitcnt vmcnt(0)
    v_mfma_f32_4x4x4_16b_bf16 v[96:99], v[122:123], v[40:41], 0
    s_waitcnt lgkmcnt(0)
    v_dot2_f32_bf16 v100, v90, v95, 0
    v_dot2_f32_bf16 v101, v91, v95, 0
    v_dot2_f32_bf16 v102, v92, v95, 0
    v_dot2_f32_bf16 v103, v93, v95, 0
    s_nop 2
    v_pk_mul_f32 v[96:97], v[96:97], v[100:101]
    v_pk_mul_f32 v[98:99], v[98:99], v[102:103]
    ds_read_b64 v[104:105], v76 offset:8752
    s_waitcnt lgkmcnt(0)
gemnet_accum_kernel_sga_t2:
    s_nop 1
    v_mfma_f32_4x4x4_16b_bf16 v[100:103], v[124:125], v[104:105], v[96:99]
    s_nop 4
    v_cvt_pk_bf16_f32 v90, v100, v101
    v_cvt_pk_bf16_f32 v91, v102, v103
    ds_cmpst_rtn_b64 v[92:93], v76, v[104:105], v[90:91] offset:8752
    s_waitcnt lgkmcnt(0)
    v_cmp_ne_u64 vcc, v[92:93], v[104:105]
    v_mov_b32 v104, v92
    v_mov_b32 v105, v93
    s_and_b64 exec, exec, vcc
    s_cbranch_execnz gemnet_accum_kernel_sga_t2
gemnet_accum_kernel_tskipa_2:
    s_mov_b64 exec, -1
    s_mov_b64 exec, -1
    s_waitcnt vmcnt(0)
    s_cmp_gt_u32 s80, 3
    s_cbranch_scc0 gemnet_accum_kernel_tskipa_3
    s_cmp_gt_u32 s27, 3
    s_cselect_b64 exec, -1, s[58:59]
    v_and_b32 v35, 0xffff8, v77
    buffer_load_dwordx2 v[42:43], v35, s[4:7], s23 offen
    v_lshrrev_b32 v94, 16, v77
    v_and_b32 v94, 0xfff0, v94
    ds_read_b128 v[90:93], v94 offset:33760
    v_lshrrev_b32 v77, 1, v94
    v_mul_f32 v94, s20, v25
    v_fract_f32 v94, v94
    v_cos_f32 v94, v94
    s_nop 0
    v_add_f32 v95, v94, v94
    v_fma_f32 v95, v95, v94, -1.0
    v_cvt_pk_bf16_f32 v95, v94, v95
    s_waitcnt vmcnt(0)
    v_mfma_f32_4x4x4_16b_bf16 v[96:99], v[122:123], v[42:43], 0
    s_waitcnt lgkmcnt(0)
    v_dot2_f32_bf16 v100, v90, v95, 0
    v_dot2_f32_bf16 v101, v91, v95, 0
    v_dot2_f32_bf16 v102, v92, v95, 0
    v_dot2_f32_bf16 v103, v93, v95, 0
    s_nop 2
    v_pk_mul_f32 v[96:97], v[96:97], v[100:101]
    v_pk_mul_f32 v[98:99], v[98:99], v[102:103]
    ds_read_b64 v[104:105], v77 offset:8752
    s_waitcnt lgkmcnt(0)
gemnet_accum_kernel_sga_t3:
    s_nop 1
    v_mfma_f32_4x4x4_16b_bf16 v[100:103], v[124:125], v[104:105], v[96:99]
    s_nop 4
    v_cvt_pk_bf16_f32 v90, v100, v101
    v_cvt_pk_bf16_f32 v91, v102, v103
    ds_cmpst_rtn_b64 v[92:93], v77, v[104:105], v[90:91] offset:8752
    s_waitcnt lgkmcnt(0)
    v_cmp_ne_u64 vcc, v[92:93], v[104:105]
    v_mov_b32 v104, v92
    v_mov_b32 v105, v93
    s_and_b64 exec, exec, vcc
    s_cbranch_execnz gemnet_accum_kernel_sga_t3
gemnet_accum_kernel_tskipa_3:
    s_mov_b64 exec, -1
    s_waitcnt lgkmcnt(0)
    s_cmp_ge_u32 s69, 4
    s_cbranch_scc0 gemnet_accum_kernel_h2sat_2
    v_lshrrev_b32 v126, 8, v48
    v_and_b32 v126, 4092, v126
    ds_add_rtn_u32 v76, v126, v3 offset:3328
    v_lshrrev_b32 v126, 8, v50
    v_and_b32 v126, 4092, v126
    ds_add_rtn_u32 v77, v126, v3 offset:3328
    s_branch gemnet_accum_kernel_h2eat_2
gemnet_accum_kernel_h2sat_2:
    s_cmp_gt_u32 s76, 2
    s_cbranch_scc0 gemnet_accum_kernel_hgat_2
    s_cmp_eq_u32 s77, 2
    s_cselect_b64 exec, s[78:79], -1
    v_lshrrev_b32 v126, 8, v48
    v_and_b32 v126, 4092, v126
    ds_add_rtn_u32 v76, v126, v3 offset:3328
    s_mov_b64 exec, -1
gemnet_accum_kernel_hgat_2:
    s_cmp_gt_u32 s76, 3
    s_cbranch_scc0 gemnet_accum_kernel_hgat_3
    s_cmp_eq_u32 s77, 3
    s_cselect_b64 exec, s[78:79], -1
    v_lshrrev_b32 v126, 8, v50
    v_and_b32 v126, 4092, v126
    ds_add_rtn_u32 v77, v126, v3 offset:3328
    s_mov_b64 exec, -1
gemnet_accum_kernel_hgat_3:
gemnet_accum_kernel_h2eat_2:
    s_movk_i32 s25, 0
    v_add3_u32 v15, v14, v2, s25
    v_and_b32 v14, -4, v15
    v_cmp_ne_u32 s[28:29], v14, v15
gemnet_accum_kernel_fbat_0:
    s_movk_i32 s25, 384
    v_add3_u32 v17, v16, v2, s25
    v_and_b32 v16, -4, v17
    v_cmp_ne_u32 s[30:31], v16, v17
gemnet_accum_kernel_fbat_1:
    s_movk_i32 s25, 768
    v_add3_u32 v19, v18, v2, s25
    v_and_b32 v18, -4, v19
    v_cmp_ne_u32 s[32:33], v18, v19
gemnet_accum_kernel_fbat_2:
    s_movk_i32 s25, 1152
    v_add3_u32 v21, v20, v2, s25
    v_and_b32 v20, -4, v21
    v_cmp_ne_u32 s[34:35], v20, v21
gemnet_accum_kernel_fbat_3:
    s_movk_i32 s25, 1536
    v_add3_u32 v23, v22, v2, s25
    v_and_b32 v22, -4, v23
    v_cmp_ne_u32 s[36:37], v22, v23
gemnet_accum_kernel_fbat_4:
    v_readlane_b32 s62, v127, 5
    v_readlane_b32 s63, v0, 5
    s_nop 1
    v_mbcnt_lo_u32_b32 v126, s62, 0
    v_mbcnt_hi_u32_b32 v126, s63, v126
    v_add_lshl_u32 v126, v126, s24, 2
    s_bcnt1_i32_b64 s65, s[62:63]
    ds_bpermute_b32 v24, v126, v89
    s_add_u32 s24, s24, s65
gemnet_accum_kernel_faat_5:
gemnet_accum_kernel_taila_4:
    s_mov_b64 exec, -1
    s_waitcnt vmcnt(0)
    s_cmp_gt_u32 s80, 4
    s_cbranch_scc0 gemnet_accum_kernel_tskipa_4
    s_cmp_gt_u32 s27, 4
    s_cselect_b64 exec, -1, s[58:59]
    v_and_b32 v35, 0xffff8, v78
    buffer_load_dwordx2 v[36:37], v35, s[4:7], s23 offen
    v_lshrrev_b32 v94, 16, v78
    v_and_b32 v94, 0xfff0, v94
    ds_read_b128 v[90:93], v94 offset:33760
    v_lshrrev_b32 v78, 1, v94
    v_mul_f32 v94, s20, v26
    v_fract_f32 v94, v94
    v_cos_f32 v94, v94
    s_nop 0
    v_add_f32 v95, v94, v94
    v_fma_f32 v95, v95, v94, -1.0
    v_cvt_pk_bf16_f32 v95, v94, v95
    s_waitcnt vmcnt(0)
    v_mfma_f32_4x4x4_16b_bf16 v[96:99], v[122:123], v[36:37], 0
    s_waitcnt lgkmcnt(0)
    v_dot2_f32_bf16 v100, v90, v95, 0
    v_dot2_f32_bf16 v101, v91, v95, 0
    v_dot2_f32_bf16 v102, v92, v95, 0
    v_dot2_f32_bf16 v103, v93, v95, 0
    s_nop 2
    v_pk_mul_f32 v[96:97], v[96:97], v[100:101]
    v_pk_mul_f32 v[98:99], v[98:99], v[102:103]
    ds_read_b64 v[104:105], v78 offset:8752
    s_waitcnt lgkmcnt(0)
gemnet_accum_kernel_sga_t4:
    s_nop 1
    v_mfma_f32_4x4x4_16b_bf16 v[100:103], v[124:125], v[104:105], v[96:99]
    s_nop 4
    v_cvt_pk_bf16_f32 v90, v100, v101
    v_cvt_pk_bf16_f32 v91, v102, v103
    ds_cmpst_rtn_b64 v[92:93], v78, v[104:105], v[90:91] offset:8752
    s_waitcnt lgkmcnt(0)
    v_cmp_ne_u64 vcc, v[92:93], v[104:105]
    v_mov_b32 v104, v92
    v_mov_b32 v105, v93
    s_and_b64 exec, exec, vcc
    s_cbranch_execnz gemnet_accum_kernel_sga_t4
gemnet_accum_kernel_tskipa_4:
    s_mov_b64 exec, -1
    s_mov_b64 exec, -1
    s_waitcnt vmcnt(0)
    s_cmp_gt_u32 s80, 5
    s_cbranch_scc0 gemnet_accum_kernel_tskipa_5
    s_cmp_gt_u32 s27, 5
    s_cselect_b64 exec, -1, s[58:59]
    v_and_b32 v35, 0xffff8, v79
    buffer_load_dwordx2 v[38:39], v35, s[4:7], s23 offen
    v_lshrrev_b32 v94, 16, v79
    v_and_b32 v94, 0xfff0, v94
    ds_read_b128 v[90:93], v94 offset:33760
    v_lshrrev_b32 v79, 1, v94
    v_mul_f32 v94, s20, v27
    v_fract_f32 v94, v94
    v_cos_f32 v94, v94
    s_nop 0
    v_add_f32 v95, v94, v94
    v_fma_f32 v95, v95, v94, -1.0
    v_cvt_pk_bf16_f32 v95, v94, v95
    s_waitcnt vmcnt(0)
    v_mfma_f32_4x4x4_16b_bf16 v[96:99], v[122:123], v[38:39], 0
    s_waitcnt lgkmcnt(0)
    v_dot2_f32_bf16 v100, v90, v95, 0
    v_dot2_f32_bf16 v101, v91, v95, 0
    v_dot2_f32_bf16 v102, v92, v95, 0
    v_dot2_f32_bf16 v103, v93, v95, 0
    s_nop 2
    v_pk_mul_f32 v[96:97], v[96:97], v[100:101]
    v_pk_mul_f32 v[98:99], v[98:99], v[102:103]
    ds_read_b64 v[104:105], v79 offset:8752
    s_waitcnt lgkmcnt(0)
gemnet_accum_kernel_sga_t5:
    s_nop 1
    v_mfma_f32_4x4x4_16b_bf16 v[100:103], v[124:125], v[104:105], v[96:99]
    s_nop 4
    v_cvt_pk_bf16_f32 v90, v100, v101
    v_cvt_pk_bf16_f32 v91, v102, v103
    ds_cmpst_rtn_b64 v[92:93], v79, v[104:105], v[90:91] offset:8752
    s_waitcnt lgkmcnt(0)
    v_cmp_ne_u64 vcc, v[92:93], v[104:105]
    v_mov_b32 v104, v92
    v_mov_b32 v105, v93
    s_and_b64 exec, exec, vcc
    s_cbranch_execnz gemnet_accum_kernel_sga_t5
gemnet_accum_kernel_tskipa_5:
    s_mov_b64 exec, -1
    s_waitcnt lgkmcnt(0)
    s_cmp_ge_u32 s69, 6
    s_cbranch_scc0 gemnet_accum_kernel_h2sat_4
    v_lshrrev_b32 v126, 8, v52
    v_and_b32 v126, 4092, v126
    ds_add_rtn_u32 v78, v126, v3 offset:3328
    v_lshrrev_b32 v126, 8, v54
    v_and_b32 v126, 4092, v126
    ds_add_rtn_u32 v79, v126, v3 offset:3328
    s_branch gemnet_accum_kernel_h2eat_4
gemnet_accum_kernel_h2sat_4:
    s_cmp_gt_u32 s76, 4
    s_cbranch_scc0 gemnet_accum_kernel_hgat_4
    s_cmp_eq_u32 s77, 4
    s_cselect_b64 exec, s[78:79], -1
    v_lshrrev_b32 v126, 8, v52
    v_and_b32 v126, 4092, v126
    ds_add_rtn_u32 v78, v126, v3 offset:3328
    s_mov_b64 exec, -1
gemnet_accum_kernel_hgat_4:
    s_cmp_gt_u32 s76, 5
    s_cbranch_scc0 gemnet_accum_kernel_hgat_5
    s_cmp_eq_u32 s77, 5
    s_cselect_b64 exec, s[78:79], -1
    v_lshrrev_b32 v126, 8, v54
    v_and_b32 v126, 4092, v126
    ds_add_rtn_u32 v79, v126, v3 offset:3328
    s_mov_b64 exec, -1
gemnet_accum_kernel_hgat_5:
gemnet_accum_kernel_h2eat_4:
    s_movk_i32 s25, 1920
    v_add3_u32 v25, v24, v2, s25
    v_and_b32 v24, -4, v25
    v_cmp_ne_u32 s[38:39], v24, v25
gemnet_accum_kernel_fbat_5:
    v_readlane_b32 s62, v127, 6
    v_readlane_b32 s63, v0, 6
    s_nop 1
    v_mbcnt_lo_u32_b32 v126, s62, 0
    v_mbcnt_hi_u32_b32 v126, s63, v126
    v_add_lshl_u32 v126, v126, s24, 2
    s_bcnt1_i32_b64 s65, s[62:63]
    ds_bpermute_b32 v26, v126, v89
    s_add_u32 s24, s24, s65
gemnet_accum_kernel_faat_6:
gemnet_accum_kernel_taila_6:
    s_mov_b64 exec, -1
    s_waitcnt vmcnt(0)
    s_cmp_gt_u32 s80, 6
    s_cbranch_scc0 gemnet_accum_kernel_tskipa_6
    s_cmp_gt_u32 s27, 6
    s_cselect_b64 exec, -1, s[58:59]
    v_and_b32 v35, 0xffff8, v80
    buffer_load_dwordx2 v[40:41], v35, s[4:7], s23 offen
    v_lshrrev_b32 v94, 16, v80
    v_and_b32 v94, 0xfff0, v94
    ds_read_b128 v[90:93], v94 offset:33760
    v_lshrrev_b32 v80, 1, v94
    v_mul_f32 v94, s20, v28
    v_fract_f32 v94, v94
    v_cos_f32 v94, v94
    s_nop 0
    v_add_f32 v95, v94, v94
    v_fma_f32 v95, v95, v94, -1.0
    v_cvt_pk_bf16_f32 v95, v94, v95
    s_waitcnt vmcnt(0)
    v_mfma_f32_4x4x4_16b_bf16 v[96:99], v[122:123], v[40:41], 0
    s_waitcnt lgkmcnt(0)
    v_dot2_f32_bf16 v100, v90, v95, 0
    v_dot2_f32_bf16 v101, v91, v95, 0
    v_dot2_f32_bf16 v102, v92, v95, 0
    v_dot2_f32_bf16 v103, v93, v95, 0
    s_nop 2
    v_pk_mul_f32 v[96:97], v[96:97], v[100:101]
    v_pk_mul_f32 v[98:99], v[98:99], v[102:103]
    ds_read_b64 v[104:105], v80 offset:8752
    s_waitcnt lgkmcnt(0)
gemnet_accum_kernel_sga_t6:
    s_nop 1
    v_mfma_f32_4x4x4_16b_bf16 v[100:103], v[124:125], v[104:105], v[96:99]
    s_nop 4
    v_cvt_pk_bf16_f32 v90, v100, v101
    v_cvt_pk_bf16_f32 v91, v102, v103
    ds_cmpst_rtn_b64 v[92:93], v80, v[104:105], v[90:91] offset:8752
    s_waitcnt lgkmcnt(0)
    v_cmp_ne_u64 vcc, v[92:93], v[104:105]
    v_mov_b32 v104, v92
    v_mov_b32 v105, v93
    s_and_b64 exec, exec, vcc
    s_cbranch_execnz gemnet_accum_kernel_sga_t6
gemnet_accum_kernel_tskipa_6:
    s_mov_b64 exec, -1
    s_mov_b64 exec, -1
    s_waitcnt vmcnt(0)
    s_cmp_gt_u32 s80, 7
    s_cbranch_scc0 gemnet_accum_kernel_tskipa_7
    s_cmp_gt_u32 s27, 7
    s_cselect_b64 exec, -1, s[58:59]
    v_and_b32 v35, 0xffff8, v81
    buffer_load_dwordx2 v[42:43], v35, s[4:7], s23 offen
    v_lshrrev_b32 v94, 16, v81
    v_and_b32 v94, 0xfff0, v94
    ds_read_b128 v[90:93], v94 offset:33760
    v_lshrrev_b32 v81, 1, v94
    v_mul_f32 v94, s20, v29
    v_fract_f32 v94, v94
    v_cos_f32 v94, v94
    s_nop 0
    v_add_f32 v95, v94, v94
    v_fma_f32 v95, v95, v94, -1.0
    v_cvt_pk_bf16_f32 v95, v94, v95
    s_waitcnt vmcnt(0)
    v_mfma_f32_4x4x4_16b_bf16 v[96:99], v[122:123], v[42:43], 0
    s_waitcnt lgkmcnt(0)
    v_dot2_f32_bf16 v100, v90, v95, 0
    v_dot2_f32_bf16 v101, v91, v95, 0
    v_dot2_f32_bf16 v102, v92, v95, 0
    v_dot2_f32_bf16 v103, v93, v95, 0
    s_nop 2
    v_pk_mul_f32 v[96:97], v[96:97], v[100:101]
    v_pk_mul_f32 v[98:99], v[98:99], v[102:103]
    ds_read_b64 v[104:105], v81 offset:8752
    s_waitcnt lgkmcnt(0)
gemnet_accum_kernel_sga_t7:
    s_nop 1
    v_mfma_f32_4x4x4_16b_bf16 v[100:103], v[124:125], v[104:105], v[96:99]
    s_nop 4
    v_cvt_pk_bf16_f32 v90, v100, v101
    v_cvt_pk_bf16_f32 v91, v102, v103
    ds_cmpst_rtn_b64 v[92:93], v81, v[104:105], v[90:91] offset:8752
    s_waitcnt lgkmcnt(0)
    v_cmp_ne_u64 vcc, v[92:93], v[104:105]
    v_mov_b32 v104, v92
    v_mov_b32 v105, v93
    s_and_b64 exec, exec, vcc
    s_cbranch_execnz gemnet_accum_kernel_sga_t7
gemnet_accum_kernel_tskipa_7:
    s_mov_b64 exec, -1
    s_waitcnt lgkmcnt(0)
    s_cmp_ge_u32 s69, 8
    s_cbranch_scc0 gemnet_accum_kernel_h2sat_6
    v_lshrrev_b32 v126, 8, v56
    v_and_b32 v126, 4092, v126
    ds_add_rtn_u32 v80, v126, v3 offset:3328
    v_lshrrev_b32 v126, 8, v58
    v_and_b32 v126, 4092, v126
    ds_add_rtn_u32 v81, v126, v3 offset:3328
    s_branch gemnet_accum_kernel_h2eat_6
gemnet_accum_kernel_h2sat_6:
    s_cmp_gt_u32 s76, 6
    s_cbranch_scc0 gemnet_accum_kernel_hgat_6
    s_cmp_eq_u32 s77, 6
    s_cselect_b64 exec, s[78:79], -1
    v_lshrrev_b32 v126, 8, v56
    v_and_b32 v126, 4092, v126
    ds_add_rtn_u32 v80, v126, v3 offset:3328
    s_mov_b64 exec, -1
gemnet_accum_kernel_hgat_6:
    s_cmp_gt_u32 s76, 7
    s_cbranch_scc0 gemnet_accum_kernel_hgat_7
    s_cmp_eq_u32 s77, 7
    s_cselect_b64 exec, s[78:79], -1
    v_lshrrev_b32 v126, 8, v58
    v_and_b32 v126, 4092, v126
    ds_add_rtn_u32 v81, v126, v3 offset:3328
    s_mov_b64 exec, -1
gemnet_accum_kernel_hgat_7:
gemnet_accum_kernel_h2eat_6:
    s_movk_i32 s25, 2304
    v_add3_u32 v27, v26, v2, s25
    v_and_b32 v26, -4, v27
    v_cmp_ne_u32 s[40:41], v26, v27
gemnet_accum_kernel_fbat_6:
    v_readlane_b32 s62, v127, 7
    v_readlane_b32 s63, v0, 7
    s_nop 1
    v_mbcnt_lo_u32_b32 v126, s62, 0
    v_mbcnt_hi_u32_b32 v126, s63, v126
    v_add_lshl_u32 v126, v126, s24, 2
    s_bcnt1_i32_b64 s65, s[62:63]
    ds_bpermute_b32 v28, v126, v89
    s_add_u32 s24, s24, s65
gemnet_accum_kernel_faat_7:
gemnet_accum_kernel_taila_8:
    s_mov_b64 exec, -1
    s_waitcnt vmcnt(0)
    s_cmp_gt_u32 s80, 8
    s_cbranch_scc0 gemnet_accum_kernel_tskipa_8
    s_cmp_gt_u32 s27, 8
    s_cselect_b64 exec, -1, s[58:59]
    v_and_b32 v35, 0xffff8, v82
    buffer_load_dwordx2 v[36:37], v35, s[4:7], s23 offen
    v_lshrrev_b32 v94, 16, v82
    v_and_b32 v94, 0xfff0, v94
    ds_read_b128 v[90:93], v94 offset:33760
    v_lshrrev_b32 v82, 1, v94
    v_mul_f32 v94, s20, v30
    v_fract_f32 v94, v94
    v_cos_f32 v94, v94
    s_nop 0
    v_add_f32 v95, v94, v94
    v_fma_f32 v95, v95, v94, -1.0
    v_cvt_pk_bf16_f32 v95, v94, v95
    s_waitcnt vmcnt(0)
    v_mfma_f32_4x4x4_16b_bf16 v[96:99], v[122:123], v[36:37], 0
    s_waitcnt lgkmcnt(0)
    v_dot2_f32_bf16 v100, v90, v95, 0
    v_dot2_f32_bf16 v101, v91, v95, 0
    v_dot2_f32_bf16 v102, v92, v95, 0
    v_dot2_f32_bf16 v103, v93, v95, 0
    s_nop 2
    v_pk_mul_f32 v[96:97], v[96:97], v[100:101]
    v_pk_mul_f32 v[98:99], v[98:99], v[102:103]
    ds_read_b64 v[104:105], v82 offset:8752
    s_waitcnt lgkmcnt(0)
gemnet_accum_kernel_sga_t8:
    s_nop 1
    v_mfma_f32_4x4x4_16b_bf16 v[100:103], v[124:125], v[104:105], v[96:99]
    s_nop 4
    v_cvt_pk_bf16_f32 v90, v100, v101
    v_cvt_pk_bf16_f32 v91, v102, v103
    ds_cmpst_rtn_b64 v[92:93], v82, v[104:105], v[90:91] offset:8752
    s_waitcnt lgkmcnt(0)
    v_cmp_ne_u64 vcc, v[92:93], v[104:105]
    v_mov_b32 v104, v92
    v_mov_b32 v105, v93
    s_and_b64 exec, exec, vcc
    s_cbranch_execnz gemnet_accum_kernel_sga_t8
gemnet_accum_kernel_tskipa_8:
    s_mov_b64 exec, -1
    s_mov_b64 exec, -1
    s_waitcnt vmcnt(0)
    s_cmp_gt_u32 s80, 9
    s_cbranch_scc0 gemnet_accum_kernel_tskipa_9
    s_cmp_gt_u32 s27, 9
    s_cselect_b64 exec, -1, s[58:59]
    v_and_b32 v35, 0xffff8, v83
    buffer_load_dwordx2 v[38:39], v35, s[4:7], s23 offen
    v_lshrrev_b32 v94, 16, v83
    v_and_b32 v94, 0xfff0, v94
    ds_read_b128 v[90:93], v94 offset:33760
    v_lshrrev_b32 v83, 1, v94
    v_mul_f32 v94, s20, v31
    v_fract_f32 v94, v94
    v_cos_f32 v94, v94
    s_nop 0
    v_add_f32 v95, v94, v94
    v_fma_f32 v95, v95, v94, -1.0
    v_cvt_pk_bf16_f32 v95, v94, v95
    s_waitcnt vmcnt(0)
    v_mfma_f32_4x4x4_16b_bf16 v[96:99], v[122:123], v[38:39], 0
    s_waitcnt lgkmcnt(0)
    v_dot2_f32_bf16 v100, v90, v95, 0
    v_dot2_f32_bf16 v101, v91, v95, 0
    v_dot2_f32_bf16 v102, v92, v95, 0
    v_dot2_f32_bf16 v103, v93, v95, 0
    s_nop 2
    v_pk_mul_f32 v[96:97], v[96:97], v[100:101]
    v_pk_mul_f32 v[98:99], v[98:99], v[102:103]
    ds_read_b64 v[104:105], v83 offset:8752
    s_waitcnt lgkmcnt(0)
gemnet_accum_kernel_sga_t9:
    s_nop 1
    v_mfma_f32_4x4x4_16b_bf16 v[100:103], v[124:125], v[104:105], v[96:99]
    s_nop 4
    v_cvt_pk_bf16_f32 v90, v100, v101
    v_cvt_pk_bf16_f32 v91, v102, v103
    ds_cmpst_rtn_b64 v[92:93], v83, v[104:105], v[90:91] offset:8752
    s_waitcnt lgkmcnt(0)
    v_cmp_ne_u64 vcc, v[92:93], v[104:105]
    v_mov_b32 v104, v92
    v_mov_b32 v105, v93
    s_and_b64 exec, exec, vcc
    s_cbranch_execnz gemnet_accum_kernel_sga_t9
gemnet_accum_kernel_tskipa_9:
    s_mov_b64 exec, -1
    s_waitcnt lgkmcnt(0)
    s_cmp_ge_u32 s69, 10
    s_cbranch_scc0 gemnet_accum_kernel_h2sat_8
    v_lshrrev_b32 v126, 8, v60
    v_and_b32 v126, 4092, v126
    ds_add_rtn_u32 v82, v126, v3 offset:3328
    v_lshrrev_b32 v126, 8, v62
    v_and_b32 v126, 4092, v126
    ds_add_rtn_u32 v83, v126, v3 offset:3328
    s_branch gemnet_accum_kernel_h2eat_8
gemnet_accum_kernel_h2sat_8:
    s_cmp_gt_u32 s76, 8
    s_cbranch_scc0 gemnet_accum_kernel_hgat_8
    s_cmp_eq_u32 s77, 8
    s_cselect_b64 exec, s[78:79], -1
    v_lshrrev_b32 v126, 8, v60
    v_and_b32 v126, 4092, v126
    ds_add_rtn_u32 v82, v126, v3 offset:3328
    s_mov_b64 exec, -1
gemnet_accum_kernel_hgat_8:
    s_cmp_gt_u32 s76, 9
    s_cbranch_scc0 gemnet_accum_kernel_hgat_9
    s_cmp_eq_u32 s77, 9
    s_cselect_b64 exec, s[78:79], -1
    v_lshrrev_b32 v126, 8, v62
    v_and_b32 v126, 4092, v126
    ds_add_rtn_u32 v83, v126, v3 offset:3328
    s_mov_b64 exec, -1
gemnet_accum_kernel_hgat_9:
gemnet_accum_kernel_h2eat_8:
    s_movk_i32 s25, 2688
    v_add3_u32 v29, v28, v2, s25
    v_and_b32 v28, -4, v29
    v_cmp_ne_u32 s[42:43], v28, v29
gemnet_accum_kernel_fbat_7:
    v_readlane_b32 s62, v127, 8
    v_readlane_b32 s63, v0, 8
    s_nop 1
    v_mbcnt_lo_u32_b32 v126, s62, 0
    v_mbcnt_hi_u32_b32 v126, s63, v126
    v_add_lshl_u32 v126, v126, s24, 2
    s_bcnt1_i32_b64 s65, s[62:63]
    ds_bpermute_b32 v30, v126, v89
    s_add_u32 s24, s24, s65
gemnet_accum_kernel_faat_8:
gemnet_accum_kernel_taila_10:
    s_mov_b64 exec, -1
    s_waitcnt vmcnt(0)
    s_cmp_gt_u32 s80, 10
    s_cbranch_scc0 gemnet_accum_kernel_tskipa_10
    s_cmp_gt_u32 s27, 10
    s_cselect_b64 exec, -1, s[58:59]
    v_and_b32 v35, 0xffff8, v84
    buffer_load_dwordx2 v[40:41], v35, s[4:7], s23 offen
    v_lshrrev_b32 v94, 16, v84
    v_and_b32 v94, 0xfff0, v94
    ds_read_b128 v[90:93], v94 offset:33760
    v_lshrrev_b32 v84, 1, v94
    v_mul_f32 v94, s20, v32
    v_fract_f32 v94, v94
    v_cos_f32 v94, v94
    s_nop 0
    v_add_f32 v95, v94, v94
    v_fma_f32 v95, v95, v94, -1.0
    v_cvt_pk_bf16_f32 v95, v94, v95
    s_waitcnt vmcnt(0)
    v_mfma_f32_4x4x4_16b_bf16 v[96:99], v[122:123], v[40:41], 0
    s_waitcnt lgkmcnt(0)
    v_dot2_f32_bf16 v100, v90, v95, 0
    v_dot2_f32_bf16 v101, v91, v95, 0
    v_dot2_f32_bf16 v102, v92, v95, 0
    v_dot2_f32_bf16 v103, v93, v95, 0
    s_nop 2
    v_pk_mul_f32 v[96:97], v[96:97], v[100:101]
    v_pk_mul_f32 v[98:99], v[98:99], v[102:103]
    ds_read_b64 v[104:105], v84 offset:8752
    s_waitcnt lgkmcnt(0)
gemnet_accum_kernel_sga_t10:
    s_nop 1
    v_mfma_f32_4x4x4_16b_bf16 v[100:103], v[124:125], v[104:105], v[96:99]
    s_nop 4
    v_cvt_pk_bf16_f32 v90, v100, v101
    v_cvt_pk_bf16_f32 v91, v102, v103
    ds_cmpst_rtn_b64 v[92:93], v84, v[104:105], v[90:91] offset:8752
    s_waitcnt lgkmcnt(0)
    v_cmp_ne_u64 vcc, v[92:93], v[104:105]
    v_mov_b32 v104, v92
    v_mov_b32 v105, v93
    s_and_b64 exec, exec, vcc
    s_cbranch_execnz gemnet_accum_kernel_sga_t10
gemnet_accum_kernel_tskipa_10:
    s_mov_b64 exec, -1
    s_mov_b64 exec, -1
    s_waitcnt vmcnt(0)
    s_cmp_gt_u32 s80, 11
    s_cbranch_scc0 gemnet_accum_kernel_tskipa_11
    s_cmp_gt_u32 s27, 11
    s_cselect_b64 exec, -1, s[58:59]
    v_and_b32 v35, 0xffff8, v85
    buffer_load_dwordx2 v[42:43], v35, s[4:7], s23 offen
    v_lshrrev_b32 v94, 16, v85
    v_and_b32 v94, 0xfff0, v94
    ds_read_b128 v[90:93], v94 offset:33760
    v_lshrrev_b32 v85, 1, v94
    v_mul_f32 v94, s20, v33
    v_fract_f32 v94, v94
    v_cos_f32 v94, v94
    s_nop 0
    v_add_f32 v95, v94, v94
    v_fma_f32 v95, v95, v94, -1.0
    v_cvt_pk_bf16_f32 v95, v94, v95
    s_waitcnt vmcnt(0)
    v_mfma_f32_4x4x4_16b_bf16 v[96:99], v[122:123], v[42:43], 0
    s_waitcnt lgkmcnt(0)
    v_dot2_f32_bf16 v100, v90, v95, 0
    v_dot2_f32_bf16 v101, v91, v95, 0
    v_dot2_f32_bf16 v102, v92, v95, 0
    v_dot2_f32_bf16 v103, v93, v95, 0
    s_nop 2
    v_pk_mul_f32 v[96:97], v[96:97], v[100:101]
    v_pk_mul_f32 v[98:99], v[98:99], v[102:103]
    ds_read_b64 v[104:105], v85 offset:8752
    s_waitcnt lgkmcnt(0)
gemnet_accum_kernel_sga_t11:
    s_nop 1
    v_mfma_f32_4x4x4_16b_bf16 v[100:103], v[124:125], v[104:105], v[96:99]
    s_nop 4
    v_cvt_pk_bf16_f32 v90, v100, v101
    v_cvt_pk_bf16_f32 v91, v102, v103
    ds_cmpst_rtn_b64 v[92:93], v85, v[104:105], v[90:91] offset:8752
    s_waitcnt lgkmcnt(0)
    v_cmp_ne_u64 vcc, v[92:93], v[104:105]
    v_mov_b32 v104, v92
    v_mov_b32 v105, v93
    s_and_b64 exec, exec, vcc
    s_cbranch_execnz gemnet_accum_kernel_sga_t11
gemnet_accum_kernel_tskipa_11:
    s_mov_b64 exec, -1
    s_waitcnt lgkmcnt(0)
    s_cmp_ge_u32 s69, 12
    s_cbranch_scc0 gemnet_accum_kernel_h2sat_10
    v_lshrrev_b32 v126, 8, v64
    v_and_b32 v126, 4092, v126
    ds_add_rtn_u32 v84, v126, v3 offset:3328
    v_lshrrev_b32 v126, 8, v66
    v_and_b32 v126, 4092, v126
    ds_add_rtn_u32 v85, v126, v3 offset:3328
    s_branch gemnet_accum_kernel_h2eat_10
gemnet_accum_kernel_h2sat_10:
    s_cmp_gt_u32 s76, 10
    s_cbranch_scc0 gemnet_accum_kernel_hgat_10
    s_cmp_eq_u32 s77, 10
    s_cselect_b64 exec, s[78:79], -1
    v_lshrrev_b32 v126, 8, v64
    v_and_b32 v126, 4092, v126
    ds_add_rtn_u32 v84, v126, v3 offset:3328
    s_mov_b64 exec, -1
gemnet_accum_kernel_hgat_10:
    s_cmp_gt_u32 s76, 11
    s_cbranch_scc0 gemnet_accum_kernel_hgat_11
    s_cmp_eq_u32 s77, 11
    s_cselect_b64 exec, s[78:79], -1
    v_lshrrev_b32 v126, 8, v66
    v_and_b32 v126, 4092, v126
    ds_add_rtn_u32 v85, v126, v3 offset:3328
    s_mov_b64 exec, -1
gemnet_accum_kernel_hgat_11:
gemnet_accum_kernel_h2eat_10:
    s_movk_i32 s25, 3072
    v_add3_u32 v31, v30, v2, s25
    v_and_b32 v30, -4, v31
    v_cmp_ne_u32 s[44:45], v30, v31
gemnet_accum_kernel_fbat_8:
    v_readlane_b32 s62, v127, 9
    v_readlane_b32 s63, v0, 9
    s_nop 1
    v_mbcnt_lo_u32_b32 v126, s62, 0
    v_mbcnt_hi_u32_b32 v126, s63, v126
    v_add_lshl_u32 v126, v126, s24, 2
    s_bcnt1_i32_b64 s65, s[62:63]
    ds_bpermute_b32 v32, v126, v89
    s_add_u32 s24, s24, s65
gemnet_accum_kernel_faat_9:
    s_mov_b64 exec, -1
    s_waitcnt vmcnt(0)
    s_cmp_gt_u32 s80, 12
    s_cbranch_scc0 gemnet_accum_kernel_tskipa_12
    s_cmp_gt_u32 s27, 12
    s_cselect_b64 exec, -1, s[58:59]
    v_and_b32 v35, 0xffff8, v86
    buffer_load_dwordx2 v[36:37], v35, s[4:7], s23 offen
    v_lshrrev_b32 v94, 16, v86
    v_and_b32 v94, 0xfff0, v94
    ds_read_b128 v[90:93], v94 offset:33760
    v_lshrrev_b32 v86, 1, v94
    v_mul_f32 v94, s20, v34
    v_fract_f32 v94, v94
    v_cos_f32 v94, v94
    s_nop 0
    v_add_f32 v95, v94, v94
    v_fma_f32 v95, v95, v94, -1.0
    v_cvt_pk_bf16_f32 v95, v94, v95
    s_waitcnt vmcnt(0)
    v_mfma_f32_4x4x4_16b_bf16 v[96:99], v[122:123], v[36:37], 0
    s_waitcnt lgkmcnt(0)
    v_dot2_f32_bf16 v100, v90, v95, 0
    v_dot2_f32_bf16 v101, v91, v95, 0
    v_dot2_f32_bf16 v102, v92, v95, 0
    v_dot2_f32_bf16 v103, v93, v95, 0
    s_nop 2
    v_pk_mul_f32 v[96:97], v[96:97], v[100:101]
    v_pk_mul_f32 v[98:99], v[98:99], v[102:103]
    ds_read_b64 v[104:105], v86 offset:8752
    s_waitcnt lgkmcnt(0)
gemnet_accum_kernel_sga_t12:
    s_nop 1
    v_mfma_f32_4x4x4_16b_bf16 v[100:103], v[124:125], v[104:105], v[96:99]
    s_nop 4
    v_cvt_pk_bf16_f32 v90, v100, v101
    v_cvt_pk_bf16_f32 v91, v102, v103
    ds_cmpst_rtn_b64 v[92:93], v86, v[104:105], v[90:91] offset:8752
    s_waitcnt lgkmcnt(0)
    v_cmp_ne_u64 vcc, v[92:93], v[104:105]
    v_mov_b32 v104, v92
    v_mov_b32 v105, v93
    s_and_b64 exec, exec, vcc
    s_cbranch_execnz gemnet_accum_kernel_sga_t12
gemnet_accum_kernel_tskipa_12:
    s_mov_b64 exec, -1
    s_cmp_gt_u32 s76, 12
    s_cbranch_scc0 gemnet_accum_kernel_hgat_12
    s_cmp_eq_u32 s77, 12
    s_cselect_b64 exec, s[78:79], -1
    v_lshrrev_b32 v126, 8, v68
    v_and_b32 v126, 4092, v126
    ds_add_rtn_u32 v86, v126, v3 offset:3328
    s_mov_b64 exec, -1
gemnet_accum_kernel_hgat_12:
gemnet_accum_kernel_pda:
    s_mov_b64 exec, -1
    s_setprio 0
    s_cmp_gt_u32 s76, 13
    s_cbranch_scc0 gemnet_accum_kernel_hgae_13
    s_cmp_eq_u32 s77, 13
    s_cselect_b64 exec, s[78:79], -1
    v_lshrrev_b32 v126, 8, v70
    v_and_b32 v126, 4092, v126
    ds_add_rtn_u32 v87, v126, v3 offset:3328
    s_mov_b64 exec, -1
gemnet_accum_kernel_hgae_13:
    s_cmp_gt_u32 s76, 14
    s_cbranch_scc0 gemnet_accum_kernel_hgae_14
    s_cmp_eq_u32 s77, 14
    s_cselect_b64 exec, s[78:79], -1
    v_lshrrev_b32 v126, 8, v72
    v_and_b32 v126, 4092, v126
    ds_add_rtn_u32 v88, v126, v3 offset:3328
    s_mov_b64 exec, -1
gemnet_accum_kernel_hgae_14:
    s_waitcnt vmcnt(0) lgkmcnt(0)
    s_movk_i32 s25, 3456
    v_add3_u32 v33, v32, v2, s25
    v_and_b32 v32, -4, v33
    v_cmp_ne_u32 s[46:47], v32, v33
gemnet_accum_kernel_fbae_9:
    v_readlane_b32 s62, v127, 10
    v_readlane_b32 s63, v0, 10
    s_nop 1
    v_mbcnt_lo_u32_b32 v126, s62, 0
    v_mbcnt_hi_u32_b32 v126, s63, v126
    v_add_lshl_u32 v126, v126, s24, 2
    s_bcnt1_i32_b64 s65, s[62:63]
    ds_bpermute_b32 v34, v126, v89
    s_add_u32 s24, s24, s65
gemnet_accum_kernel_faae_10:
    v_readlane_b32 s62, v127, 11
    v_readlane_b32 s63, v0, 11
    s_nop 1
    v_mbcnt_lo_u32_b32 v126, s62, 0
    v_mbcnt_hi_u32_b32 v126, s63, v126
    v_add_lshl_u32 v126, v126, s24, 2
    s_bcnt1_i32_b64 s65, s[62:63]
    ds_bpermute_b32 v36, v126, v89
    s_add_u32 s24, s24, s65
gemnet_accum_kernel_faae_11:
    v_readlane_b32 s62, v127, 12
    v_readlane_b32 s63, v0, 12
    s_nop 1
    v_mbcnt_lo_u32_b32 v126, s62, 0
    v_mbcnt_hi_u32_b32 v126, s63, v126
    v_add_lshl_u32 v126, v126, s24, 2
    s_bcnt1_i32_b64 s65, s[62:63]
    ds_bpermute_b32 v38, v126, v89
    s_add_u32 s24, s24, s65
gemnet_accum_kernel_faae_12:
    s_cmp_gt_u32 s72, 13
    s_cbranch_scc0 gemnet_accum_kernel_faae_13
    v_readlane_b32 s62, v127, 13
    v_readlane_b32 s63, v0, 13
    s_nop 1
    v_mbcnt_lo_u32_b32 v126, s62, 0
    v_mbcnt_hi_u32_b32 v126, s63, v126
    v_add_lshl_u32 v126, v126, s24, 2
    s_bcnt1_i32_b64 s65, s[62:63]
    ds_bpermute_b32 v40, v126, v89
    s_add_u32 s24, s24, s65
gemnet_accum_kernel_faae_13:
    s_cmp_gt_u32 s72, 14
    s_cbranch_scc0 gemnet_accum_kernel_faae_14
    v_readlane_b32 s62, v127, 14
    v_readlane_b32 s63, v0, 14
    s_nop 1
    v_mbcnt_lo_u32_b32 v126, s62, 0
    v_mbcnt_hi_u32_b32 v126, s63, v126
    v_add_lshl_u32 v126, v126, s24, 2
    s_bcnt1_i32_b64 s65, s[62:63]
    ds_bpermute_b32 v42, v126, v89
    s_add_u32 s24, s24, s65
gemnet_accum_kernel_faae_14:
    s_waitcnt lgkmcnt(0)
    s_movk_i32 s25, 3840
    v_add3_u32 v35, v34, v2, s25
    v_and_b32 v34, -4, v35
    v_cmp_ne_u32 s[48:49], v34, v35
gemnet_accum_kernel_fbae_10:
    s_movk_i32 s25, 4224
    v_add3_u32 v37, v36, v2, s25
    v_and_b32 v36, -4, v37
    v_cmp_ne_u32 s[50:51], v36, v37
gemnet_accum_kernel_fbae_11:
    s_movk_i32 s25, 4608
    v_add3_u32 v39, v38, v2, s25
    v_and_b32 v38, -4, v39
    v_cmp_ne_u32 s[52:53], v38, v39
gemnet_accum_kernel_fbae_12:
    s_cmp_gt_u32 s72, 13
    s_cbranch_scc0 gemnet_accum_kernel_fbae_13
    s_movk_i32 s25, 4992
    v_add3_u32 v41, v40, v2, s25
    v_and_b32 v40, -4, v41
    v_cmp_ne_u32 s[54:55], v40, v41
gemnet_accum_kernel_fbae_13:
    s_cmp_gt_u32 s72, 14
    s_cbranch_scc0 gemnet_accum_kernel_fbae_14
    s_movk_i32 s25, 5376
    v_add3_u32 v43, v42, v2, s25
    v_and_b32 v42, -4, v43
    v_cmp_ne_u32 s[56:57], v42, v43
gemnet_accum_kernel_fbae_14:
    s_add_u32 s23, s23, 800000
    s_waitcnt vmcnt(0)
    s_cmp_lt_u32 s22, 4
    s_cbranch_scc0 gemnet_accum_kernel_nopfb
    v_lshlrev_b32 v5, 7, v1
    s_add_u32 s64, s23, s89
    buffer_load_dword v5, v5, s[4:7], s64 offen
gemnet_accum_kernel_nopfb:
    s_cmp_gt_u32 s72, 0
    s_cbranch_scc0 gemnet_accum_kernel_hnb_0
    s_cmp_eq_u32 s73, 0
    s_cselect_b64 exec, s[74:75], -1
    buffer_load_dwordx2 v[14:15], v14, s[8:11], 0 offen
    s_mov_b64 exec, -1
gemnet_accum_kernel_hnb_0:
    s_waitcnt lgkmcnt(0)
    s_barrier
    s_cmp_eq_u32 s22, 0
    s_cbranch_scc1 gemnet_accum_kernel_doscanb
    s_cmp_gt_u32 s72, 1
    s_cbranch_scc0 gemnet_accum_kernel_hmbo_1
    s_cmp_eq_u32 s73, 1
    s_cselect_b64 exec, s[74:75], -1
    buffer_load_dwordx2 v[16:17], v16, s[8:11], 0 offen
    s_mov_b64 exec, -1
gemnet_accum_kernel_hmbo_1:
    s_cmp_gt_u32 s72, 2
    s_cbranch_scc0 gemnet_accum_kernel_hmbo_2
    s_cmp_eq_u32 s73, 2
    s_cselect_b64 exec, s[74:75], -1
    buffer_load_dwordx2 v[18:19], v18, s[8:11], 0 offen
    s_mov_b64 exec, -1
gemnet_accum_kernel_hmbo_2:
    s_cmp_gt_u32 s72, 3
    s_cbranch_scc0 gemnet_accum_kernel_hmbo_3
    s_cmp_eq_u32 s73, 3
    s_cselect_b64 exec, s[74:75], -1
    buffer_load_dwordx2 v[20:21], v20, s[8:11], 0 offen
    s_mov_b64 exec, -1
gemnet_accum_kernel_hmbo_3:
    s_branch gemnet_accum_kernel_noscanb
gemnet_accum_kernel_doscanb:
    v_mul_u32_u24 v114, 52, v1
    ds_read_b32 v98, v114 offset:3328
    ds_read_b32 v99, v114 offset:3332
    ds_read_b32 v100, v114 offset:3336
    ds_read_b32 v101, v114 offset:3340
    ds_read_b32 v102, v114 offset:3344
    ds_read_b32 v103, v114 offset:3348
    ds_read_b32 v104, v114 offset:3352
    ds_read_b32 v105, v114 offset:3356
    ds_read_b32 v106, v114 offset:3360
    ds_read_b32 v107, v114 offset:3364
    ds_read_b32 v108, v114 offset:3368
    ds_read_b32 v109, v114 offset:3372
    ds_read_b32 v110, v114 offset:3376
    s_waitcnt lgkmcnt(0)
    v_add_u32 v115, v98, v99
    v_add_u32 v115, v115, v100
    v_add_u32 v115, v115, v101
    v_add_u32 v115, v115, v102
    v_add_u32 v115, v115, v103
    v_add_u32 v115, v115, v104
    v_add_u32 v115, v115, v105
    v_add_u32 v115, v115, v106
    v_add_u32 v115, v115, v107
    v_add_u32 v115, v115, v108
    v_add_u32 v115, v115, v109
    v_add_u32 v115, v115, v110
    v_mov_b32 v116, v115
    s_nop 1
    v_add_u32_dpp v116, v116, v116 row_shr:1 row_mask:0xf bank_mask:0xf
    s_nop 1
    v_add_u32_dpp v116, v116, v116 row_shr:2 row_mask:0xf bank_mask:0xf
    s_nop 1
    v_add_u32_dpp v116, v116, v116 row_shr:4 row_mask:0xf bank_mask:0xf
    s_nop 1
    v_add_u32_dpp v116, v116, v116 row_shr:8 row_mask:0xf bank_mask:0xf
    s_nop 1
    v_add_u32_dpp v116, v116, v116 row_bcast:15 row_mask:0xa bank_mask:0xf
    s_nop 1
    v_add_u32_dpp v116, v116, v116 row_bcast:31 row_mask:0xc bank_mask:0xf
    s_mov_b32 s62, 0
    s_mov_b32 s63, 0x80000000
    s_mov_b64 exec, s[62:63]
    v_mov_b32 v90, 0
    ds_write_b32 v90, v116 offset:6656
    s_mov_b64 exec, -1
    v_sub_u32 v116, v116, v115
    v_add_u32 v116, 27596, v116
    ds_write_b32 v114, v116 offset:3328
    v_add_u32 v116, v116, v98
    ds_write_b32 v114, v116 offset:3332
    v_add_u32 v116, v116, v99
    ds_write_b32 v114, v116 offset:3336
    v_add_u32 v116, v116, v100
    ds_write_b32 v114, v116 offset:3340
    v_add_u32 v116, v116, v101
    ds_write_b32 v114, v116 offset:3344
    v_add_u32 v116, v116, v102
    ds_write_b32 v114, v116 offset:3348
    v_add_u32 v116, v116, v103
    ds_write_b32 v114, v116 offset:3352
    v_add_u32 v116, v116, v104
    ds_write_b32 v114, v116 offset:3356
    v_add_u32 v116, v116, v105
    ds_write_b32 v114, v116 offset:3360
    v_add_u32 v116, v116, v106
    ds_write_b32 v114, v116 offset:3364
    v_add_u32 v116, v116, v107
    ds_write_b32 v114, v116 offset:3368
    v_add_u32 v116, v116, v108
    ds_write_b32 v114, v116 offset:3372
    v_add_u32 v116, v116, v109
    ds_write_b32 v114, v116 offset:3376
    s_cmp_gt_u32 s72, 1
    s_cbranch_scc0 gemnet_accum_kernel_hmbs_1
    s_cmp_eq_u32 s73, 1
    s_cselect_b64 exec, s[74:75], -1
    buffer_load_dwordx2 v[16:17], v16, s[8:11], 0 offen
    s_mov_b64 exec, -1
gemnet_accum_kernel_hmbs_1:
    s_cmp_gt_u32 s72, 2
    s_cbranch_scc0 gemnet_accum_kernel_hmbs_2
    s_cmp_eq_u32 s73, 2
    s_cselect_b64 exec, s[74:75], -1
    buffer_load_dwordx2 v[18:19], v18, s[8:11], 0 offen
    s_mov_b64 exec, -1
gemnet_accum_kernel_hmbs_2:
    s_cmp_gt_u32 s72, 3
    s_cbranch_scc0 gemnet_accum_kernel_hmbs_3
    s_cmp_eq_u32 s73, 3
    s_cselect_b64 exec, s[74:75], -1
    buffer_load_dwordx2 v[20:21], v20, s[8:11], 0 offen
    s_mov_b64 exec, -1
gemnet_accum_kernel_hmbs_3:
    s_waitcnt lgkmcnt(0)
gemnet_accum_kernel_noscanb:
    s_barrier
    v_mov_b32 v90, 0
    ds_read_b32 v91, v90 offset:6656
    s_min_u32 s64, s69, s68
    s_cmp_ge_u32 s64, 11
    s_cbranch_scc0 gemnet_accum_kernel_scgb
    v_lshrrev_b32 v98, 8, v44
    v_and_b32 v98, 4092, v98
    ds_read_b32 v98, v98 offset:3328
    v_lshrrev_b32 v99, 8, v46
    v_and_b32 v99, 4092, v99
    ds_read_b32 v99, v99 offset:3328
    v_lshrrev_b32 v100, 8, v48
    v_and_b32 v100, 4092, v100
    ds_read_b32 v100, v100 offset:3328
    v_lshrrev_b32 v101, 8, v50
    v_and_b32 v101, 4092, v101
    ds_read_b32 v101, v101 offset:3328
    v_lshrrev_b32 v102, 8, v52
    v_and_b32 v102, 4092, v102
    ds_read_b32 v102, v102 offset:3328
    v_lshrrev_b32 v103, 8, v54
    v_and_b32 v103, 4092, v103
    ds_read_b32 v103, v103 offset:3328
    v_lshrrev_b32 v104, 8, v56
    v_and_b32 v104, 4092, v104
    ds_read_b32 v104, v104 offset:3328
    v_lshrrev_b32 v105, 8, v58
    v_and_b32 v105, 4092, v105
    ds_read_b32 v105, v105 offset:3328
    v_lshrrev_b32 v106, 8, v60
    v_and_b32 v106, 4092, v106
    ds_read_b32 v106, v106 offset:3328
    v_lshrrev_b32 v107, 8, v62
    v_and_b32 v107, 4092, v107
    ds_read_b32 v107, v107 offset:3328
    v_lshrrev_b32 v108, 8, v64
    v_and_b32 v108, 4092, v108
    ds_read_b32 v108, v108 offset:3328
    s_cmp_gt_u32 s76, 11
    s_cbranch_scc0 gemnet_accum_kernel_sabf
    s_cmp_eq_u32 s77, 11
    s_cselect_b64 exec, s[78:79], -1
    v_lshrrev_b32 v109, 8, v66
    v_and_b32 v109, 4092, v109
    ds_read_b32 v109, v109 offset:3328
    s_cmp_gt_u32 s76, 12
    s_cbranch_scc0 gemnet_accum_kernel_sabf
    s_cmp_eq_u32 s77, 12
    s_cselect_b64 exec, s[78:79], -1
    v_lshrrev_b32 v110, 8, v68
    v_and_b32 v110, 4092, v110
    ds_read_b32 v110, v110 offset:3328
    s_cmp_gt_u32 s76, 13
    s_cbranch_scc0 gemnet_accum_kernel_sabf
    s_cmp_eq_u32 s77, 13
    s_cselect_b64 exec, s[78:79], -1
    v_lshrrev_b32 v111, 8, v70
    v_and_b32 v111, 4092, v111
    ds_read_b32 v111, v111 offset:3328
    s_cmp_gt_u32 s76, 14
    s_cbranch_scc0 gemnet_accum_kernel_sabf
    s_cmp_eq_u32 s77, 14
    s_cselect_b64 exec, s[78:79], -1
    v_lshrrev_b32 v112, 8, v72
    v_and_b32 v112, 4092, v112
    ds_read_b32 v112, v112 offset:3328
gemnet_accum_kernel_sabf:
    s_mov_b64 exec, -1
    s_waitcnt lgkmcnt(0)
    v_readfirstlane_b32 s26, v91
    v_add_u32 v98, v98, v74
    v_lshlrev_b32 v74, 2, v98
    v_add_u32 v98, v98, v98
    ds_write_b32 v74, v44
    ds_write_b16 v98, v45 offset:28568
    v_add_u32 v99, v99, v75
    v_lshlrev_b32 v75, 2, v99
    v_add_u32 v99, v99, v99
    ds_write_b32 v75, v46
    ds_write_b16 v99, v47 offset:28568
    v_add_u32 v100, v100, v76
    v_lshlrev_b32 v76, 2, v100
    v_add_u32 v100, v100, v100
    ds_write_b32 v76, v48
    ds_write_b16 v100, v49 offset:28568
    v_add_u32 v101, v101, v77
    v_lshlrev_b32 v77, 2, v101
    v_add_u32 v101, v101, v101
    ds_write_b32 v77, v50
    ds_write_b16 v101, v51 offset:28568
    v_add_u32 v102, v102, v78
    v_lshlrev_b32 v78, 2, v102
    v_add_u32 v102, v102, v102
    ds_write_b32 v78, v52
    ds_write_b16 v102, v53 offset:28568
    buffer_load_dwordx2 v[22:23], v22, s[8:11], 0 offen
    v_add_u32 v103, v103, v79
    v_lshlrev_b32 v79, 2, v103
    v_add_u32 v103, v103, v103
    ds_write_b32 v79, v54
    ds_write_b16 v103, v55 offset:28568
    buffer_load_dwordx2 v[24:25], v24, s[8:11], 0 offen
    v_add_u32 v104, v104, v80
    v_lshlrev_b32 v80, 2, v104
    v_add_u32 v104, v104, v104
    ds_write_b32 v80, v56
    ds_write_b16 v104, v57 offset:28568
    buffer_load_dwordx2 v[26:27], v26, s[8:11], 0 offen
    v_add_u32 v105, v105, v81
    v_lshlrev_b32 v81, 2, v105
    v_add_u32 v105, v105, v105
    ds_write_b32 v81, v58
    ds_write_b16 v105, v59 offset:28568
    buffer_load_dwordx2 v[28:29], v28, s[8:11], 0 offen
    v_add_u32 v106, v106, v82
    v_lshlrev_b32 v82, 2, v106
    v_add_u32 v106, v106, v106
    ds_write_b32 v82, v60
    ds_write_b16 v106, v61 offset:28568
    buffer_load_dwordx2 v[30:31], v30, s[8:11], 0 offen
    v_add_u32 v107, v107, v83
    v_lshlrev_b32 v83, 2, v107
    v_add_u32 v107, v107, v107
    ds_write_b32 v83, v62
    ds_write_b16 v107, v63 offset:28568
    buffer_load_dwordx2 v[32:33], v32, s[8:11], 0 offen
    v_add_u32 v108, v108, v84
    v_lshlrev_b32 v84, 2, v108
    v_add_u32 v108, v108, v108
    ds_write_b32 v84, v64
    ds_write_b16 v108, v65 offset:28568
    buffer_load_dwordx2 v[34:35], v34, s[8:11], 0 offen
    s_cmp_gt_u32 s76, 11
    s_cbranch_scc0 gemnet_accum_kernel_sbbf_11
    s_cmp_eq_u32 s77, 11
    s_cselect_b64 exec, s[78:79], -1
    v_add_u32 v109, v109, v85
    v_lshlrev_b32 v85, 2, v109
    v_add_u32 v109, v109, v109
    ds_write_b32 v85, v66
    ds_write_b16 v109, v67 offset:28568
gemnet_accum_kernel_sbbf_11:
    s_cmp_gt_u32 s72, 11
    s_cbranch_scc0 gemnet_accum_kernel_snbf_11
    s_cmp_eq_u32 s73, 11
    s_cselect_b64 exec, s[74:75], -1
    buffer_load_dwordx2 v[36:37], v36, s[8:11], 0 offen
    s_mov_b64 exec, -1
gemnet_accum_kernel_snbf_11:
    s_cmp_gt_u32 s76, 12
    s_cbranch_scc0 gemnet_accum_kernel_sbbf_12
    s_cmp_eq_u32 s77, 12
    s_cselect_b64 exec, s[78:79], -1
    v_add_u32 v110, v110, v86
    v_lshlrev_b32 v86, 2, v110
    v_add_u32 v110, v110, v110
    ds_write_b32 v86, v68
    ds_write_b16 v110, v69 offset:28568
gemnet_accum_kernel_sbbf_12:
    s_cmp_gt_u32 s72, 12
    s_cbranch_scc0 gemnet_accum_kernel_snbf_12
    s_cmp_eq_u32 s73, 12
    s_cselect_b64 exec, s[74:75], -1
    buffer_load_dwordx2 v[38:39], v38, s[8:11], 0 offen
    s_mov_b64 exec, -1
gemnet_accum_kernel_snbf_12:
    s_cmp_gt_u32 s76, 13
    s_cbranch_scc0 gemnet_accum_kernel_sbbf_13
    s_cmp_eq_u32 s77, 13
    s_cselect_b64 exec, s[78:79], -1
    v_add_u32 v111, v111, v87
    v_lshlrev_b32 v87, 2, v111
    v_add_u32 v111, v111, v111
    ds_write_b32 v87, v70
    ds_write_b16 v111, v71 offset:28568
gemnet_accum_kernel_sbbf_13:
    s_cmp_gt_u32 s72, 13
    s_cbranch_scc0 gemnet_accum_kernel_snbf_13
    s_cmp_eq_u32 s73, 13
    s_cselect_b64 exec, s[74:75], -1
    buffer_load_dwordx2 v[40:41], v40, s[8:11], 0 offen
    s_mov_b64 exec, -1
gemnet_accum_kernel_snbf_13:
    s_cmp_gt_u32 s76, 14
    s_cbranch_scc0 gemnet_accum_kernel_sbbf_14
    s_cmp_eq_u32 s77, 14
    s_cselect_b64 exec, s[78:79], -1
    v_add_u32 v112, v112, v88
    v_lshlrev_b32 v88, 2, v112
    v_add_u32 v112, v112, v112
    ds_write_b32 v88, v72
    ds_write_b16 v112, v73 offset:28568
gemnet_accum_kernel_sbbf_14:
    s_cmp_gt_u32 s72, 14
    s_cbranch_scc0 gemnet_accum_kernel_snbf_14
    s_cmp_eq_u32 s73, 14
    s_cselect_b64 exec, s[74:75], -1
    buffer_load_dwordx2 v[42:43], v42, s[8:11], 0 offen
    s_mov_b64 exec, -1
gemnet_accum_kernel_snbf_14:
    s_branch gemnet_accum_kernel_sceb
gemnet_accum_kernel_scgb:
    s_cmp_gt_u32 s76, 0
    s_cbranch_scc0 gemnet_accum_kernel_sabg
    s_cmp_eq_u32 s77, 0
    s_cselect_b64 exec, s[78:79], -1
    v_lshrrev_b32 v98, 8, v44
    v_and_b32 v98, 4092, v98
    ds_read_b32 v98, v98 offset:3328
    s_cmp_gt_u32 s76, 1
    s_cbranch_scc0 gemnet_accum_kernel_sabg
    s_cmp_eq_u32 s77, 1
    s_cselect_b64 exec, s[78:79], -1
    v_lshrrev_b32 v99, 8, v46
    v_and_b32 v99, 4092, v99
    ds_read_b32 v99, v99 offset:3328
    s_cmp_gt_u32 s76, 2
    s_cbranch_scc0 gemnet_accum_kernel_sabg
    s_cmp_eq_u32 s77, 2
    s_cselect_b64 exec, s[78:79], -1
    v_lshrrev_b32 v100, 8, v48
    v_and_b32 v100, 4092, v100
    ds_read_b32 v100, v100 offset:3328
    s_cmp_gt_u32 s76, 3
    s_cbranch_scc0 gemnet_accum_kernel_sabg
    s_cmp_eq_u32 s77, 3
    s_cselect_b64 exec, s[78:79], -1
    v_lshrrev_b32 v101, 8, v50
    v_and_b32 v101, 4092, v101
    ds_read_b32 v101, v101 offset:3328
    s_cmp_gt_u32 s76, 4
    s_cbranch_scc0 gemnet_accum_kernel_sabg
    s_cmp_eq_u32 s77, 4
    s_cselect_b64 exec, s[78:79], -1
    v_lshrrev_b32 v102, 8, v52
    v_and_b32 v102, 4092, v102
    ds_read_b32 v102, v102 offset:3328
    s_cmp_gt_u32 s76, 5
    s_cbranch_scc0 gemnet_accum_kernel_sabg
    s_cmp_eq_u32 s77, 5
    s_cselect_b64 exec, s[78:79], -1
    v_lshrrev_b32 v103, 8, v54
    v_and_b32 v103, 4092, v103
    ds_read_b32 v103, v103 offset:3328
    s_cmp_gt_u32 s76, 6
    s_cbranch_scc0 gemnet_accum_kernel_sabg
    s_cmp_eq_u32 s77, 6
    s_cselect_b64 exec, s[78:79], -1
    v_lshrrev_b32 v104, 8, v56
    v_and_b32 v104, 4092, v104
    ds_read_b32 v104, v104 offset:3328
    s_cmp_gt_u32 s76, 7
    s_cbranch_scc0 gemnet_accum_kernel_sabg
    s_cmp_eq_u32 s77, 7
    s_cselect_b64 exec, s[78:79], -1
    v_lshrrev_b32 v105, 8, v58
    v_and_b32 v105, 4092, v105
    ds_read_b32 v105, v105 offset:3328
    s_cmp_gt_u32 s76, 8
    s_cbranch_scc0 gemnet_accum_kernel_sabg
    s_cmp_eq_u32 s77, 8
    s_cselect_b64 exec, s[78:79], -1
    v_lshrrev_b32 v106, 8, v60
    v_and_b32 v106, 4092, v106
    ds_read_b32 v106, v106 offset:3328
    s_cmp_gt_u32 s76, 9
    s_cbranch_scc0 gemnet_accum_kernel_sabg
    s_cmp_eq_u32 s77, 9
    s_cselect_b64 exec, s[78:79], -1
    v_lshrrev_b32 v107, 8, v62
    v_and_b32 v107, 4092, v107
    ds_read_b32 v107, v107 offset:3328
    s_cmp_gt_u32 s76, 10
    s_cbranch_scc0 gemnet_accum_kernel_sabg
    s_cmp_eq_u32 s77, 10
    s_cselect_b64 exec, s[78:79], -1
    v_lshrrev_b32 v108, 8, v64
    v_and_b32 v108, 4092, v108
    ds_read_b32 v108, v108 offset:3328
    s_cmp_gt_u32 s76, 11
    s_cbranch_scc0 gemnet_accum_kernel_sabg
    s_cmp_eq_u32 s77, 11
    s_cselect_b64 exec, s[78:79], -1
    v_lshrrev_b32 v109, 8, v66
    v_and_b32 v109, 4092, v109
    ds_read_b32 v109, v109 offset:3328
    s_cmp_gt_u32 s76, 12
    s_cbranch_scc0 gemnet_accum_kernel_sabg
    s_cmp_eq_u32 s77, 12
    s_cselect_b64 exec, s[78:79], -1
    v_lshrrev_b32 v110, 8, v68
    v_and_b32 v110, 4092, v110
    ds_read_b32 v110, v110 offset:3328
    s_cmp_gt_u32 s76, 13
    s_cbranch_scc0 gemnet_accum_kernel_sabg
    s_cmp_eq_u32 s77, 13
    s_cselect_b64 exec, s[78:79], -1
    v_lshrrev_b32 v111, 8, v70
    v_and_b32 v111, 4092, v111
    ds_read_b32 v111, v111 offset:3328
    s_cmp_gt_u32 s76, 14
    s_cbranch_scc0 gemnet_accum_kernel_sabg
    s_cmp_eq_u32 s77, 14
    s_cselect_b64 exec, s[78:79], -1
    v_lshrrev_b32 v112, 8, v72
    v_and_b32 v112, 4092, v112
    ds_read_b32 v112, v112 offset:3328
gemnet_accum_kernel_sabg:
    s_mov_b64 exec, -1
    s_waitcnt lgkmcnt(0)
    v_readfirstlane_b32 s26, v91
    s_cmp_gt_u32 s76, 0
    s_cbranch_scc0 gemnet_accum_kernel_sbbg_0
    s_cmp_eq_u32 s77, 0
    s_cselect_b64 exec, s[78:79], -1
    v_add_u32 v98, v98, v74
    v_lshlrev_b32 v74, 2, v98
    v_add_u32 v98, v98, v98
    ds_write_b32 v74, v44
    ds_write_b16 v98, v45 offset:28568
gemnet_accum_kernel_sbbg_0:
    s_cmp_gt_u32 s76, 1
    s_cbranch_scc0 gemnet_accum_kernel_sbbg_1
    s_cmp_eq_u32 s77, 1
    s_cselect_b64 exec, s[78:79], -1
    v_add_u32 v99, v99, v75
    v_lshlrev_b32 v75, 2, v99
    v_add_u32 v99, v99, v99
    ds_write_b32 v75, v46
    ds_write_b16 v99, v47 offset:28568
gemnet_accum_kernel_sbbg_1:
    s_cmp_gt_u32 s76, 2
    s_cbranch_scc0 gemnet_accum_kernel_sbbg_2
    s_cmp_eq_u32 s77, 2
    s_cselect_b64 exec, s[78:79], -1
    v_add_u32 v100, v100, v76
    v_lshlrev_b32 v76, 2, v100
    v_add_u32 v100, v100, v100
    ds_write_b32 v76, v48
    ds_write_b16 v100, v49 offset:28568
gemnet_accum_kernel_sbbg_2:
    s_cmp_gt_u32 s76, 3
    s_cbranch_scc0 gemnet_accum_kernel_sbbg_3
    s_cmp_eq_u32 s77, 3
    s_cselect_b64 exec, s[78:79], -1
    v_add_u32 v101, v101, v77
    v_lshlrev_b32 v77, 2, v101
    v_add_u32 v101, v101, v101
    ds_write_b32 v77, v50
    ds_write_b16 v101, v51 offset:28568
gemnet_accum_kernel_sbbg_3:
    s_cmp_gt_u32 s76, 4
    s_cbranch_scc0 gemnet_accum_kernel_sbbg_4
    s_cmp_eq_u32 s77, 4
    s_cselect_b64 exec, s[78:79], -1
    v_add_u32 v102, v102, v78
    v_lshlrev_b32 v78, 2, v102
    v_add_u32 v102, v102, v102
    ds_write_b32 v78, v52
    ds_write_b16 v102, v53 offset:28568
gemnet_accum_kernel_sbbg_4:
    s_cmp_gt_u32 s72, 4
    s_cbranch_scc0 gemnet_accum_kernel_snbg_4
    s_cmp_eq_u32 s73, 4
    s_cselect_b64 exec, s[74:75], -1
    buffer_load_dwordx2 v[22:23], v22, s[8:11], 0 offen
    s_mov_b64 exec, -1
gemnet_accum_kernel_snbg_4:
    s_cmp_gt_u32 s76, 5
    s_cbranch_scc0 gemnet_accum_kernel_sbbg_5
    s_cmp_eq_u32 s77, 5
    s_cselect_b64 exec, s[78:79], -1
    v_add_u32 v103, v103, v79
    v_lshlrev_b32 v79, 2, v103
    v_add_u32 v103, v103, v103
    ds_write_b32 v79, v54
    ds_write_b16 v103, v55 offset:28568
gemnet_accum_kernel_sbbg_5:
    s_cmp_gt_u32 s72, 5
    s_cbranch_scc0 gemnet_accum_kernel_snbg_5
    s_cmp_eq_u32 s73, 5
    s_cselect_b64 exec, s[74:75], -1
    buffer_load_dwordx2 v[24:25], v24, s[8:11], 0 offen
    s_mov_b64 exec, -1
gemnet_accum_kernel_snbg_5:
    s_cmp_gt_u32 s76, 6
    s_cbranch_scc0 gemnet_accum_kernel_sbbg_6
    s_cmp_eq_u32 s77, 6
    s_cselect_b64 exec, s[78:79], -1
    v_add_u32 v104, v104, v80
    v_lshlrev_b32 v80, 2, v104
    v_add_u32 v104, v104, v104
    ds_write_b32 v80, v56
    ds_write_b16 v104, v57 offset:28568
gemnet_accum_kernel_sbbg_6:
    s_cmp_gt_u32 s72, 6
    s_cbranch_scc0 gemnet_accum_kernel_snbg_6
    s_cmp_eq_u32 s73, 6
    s_cselect_b64 exec, s[74:75], -1
    buffer_load_dwordx2 v[26:27], v26, s[8:11], 0 offen
    s_mov_b64 exec, -1
gemnet_accum_kernel_snbg_6:
    s_cmp_gt_u32 s76, 7
    s_cbranch_scc0 gemnet_accum_kernel_sbbg_7
    s_cmp_eq_u32 s77, 7
    s_cselect_b64 exec, s[78:79], -1
    v_add_u32 v105, v105, v81
    v_lshlrev_b32 v81, 2, v105
    v_add_u32 v105, v105, v105
    ds_write_b32 v81, v58
    ds_write_b16 v105, v59 offset:28568
gemnet_accum_kernel_sbbg_7:
    s_cmp_gt_u32 s72, 7
    s_cbranch_scc0 gemnet_accum_kernel_snbg_7
    s_cmp_eq_u32 s73, 7
    s_cselect_b64 exec, s[74:75], -1
    buffer_load_dwordx2 v[28:29], v28, s[8:11], 0 offen
    s_mov_b64 exec, -1
gemnet_accum_kernel_snbg_7:
    s_cmp_gt_u32 s76, 8
    s_cbranch_scc0 gemnet_accum_kernel_sbbg_8
    s_cmp_eq_u32 s77, 8
    s_cselect_b64 exec, s[78:79], -1
    v_add_u32 v106, v106, v82
    v_lshlrev_b32 v82, 2, v106
    v_add_u32 v106, v106, v106
    ds_write_b32 v82, v60
    ds_write_b16 v106, v61 offset:28568
gemnet_accum_kernel_sbbg_8:
    s_cmp_gt_u32 s72, 8
    s_cbranch_scc0 gemnet_accum_kernel_snbg_8
    s_cmp_eq_u32 s73, 8
    s_cselect_b64 exec, s[74:75], -1
    buffer_load_dwordx2 v[30:31], v30, s[8:11], 0 offen
    s_mov_b64 exec, -1
gemnet_accum_kernel_snbg_8:
    s_cmp_gt_u32 s76, 9
    s_cbranch_scc0 gemnet_accum_kernel_sbbg_9
    s_cmp_eq_u32 s77, 9
    s_cselect_b64 exec, s[78:79], -1
    v_add_u32 v107, v107, v83
    v_lshlrev_b32 v83, 2, v107
    v_add_u32 v107, v107, v107
    ds_write_b32 v83, v62
    ds_write_b16 v107, v63 offset:28568
gemnet_accum_kernel_sbbg_9:
    s_cmp_gt_u32 s72, 9
    s_cbranch_scc0 gemnet_accum_kernel_snbg_9
    s_cmp_eq_u32 s73, 9
    s_cselect_b64 exec, s[74:75], -1
    buffer_load_dwordx2 v[32:33], v32, s[8:11], 0 offen
    s_mov_b64 exec, -1
gemnet_accum_kernel_snbg_9:
    s_cmp_gt_u32 s76, 10
    s_cbranch_scc0 gemnet_accum_kernel_sbbg_10
    s_cmp_eq_u32 s77, 10
    s_cselect_b64 exec, s[78:79], -1
    v_add_u32 v108, v108, v84
    v_lshlrev_b32 v84, 2, v108
    v_add_u32 v108, v108, v108
    ds_write_b32 v84, v64
    ds_write_b16 v108, v65 offset:28568
gemnet_accum_kernel_sbbg_10:
    s_cmp_gt_u32 s72, 10
    s_cbranch_scc0 gemnet_accum_kernel_snbg_10
    s_cmp_eq_u32 s73, 10
    s_cselect_b64 exec, s[74:75], -1
    buffer_load_dwordx2 v[34:35], v34, s[8:11], 0 offen
    s_mov_b64 exec, -1
gemnet_accum_kernel_snbg_10:
    s_cmp_gt_u32 s76, 11
    s_cbranch_scc0 gemnet_accum_kernel_sbbg_11
    s_cmp_eq_u32 s77, 11
    s_cselect_b64 exec, s[78:79], -1
    v_add_u32 v109, v109, v85
    v_lshlrev_b32 v85, 2, v109
    v_add_u32 v109, v109, v109
    ds_write_b32 v85, v66
    ds_write_b16 v109, v67 offset:28568
gemnet_accum_kernel_sbbg_11:
    s_cmp_gt_u32 s72, 11
    s_cbranch_scc0 gemnet_accum_kernel_snbg_11
    s_cmp_eq_u32 s73, 11
    s_cselect_b64 exec, s[74:75], -1
    buffer_load_dwordx2 v[36:37], v36, s[8:11], 0 offen
    s_mov_b64 exec, -1
gemnet_accum_kernel_snbg_11:
    s_cmp_gt_u32 s76, 12
    s_cbranch_scc0 gemnet_accum_kernel_sbbg_12
    s_cmp_eq_u32 s77, 12
    s_cselect_b64 exec, s[78:79], -1
    v_add_u32 v110, v110, v86
    v_lshlrev_b32 v86, 2, v110
    v_add_u32 v110, v110, v110
    ds_write_b32 v86, v68
    ds_write_b16 v110, v69 offset:28568
gemnet_accum_kernel_sbbg_12:
    s_cmp_gt_u32 s72, 12
    s_cbranch_scc0 gemnet_accum_kernel_snbg_12
    s_cmp_eq_u32 s73, 12
    s_cselect_b64 exec, s[74:75], -1
    buffer_load_dwordx2 v[38:39], v38, s[8:11], 0 offen
    s_mov_b64 exec, -1
gemnet_accum_kernel_snbg_12:
    s_cmp_gt_u32 s76, 13
    s_cbranch_scc0 gemnet_accum_kernel_sbbg_13
    s_cmp_eq_u32 s77, 13
    s_cselect_b64 exec, s[78:79], -1
    v_add_u32 v111, v111, v87
    v_lshlrev_b32 v87, 2, v111
    v_add_u32 v111, v111, v111
    ds_write_b32 v87, v70
    ds_write_b16 v111, v71 offset:28568
gemnet_accum_kernel_sbbg_13:
    s_cmp_gt_u32 s72, 13
    s_cbranch_scc0 gemnet_accum_kernel_snbg_13
    s_cmp_eq_u32 s73, 13
    s_cselect_b64 exec, s[74:75], -1
    buffer_load_dwordx2 v[40:41], v40, s[8:11], 0 offen
    s_mov_b64 exec, -1
gemnet_accum_kernel_snbg_13:
    s_cmp_gt_u32 s76, 14
    s_cbranch_scc0 gemnet_accum_kernel_sbbg_14
    s_cmp_eq_u32 s77, 14
    s_cselect_b64 exec, s[78:79], -1
    v_add_u32 v112, v112, v88
    v_lshlrev_b32 v88, 2, v112
    v_add_u32 v112, v112, v112
    ds_write_b32 v88, v72
    ds_write_b16 v112, v73 offset:28568
gemnet_accum_kernel_sbbg_14:
    s_cmp_gt_u32 s72, 14
    s_cbranch_scc0 gemnet_accum_kernel_snbg_14
    s_cmp_eq_u32 s73, 14
    s_cselect_b64 exec, s[74:75], -1
    buffer_load_dwordx2 v[42:43], v42, s[8:11], 0 offen
    s_mov_b64 exec, -1
gemnet_accum_kernel_snbg_14:
gemnet_accum_kernel_sceb:
    s_mov_b64 exec, -1
    s_waitcnt lgkmcnt(0)
    s_barrier
    s_cmp_lt_u32 s22, 13
    s_cbranch_scc0 gemnet_accum_kernel_nzb
    v_mov_b32 v91, 0
    s_lshl_b32 s64, s22, 8
    v_lshlrev_b32 v90, 2, v1
    v_add_u32 v90, s64, v90
    ds_write_b32 v90, v91 offset:3328
gemnet_accum_kernel_nzb:
    s_mul_i32 s64, s22, 832
    v_add_u32 v90, s64, v1
    v_add_u32 v91, v90, v90
    v_lshlrev_b32 v90, 2, v90
    v_add_u32 v90, 110384, v90
    v_add_u32 v91, 83760, v91
    ds_read_b32 v74, v90 offset:0
    ds_read_b32 v75, v90 offset:256
    s_sub_i32 s65, s26, s64
    s_max_i32 s65, s65, 0
    s_min_i32 s65, s65, 832
    s_lshr_b32 s27, s65, 6
    s_and_b32 s66, s65, 63
    s_bfm_b64 s[58:59], s66, 0
    s_cmp_lg_u32 s66, 0
    s_cselect_b64 s[60:61], s[58:59], 1
    s_addc_u32 s80, s27, 0
    v_mov_b32 v52, 0
    v_mov_b32 v53, 0
    v_mov_b32 v54, 0
    v_mov_b32 v55, 0
    v_mov_b32 v56, 0
    v_mov_b32 v57, 0
    v_mov_b32 v58, 0
    v_mov_b32 v59, 0
    v_mov_b32 v60, 0
    v_mov_b32 v61, 0
    v_mov_b32 v62, 0
    v_mov_b32 v63, 0
    v_mov_b32 v64, 0
    s_waitcnt lgkmcnt(0)
    s_cmp_eq_u32 s27, 0
    s_cselect_b64 s[62:63], s[60:61], 1
    v_and_b32 v65, 0xffff8, v74
    s_cmp_gt_u32 s27, 0
    s_cselect_b64 exec, -1, s[62:63]
    buffer_load_dwordx2 v[66:67], v65, s[4:7], s23 offen
    s_mov_b64 exec, -1
    s_cmp_eq_u32 s27, 1
    s_cselect_b64 s[62:63], s[60:61], 1
    v_and_b32 v65, 0xffff8, v75
    s_cmp_gt_u32 s27, 1
    s_cselect_b64 exec, -1, s[62:63]
    buffer_load_dwordx2 v[68:69], v65, s[4:7], s23 offen
    s_mov_b64 exec, -1
    ds_read_u16_d16_hi v52, v91 offset:0
    ds_read_u16_d16_hi v53, v91 offset:128
    ds_read_b32 v76, v90 offset:512
    ds_read_u16_d16_hi v54, v91 offset:256
    ds_read_b32 v77, v90 offset:768
    ds_read_u16_d16_hi v55, v91 offset:384
    ds_read_b32 v78, v90 offset:1024
    ds_read_u16_d16_hi v56, v91 offset:512
    ds_read_b32 v79, v90 offset:1280
    ds_read_u16_d16_hi v57, v91 offset:640
    ds_read_b32 v80, v90 offset:1536
    ds_read_u16_d16_hi v58, v91 offset:768
    ds_read_b32 v81, v90 offset:1792
    ds_read_u16_d16_hi v59, v91 offset:896
    ds_read_b32 v82, v90 offset:2048
    ds_read_u16_d16_hi v60, v91 offset:1024
    ds_read_b32 v83, v90 offset:2304
    ds_read_u16_d16_hi v61, v91 offset:1152
    ds_read_b32 v84, v90 offset:2560
    ds_read_u16_d16_hi v62, v91 offset:1280
    ds_read_b32 v85, v90 offset:2816
    ds_read_u16_d16_hi v63, v91 offset:1408
    ds_read_b32 v86, v90 offset:3072
    ds_read_u16_d16_hi v64, v91 offset:1536
    s_cmp_eq_u32 s81, 3
    s_cbranch_scc1 gemnet_accum_kernel_noflb
    v_sub_u32_sdwa v106, v11, v7 dst_sel:DWORD dst_unused:UNUSED_PAD src0_sel:WORD_1 src1_sel:WORD_1
    v_lshrrev_b32 v107, 16, v7
    v_mov_b32 v108, v106
    s_lshl_b32 s64, s22, 7
    v_lshlrev_b32 v110, 3, v1
    v_add_u32 v109, s64, v110
    v_mov_b32 v110, 0
    v_mov_b32 v111, 0
    s_mov_b64 exec, 0xffff
    ds_write_b64 v109, v[110:111] offset:6704
    s_mov_b64 exec, -1
    s_nop 1
    v_add_u32_dpp v108, v108, v108 row_shr:1 row_mask:0xf bank_mask:0xf
    s_nop 1
    v_add_u32_dpp v108, v108, v108 row_shr:2 row_mask:0xf bank_mask:0xf
    s_nop 1
    v_add_u32_dpp v108, v108, v108 row_shr:4 row_mask:0xf bank_mask:0xf
    s_nop 1
    v_add_u32_dpp v108, v108, v108 row_shr:8 row_mask:0xf bank_mask:0xf
    s_nop 1
    v_add_u32_dpp v108, v108, v108 row_bcast:15 row_mask:0xa bank_mask:0xf
    s_nop 1
    v_add_u32_dpp v108, v108, v108 row_bcast:31 row_mask:0xc bank_mask:0xf
    v_cmp_ne_u32 s[90:91], 0, v106
    s_nop 0
    v_readlane_b32 s88, v108, 63
    v_sub_u32 v108, v108, v106
    v_sub_u32 v107, v107, v108
    v_mul_i32_i24 v107, 6, v107
    v_add_u32 v107, v4, v107
    v_mbcnt_lo_u32_b32 v110, s90, 0
    v_mbcnt_hi_u32_b32 v110, s91, v110
    s_bcnt1_i32_b64 s65, s[90:91]
    v_sub_u32 v111, v1, v110
    v_add_u32 v111, s65, v111
    v_cndmask_b32 v110, v111, v110, s[90:91]
    v_lshlrev_b32 v110, 2, v110
    ds_permute_b32 v89, v110, v107
    v_cmp_ne_u32 vcc, 0, v108
    v_subrev_u32 v108, 1, v108
    s_and_b64 s[62:63], vcc, s[90:91]
    v_lshlrev_b32 v111, v108, v3
    v_lshrrev_b32 v108, 3, v108
    v_and_b32 v108, 0x7c, v108
    v_add_u32 v108, s64, v108
    s_cmp_eq_u64 s[62:63], 0
    s_cbranch_scc1 gemnet_accum_kernel_nomarkb
    s_mov_b64 exec, s[62:63]
    ds_or_b32 v108, v111 offset:6704
    s_mov_b64 exec, -1
gemnet_accum_kernel_nomarkb:
    ds_read_b32 v127, v109 offset:6704
    ds_read_b32 v0, v109 offset:6708
    s_add_u32 s76, s88, 63
    s_lshr_b32 s76, s76, 6
    s_sub_u32 s77, s76, 1
    s_lshr_b32 s69, s88, 6
    s_and_b32 s65, s88, 63
    s_bfm_b64 s[78:79], s65, 0
    s_cmp_eq_u32 s65, 0
    s_cselect_b64 s[78:79], -1, s[78:79]
    s_mov_b32 s24, 0
    s_branch gemnet_accum_kernel_fldb
gemnet_accum_kernel_noflb:
    s_mov_b32 s76, 0
    s_mov_b32 s69, 0
gemnet_accum_kernel_fldb:
    s_waitcnt lgkmcnt(0)
    s_cmp_ge_u32 s27, 2
    s_cbranch_scc0 gemnet_accum_kernel_tailb_0
    s_setprio 3
    s_cmp_ge_u32 s27, 4
    s_cbranch_scc0 gemnet_accum_kernel_g2sb_0
    v_and_b32 v65, 0xffff8, v76
    buffer_load_dwordx2 v[70:71], v65, s[4:7], s23 offen
    v_and_b32 v65, 0xffff8, v77
    buffer_load_dwordx2 v[72:73], v65, s[4:7], s23 offen
    s_branch gemnet_accum_kernel_g2eb_0
gemnet_accum_kernel_g2sb_0:
    s_cmp_eq_u32 s27, 2
    s_cselect_b64 s[62:63], s[60:61], 1
    v_and_b32 v65, 0xffff8, v76
    s_cmp_gt_u32 s27, 2
    s_cselect_b64 exec, -1, s[62:63]
    buffer_load_dwordx2 v[70:71], v65, s[4:7], s23 offen
    s_mov_b64 exec, -1
    s_cmp_eq_u32 s27, 3
    s_cselect_b64 s[62:63], s[60:61], 1
    v_and_b32 v65, 0xffff8, v77
    s_cmp_gt_u32 s27, 3
    s_cselect_b64 exec, -1, s[62:63]
    buffer_load_dwordx2 v[72:73], v65, s[4:7], s23 offen
    s_mov_b64 exec, -1
gemnet_accum_kernel_g2eb_0:
    v_lshrrev_b32 v94, 16, v74
    v_lshrrev_b32 v110, 16, v75
    v_and_b32 v94, 0xfff0, v94
    v_and_b32 v110, 0xfff0, v110
    ds_read_b128 v[90:93], v94 offset:33760
    ds_read_b128 v[106:109], v110 offset:33760
    v_lshrrev_b32 v74, 1, v94
    v_lshrrev_b32 v75, 1, v110
    v_mul_f32 v94, s20, v52
    v_mul_f32 v110, s20, v53
    v_fract_f32 v94, v94
    v_fract_f32 v110, v110
    v_cos_f32 v94, v94
    v_cos_f32 v110, v110
    v_add_f32 v95, v94, v94
    v_add_f32 v111, v110, v110
    v_fma_f32 v95, v95, v94, -1.0
    v_fma_f32 v111, v111, v110, -1.0
    v_cvt_pk_bf16_f32 v95, v94, v95
    v_cvt_pk_bf16_f32 v111, v110, v111
    s_waitcnt vmcnt(2)
    v_mfma_f32_4x4x4_16b_bf16 v[96:99], v[122:123], v[66:67], 0
    v_mfma_f32_4x4x4_16b_bf16 v[112:115], v[122:123], v[68:69], 0
    s_waitcnt lgkmcnt(0)
    ds_read_b64 v[104:105], v74 offset:8752
    ds_read_b64 v[120:121], v75 offset:8752
    v_dot2_f32_bf16 v100, v90, v95, 0
    v_dot2_f32_bf16 v116, v106, v111, 0
    v_dot2_f32_bf16 v101, v91, v95, 0
    v_dot2_f32_bf16 v117, v107, v111, 0
    v_dot2_f32_bf16 v102, v92, v95, 0
    v_dot2_f32_bf16 v118, v108, v111, 0
    v_dot2_f32_bf16 v103, v93, v95, 0
    v_dot2_f32_bf16 v119, v109, v111, 0
    v_pk_mul_f32 v[96:97], v[96:97], v[100:101]
    v_pk_mul_f32 v[112:113], v[112:113], v[116:117]
    v_pk_mul_f32 v[98:99], v[98:99], v[102:103]
    v_pk_mul_f32 v[114:115], v[114:115], v[118:119]
    s_waitcnt lgkmcnt(0)
    s_nop 0
    v_mfma_f32_4x4x4_16b_bf16 v[100:103], v[124:125], v[104:105], v[96:99]
    v_mfma_f32_4x4x4_16b_bf16 v[116:119], v[124:125], v[120:121], v[112:115]
    s_nop 3
    v_cvt_pk_bf16_f32 v90, v100, v101
    v_cvt_pk_bf16_f32 v91, v102, v103
    ds_cmpst_rtn_b64 v[92:93], v74, v[104:105], v[90:91] offset:8752
    v_cvt_pk_bf16_f32 v106, v116, v117
    v_cvt_pk_bf16_f32 v107, v118, v119
    ds_cmpst_rtn_b64 v[108:109], v75, v[120:121], v[106:107] offset:8752
    s_waitcnt lgkmcnt(0)
    v_cmp_ne_u64 vcc, v[92:93], v[104:105]
    s_mov_b64 s[70:71], vcc
    v_cmp_ne_u64 vcc, v[108:109], v[120:121]
    s_mov_b64 s[90:91], vcc
    s_or_b64 s[62:63], s[70:71], vcc
    s_cbranch_scc0 gemnet_accum_kernel_pokb_0
    s_bcnt1_i32_b64 s65, s[70:71]
    s_bcnt1_i32_b64 s66, s[90:91]
    s_add_u32 s65, s65, s66
    s_cmp_le_u32 s65, 6
    s_cbranch_scc1 gemnet_accum_kernel_ppkb_0
gemnet_accum_kernel_prtb_0:
    v_mfma_f32_4x4x4_16b_bf16 v[100:103], v[124:125], v[92:93], v[96:99]
    v_mfma_f32_4x4x4_16b_bf16 v[116:119], v[124:125], v[108:109], v[112:115]
    s_mov_b64 exec, s[70:71]
    s_nop 2
    v_cvt_pk_bf16_f32 v90, v100, v101
    v_cvt_pk_bf16_f32 v91, v102, v103
    ds_cmpst_rtn_b64 v[104:105], v74, v[92:93], v[90:91] offset:8752
    s_mov_b64 exec, s[90:91]
    v_cvt_pk_bf16_f32 v106, v116, v117
    v_cvt_pk_bf16_f32 v107, v118, v119
    ds_cmpst_rtn_b64 v[120:121], v75, v[108:109], v[106:107] offset:8752
    s_waitcnt lgkmcnt(0)
    v_cmp_ne_u64 vcc, v[108:109], v[120:121]
    s_mov_b64 s[90:91], vcc
    s_mov_b64 exec, s[70:71]
    v_cmp_ne_u64 vcc, v[92:93], v[104:105]
    s_mov_b64 s[70:71], vcc
    s_or_b64 s[62:63], s[90:91], vcc
    s_cbranch_scc0 gemnet_accum_kernel_pfinb_0
gemnet_accum_kernel_ppkb_0:
    s_mov_b64 exec, s[70:71]
    s_cbranch_execz gemnet_accum_kernel_pkab_0
    v_cvt_pk_bf16_f32 v90, v96, v97
    v_cvt_pk_bf16_f32 v91, v98, v99
    ds_pk_add_bf16 v74, v90 offset:8752
    ds_pk_add_bf16 v74, v91 offset:8756
gemnet_accum_kernel_pkab_0:
    s_mov_b64 exec, s[90:91]
    s_cbranch_execz gemnet_accum_kernel_pfinb_0
    v_cvt_pk_bf16_f32 v106, v112, v113
    v_cvt_pk_bf16_f32 v107, v114, v115
    ds_pk_add_bf16 v75, v106 offset:8752
    ds_pk_add_bf16 v75, v107 offset:8756
gemnet_accum_kernel_pfinb_0:
    s_mov_b64 exec, -1
gemnet_accum_kernel_pokb_0:
    v_lshrrev_b32 v126, 16, v14
    v_cndmask_b32 v14, v14, v15, s[28:29]
    v_cndmask_b32 v15, v15, v126, s[28:29]
    v_lshrrev_b32 v126, 16, v16
    v_cndmask_b32 v16, v16, v17, s[30:31]
    v_cndmask_b32 v17, v17, v126, s[30:31]
    v_lshrrev_b32 v126, 16, v18
    v_cndmask_b32 v18, v18, v19, s[32:33]
    v_cndmask_b32 v19, v19, v126, s[32:33]
    v_lshrrev_b32 v126, 16, v20
    v_cndmask_b32 v20, v20, v21, s[34:35]
    v_cndmask_b32 v21, v21, v126, s[34:35]
    v_lshrrev_b32 v126, 16, v22
    v_cndmask_b32 v22, v22, v23, s[36:37]
    v_cndmask_b32 v23, v23, v126, s[36:37]
    v_lshrrev_b32 v126, 16, v24
    v_cndmask_b32 v24, v24, v25, s[38:39]
    v_cndmask_b32 v25, v25, v126, s[38:39]
    v_lshrrev_b32 v126, 16, v26
    v_cndmask_b32 v26, v26, v27, s[40:41]
    v_cndmask_b32 v27, v27, v126, s[40:41]
    v_lshrrev_b32 v126, 16, v28
    v_cndmask_b32 v28, v28, v29, s[42:43]
    v_cndmask_b32 v29, v29, v126, s[42:43]
    v_lshrrev_b32 v126, 16, v30
    v_cndmask_b32 v30, v30, v31, s[44:45]
    v_cndmask_b32 v31, v31, v126, s[44:45]
    v_lshrrev_b32 v126, 16, v32
    v_cndmask_b32 v32, v32, v33, s[46:47]
    v_cndmask_b32 v33, v33, v126, s[46:47]
    v_lshrrev_b32 v126, 16, v34
    v_cndmask_b32 v34, v34, v35, s[48:49]
    v_cndmask_b32 v35, v35, v126, s[48:49]
    v_lshrrev_b32 v126, 16, v36
    v_cndmask_b32 v36, v36, v37, s[50:51]
    v_cndmask_b32 v37, v37, v126, s[50:51]
    v_lshrrev_b32 v126, 16, v38
    v_cndmask_b32 v38, v38, v39, s[52:53]
    v_cndmask_b32 v39, v39, v126, s[52:53]
    s_cmp_gt_u32 s72, 13
    s_cbranch_scc0 gemnet_accum_kernel_decbn
    v_lshrrev_b32 v126, 16, v40
    v_cndmask_b32 v40, v40, v41, s[54:55]
    v_cndmask_b32 v41, v41, v126, s[54:55]
    s_cmp_gt_u32 s72, 14
    s_cbranch_scc0 gemnet_accum_kernel_decbn
    v_lshrrev_b32 v126, 16, v42
    v_cndmask_b32 v42, v42, v43, s[56:57]
    v_cndmask_b32 v43, v43, v126, s[56:57]
gemnet_accum_kernel_decbn:
    s_cmp_ge_u32 s68, 2
    s_cbranch_scc0 gemnet_accum_kernel_h2sbn_0
    v_lshrrev_b32 v126, 8, v14
    v_and_b32 v126, 4092, v126
    ds_add_rtn_u32 v74, v126, v3 offset:0
    v_lshrrev_b32 v126, 8, v16
    v_and_b32 v126, 4092, v126
    ds_add_rtn_u32 v75, v126, v3 offset:0
    s_branch gemnet_accum_kernel_h2ebn_0
gemnet_accum_kernel_h2sbn_0:
    s_cmp_gt_u32 s72, 0
    s_cbranch_scc0 gemnet_accum_kernel_hgbn_0
    s_cmp_eq_u32 s73, 0
    s_cselect_b64 exec, s[74:75], -1
    v_lshrrev_b32 v126, 8, v14
    v_and_b32 v126, 4092, v126
    ds_add_rtn_u32 v74, v126, v3 offset:0
    s_mov_b64 exec, -1
gemnet_accum_kernel_hgbn_0:
    s_cmp_gt_u32 s72, 1
    s_cbranch_scc0 gemnet_accum_kernel_hgbn_1
    s_cmp_eq_u32 s73, 1
    s_cselect_b64 exec, s[74:75], -1
    v_lshrrev_b32 v126, 8, v16
    v_and_b32 v126, 4092, v126
    ds_add_rtn_u32 v75, v126, v3 offset:0
    s_mov_b64 exec, -1
gemnet_accum_kernel_hgbn_1:
gemnet_accum_kernel_h2ebn_0:
    v_readlane_b32 s62, v127, 0
    v_readlane_b32 s63, v0, 0
    s_nop 1
    v_mbcnt_lo_u32_b32 v126, s62, 0
    v_mbcnt_hi_u32_b32 v126, s63, v126
    v_add_lshl_u32 v126, v126, s24, 2
    s_bcnt1_i32_b64 s65, s[62:63]
    ds_bpermute_b32 v44, v126, v89
    s_add_u32 s24, s24, s65
gemnet_accum_kernel_fabn_0:
    v_readlane_b32 s62, v127, 1
    v_readlane_b32 s63, v0, 1
    s_nop 1
    v_mbcnt_lo_u32_b32 v126, s62, 0
    v_mbcnt_hi_u32_b32 v126, s63, v126
    v_add_lshl_u32 v126, v126, s24, 2
    s_bcnt1_i32_b64 s65, s[62:63]
    ds_bpermute_b32 v46, v126, v89
    s_add_u32 s24, s24, s65
gemnet_accum_kernel_fabn_1:
    v_readlane_b32 s62, v127, 2
    v_readlane_b32 s63, v0, 2
    s_nop 1
    v_mbcnt_lo_u32_b32 v126, s62, 0
    v_mbcnt_hi_u32_b32 v126, s63, v126
    v_add_lshl_u32 v126, v126, s24, 2
    s_bcnt1_i32_b64 s65, s[62:63]
    ds_bpermute_b32 v48, v126, v89
    s_add_u32 s24, s24, s65
gemnet_accum_kernel_fabn_2:
    v_readlane_b32 s62, v127, 3
    v_readlane_b32 s63, v0, 3
    s_nop 1
    v_mbcnt_lo_u32_b32 v126, s62, 0
    v_mbcnt_hi_u32_b32 v126, s63, v126
    v_add_lshl_u32 v126, v126, s24, 2
    s_bcnt1_i32_b64 s65, s[62:63]
    ds_bpermute_b32 v50, v126, v89
    s_add_u32 s24, s24, s65
gemnet_accum_kernel_fabn_3:
    v_readlane_b32 s62, v127, 4
    v_readlane_b32 s63, v0, 4
    s_nop 1
    v_mbcnt_lo_u32_b32 v126, s62, 0
    v_mbcnt_hi_u32_b32 v126, s63, v126
    v_add_lshl_u32 v126, v126, s24, 2
    s_bcnt1_i32_b64 s65, s[62:63]
    ds_bpermute_b32 v52, v126, v89
    s_add_u32 s24, s24, s65
gemnet_accum_kernel_fabn_4:
    s_cmp_ge_u32 s27, 4
    s_cbranch_scc0 gemnet_accum_kernel_tailb_2
    s_setprio 3
    s_cmp_ge_u32 s27, 6
    s_cbranch_scc0 gemnet_accum_kernel_g2sb_1
    v_and_b32 v65, 0xffff8, v78
    buffer_load_dwordx2 v[66:67], v65, s[4:7], s23 offen
    v_and_b32 v65, 0xffff8, v79
    buffer_load_dwordx2 v[68:69], v65, s[4:7], s23 offen
    s_branch gemnet_accum_kernel_g2eb_1
gemnet_accum_kernel_g2sb_1:
    s_cmp_eq_u32 s27, 4
    s_cselect_b64 s[62:63], s[60:61], 1
    v_and_b32 v65, 0xffff8, v78
    s_cmp_gt_u32 s27, 4
    s_cselect_b64 exec, -1, s[62:63]
    buffer_load_dwordx2 v[66:67], v65, s[4:7], s23 offen
    s_mov_b64 exec, -1
    s_cmp_eq_u32 s27, 5
    s_cselect_b64 s[62:63], s[60:61], 1
    v_and_b32 v65, 0xffff8, v79
    s_cmp_gt_u32 s27, 5
    s_cselect_b64 exec, -1, s[62:63]
    buffer_load_dwordx2 v[68:69], v65, s[4:7], s23 offen
    s_mov_b64 exec, -1
gemnet_accum_kernel_g2eb_1:
    v_lshrrev_b32 v94, 16, v76
    v_lshrrev_b32 v110, 16, v77
    v_and_b32 v94, 0xfff0, v94
    v_and_b32 v110, 0xfff0, v110
    ds_read_b128 v[90:93], v94 offset:33760
    ds_read_b128 v[106:109], v110 offset:33760
    v_lshrrev_b32 v76, 1, v94
    v_lshrrev_b32 v77, 1, v110
    v_mul_f32 v94, s20, v54
    v_mul_f32 v110, s20, v55
    v_fract_f32 v94, v94
    v_fract_f32 v110, v110
    v_cos_f32 v94, v94
    v_cos_f32 v110, v110
    v_add_f32 v95, v94, v94
    v_add_f32 v111, v110, v110
    v_fma_f32 v95, v95, v94, -1.0
    v_fma_f32 v111, v111, v110, -1.0
    v_cvt_pk_bf16_f32 v95, v94, v95
    v_cvt_pk_bf16_f32 v111, v110, v111
    s_waitcnt vmcnt(2)
    v_mfma_f32_4x4x4_16b_bf16 v[96:99], v[122:123], v[70:71], 0
    v_mfma_f32_4x4x4_16b_bf16 v[112:115], v[122:123], v[72:73], 0
    s_waitcnt lgkmcnt(0)
    ds_read_b64 v[104:105], v76 offset:8752
    ds_read_b64 v[120:121], v77 offset:8752
    v_dot2_f32_bf16 v100, v90, v95, 0
    v_dot2_f32_bf16 v116, v106, v111, 0
    v_dot2_f32_bf16 v101, v91, v95, 0
    v_dot2_f32_bf16 v117, v107, v111, 0
    v_dot2_f32_bf16 v102, v92, v95, 0
    v_dot2_f32_bf16 v118, v108, v111, 0
    v_dot2_f32_bf16 v103, v93, v95, 0
    v_dot2_f32_bf16 v119, v109, v111, 0
    v_pk_mul_f32 v[96:97], v[96:97], v[100:101]
    v_pk_mul_f32 v[112:113], v[112:113], v[116:117]
    v_pk_mul_f32 v[98:99], v[98:99], v[102:103]
    v_pk_mul_f32 v[114:115], v[114:115], v[118:119]
    s_waitcnt lgkmcnt(0)
    s_nop 0
    v_mfma_f32_4x4x4_16b_bf16 v[100:103], v[124:125], v[104:105], v[96:99]
    v_mfma_f32_4x4x4_16b_bf16 v[116:119], v[124:125], v[120:121], v[112:115]
    s_nop 3
    v_cvt_pk_bf16_f32 v90, v100, v101
    v_cvt_pk_bf16_f32 v91, v102, v103
    ds_cmpst_rtn_b64 v[92:93], v76, v[104:105], v[90:91] offset:8752
    v_cvt_pk_bf16_f32 v106, v116, v117
    v_cvt_pk_bf16_f32 v107, v118, v119
    ds_cmpst_rtn_b64 v[108:109], v77, v[120:121], v[106:107] offset:8752
    s_waitcnt lgkmcnt(0)
    v_cmp_ne_u64 vcc, v[92:93], v[104:105]
    s_mov_b64 s[70:71], vcc
    v_cmp_ne_u64 vcc, v[108:109], v[120:121]
    s_mov_b64 s[90:91], vcc
    s_or_b64 s[62:63], s[70:71], vcc
    s_cbranch_scc0 gemnet_accum_kernel_pokb_1
    s_bcnt1_i32_b64 s65, s[70:71]
    s_bcnt1_i32_b64 s66, s[90:91]
    s_add_u32 s65, s65, s66
    s_cmp_le_u32 s65, 6
    s_cbranch_scc1 gemnet_accum_kernel_ppkb_1
gemnet_accum_kernel_prtb_1:
    v_mfma_f32_4x4x4_16b_bf16 v[100:103], v[124:125], v[92:93], v[96:99]
    v_mfma_f32_4x4x4_16b_bf16 v[116:119], v[124:125], v[108:109], v[112:115]
    s_mov_b64 exec, s[70:71]
    s_nop 2
    v_cvt_pk_bf16_f32 v90, v100, v101
    v_cvt_pk_bf16_f32 v91, v102, v103
    ds_cmpst_rtn_b64 v[104:105], v76, v[92:93], v[90:91] offset:8752
    s_mov_b64 exec, s[90:91]
    v_cvt_pk_bf16_f32 v106, v116, v117
    v_cvt_pk_bf16_f32 v107, v118, v119
    ds_cmpst_rtn_b64 v[120:121], v77, v[108:109], v[106:107] offset:8752
    s_waitcnt lgkmcnt(0)
    v_cmp_ne_u64 vcc, v[108:109], v[120:121]
    s_mov_b64 s[90:91], vcc
    s_mov_b64 exec, s[70:71]
    v_cmp_ne_u64 vcc, v[92:93], v[104:105]
    s_mov_b64 s[70:71], vcc
    s_or_b64 s[62:63], s[90:91], vcc
    s_cbranch_scc0 gemnet_accum_kernel_pfinb_1
gemnet_accum_kernel_ppkb_1:
    s_mov_b64 exec, s[70:71]
    s_cbranch_execz gemnet_accum_kernel_pkab_1
    v_cvt_pk_bf16_f32 v90, v96, v97
    v_cvt_pk_bf16_f32 v91, v98, v99
    ds_pk_add_bf16 v76, v90 offset:8752
    ds_pk_add_bf16 v76, v91 offset:8756
gemnet_accum_kernel_pkab_1:
    s_mov_b64 exec, s[90:91]
    s_cbranch_execz gemnet_accum_kernel_pfinb_1
    v_cvt_pk_bf16_f32 v106, v112, v113
    v_cvt_pk_bf16_f32 v107, v114, v115
    ds_pk_add_bf16 v77, v106 offset:8752
    ds_pk_add_bf16 v77, v107 offset:8756
gemnet_accum_kernel_pfinb_1:
    s_mov_b64 exec, -1
gemnet_accum_kernel_pokb_1:
    s_cmp_ge_u32 s68, 4
    s_cbranch_scc0 gemnet_accum_kernel_h2sbn_2
    v_lshrrev_b32 v126, 8, v18
    v_and_b32 v126, 4092, v126
    ds_add_rtn_u32 v76, v126, v3 offset:0
    v_lshrrev_b32 v126, 8, v20
    v_and_b32 v126, 4092, v126
    ds_add_rtn_u32 v77, v126, v3 offset:0
    s_branch gemnet_accum_kernel_h2ebn_2
gemnet_accum_kernel_h2sbn_2:
    s_cmp_gt_u32 s72, 2
    s_cbranch_scc0 gemnet_accum_kernel_hgbn_2
    s_cmp_eq_u32 s73, 2
    s_cselect_b64 exec, s[74:75], -1
    v_lshrrev_b32 v126, 8, v18
    v_and_b32 v126, 4092, v126
    ds_add_rtn_u32 v76, v126, v3 offset:0
    s_mov_b64 exec, -1
gemnet_accum_kernel_hgbn_2:
    s_cmp_gt_u32 s72, 3
    s_cbranch_scc0 gemnet_accum_kernel_hgbn_3
    s_cmp_eq_u32 s73, 3
    s_cselect_b64 exec, s[74:75], -1
    v_lshrrev_b32 v126, 8, v20
    v_and_b32 v126, 4092, v126
    ds_add_rtn_u32 v77, v126, v3 offset:0
    s_mov_b64 exec, -1
gemnet_accum_kernel_hgbn_3:
gemnet_accum_kernel_h2ebn_2:
    s_movk_i32 s25, 0
    v_add3_u32 v45, v44, v2, s25
    v_and_b32 v44, -4, v45
    v_cmp_ne_u32 s[28:29], v44, v45
gemnet_accum_kernel_fbbn_0:
    s_movk_i32 s25, 384
    v_add3_u32 v47, v46, v2, s25
    v_and_b32 v46, -4, v47
    v_cmp_ne_u32 s[30:31], v46, v47
gemnet_accum_kernel_fbbn_1:
    s_movk_i32 s25, 768
    v_add3_u32 v49, v48, v2, s25
    v_and_b32 v48, -4, v49
    v_cmp_ne_u32 s[32:33], v48, v49
gemnet_accum_kernel_fbbn_2:
    s_movk_i32 s25, 1152
    v_add3_u32 v51, v50, v2, s25
    v_and_b32 v50, -4, v51
    v_cmp_ne_u32 s[34:35], v50, v51
gemnet_accum_kernel_fbbn_3:
    s_movk_i32 s25, 1536
    v_add3_u32 v53, v52, v2, s25
    v_and_b32 v52, -4, v53
    v_cmp_ne_u32 s[36:37], v52, v53
gemnet_accum_kernel_fbbn_4:
    v_readlane_b32 s62, v127, 5
    v_readlane_b32 s63, v0, 5
    s_nop 1
    v_mbcnt_lo_u32_b32 v126, s62, 0
    v_mbcnt_hi_u32_b32 v126, s63, v126
    v_add_lshl_u32 v126, v126, s24, 2
    s_bcnt1_i32_b64 s65, s[62:63]
    ds_bpermute_b32 v54, v126, v89
    s_add_u32 s24, s24, s65
gemnet_accum_kernel_fabn_5:
    s_cmp_ge_u32 s27, 6
    s_cbranch_scc0 gemnet_accum_kernel_tailb_4
    s_setprio 2
    s_cmp_ge_u32 s27, 8
    s_cbranch_scc0 gemnet_accum_kernel_g2sb_2
    v_and_b32 v65, 0xffff8, v80
    buffer_load_dwordx2 v[70:71], v65, s[4:7], s23 offen
    v_and_b32 v65, 0xffff8, v81
    buffer_load_dwordx2 v[72:73], v65, s[4:7], s23 offen
    s_branch gemnet_accum_kernel_g2eb_2
gemnet_accum_kernel_g2sb_2:
    s_cmp_eq_u32 s27, 6
    s_cselect_b64 s[62:63], s[60:61], 1
    v_and_b32 v65, 0xffff8, v80
    s_cmp_gt_u32 s27, 6
    s_cselect_b64 exec, -1, s[62:63]
    buffer_load_dwordx2 v[70:71], v65, s[4:7], s23 offen
    s_mov_b64 exec, -1
    s_cmp_eq_u32 s27, 7
    s_cselect_b64 s[62:63], s[60:61], 1
    v_and_b32 v65, 0xffff8, v81
    s_cmp_gt_u32 s27, 7
    s_cselect_b64 exec, -1, s[62:63]
    buffer_load_dwordx2 v[72:73], v65, s[4:7], s23 offen
    s_mov_b64 exec, -1
gemnet_accum_kernel_g2eb_2:
    v_lshrrev_b32 v94, 16, v78
    v_lshrrev_b32 v110, 16, v79
    v_and_b32 v94, 0xfff0, v94
    v_and_b32 v110, 0xfff0, v110
    ds_read_b128 v[90:93], v94 offset:33760
    ds_read_b128 v[106:109], v110 offset:33760
    v_lshrrev_b32 v78, 1, v94
    v_lshrrev_b32 v79, 1, v110
    v_mul_f32 v94, s20, v56
    v_mul_f32 v110, s20, v57
    v_fract_f32 v94, v94
    v_fract_f32 v110, v110
    v_cos_f32 v94, v94
    v_cos_f32 v110, v110
    v_add_f32 v95, v94, v94
    v_add_f32 v111, v110, v110
    v_fma_f32 v95, v95, v94, -1.0
    v_fma_f32 v111, v111, v110, -1.0
    v_cvt_pk_bf16_f32 v95, v94, v95
    v_cvt_pk_bf16_f32 v111, v110, v111
    s_waitcnt vmcnt(2)
    v_mfma_f32_4x4x4_16b_bf16 v[96:99], v[122:123], v[66:67], 0
    v_mfma_f32_4x4x4_16b_bf16 v[112:115], v[122:123], v[68:69], 0
    s_waitcnt lgkmcnt(0)
    ds_read_b64 v[104:105], v78 offset:8752
    ds_read_b64 v[120:121], v79 offset:8752
    v_dot2_f32_bf16 v100, v90, v95, 0
    v_dot2_f32_bf16 v116, v106, v111, 0
    v_dot2_f32_bf16 v101, v91, v95, 0
    v_dot2_f32_bf16 v117, v107, v111, 0
    v_dot2_f32_bf16 v102, v92, v95, 0
    v_dot2_f32_bf16 v118, v108, v111, 0
    v_dot2_f32_bf16 v103, v93, v95, 0
    v_dot2_f32_bf16 v119, v109, v111, 0
    v_pk_mul_f32 v[96:97], v[96:97], v[100:101]
    v_pk_mul_f32 v[112:113], v[112:113], v[116:117]
    v_pk_mul_f32 v[98:99], v[98:99], v[102:103]
    v_pk_mul_f32 v[114:115], v[114:115], v[118:119]
    s_waitcnt lgkmcnt(0)
    s_nop 0
    v_mfma_f32_4x4x4_16b_bf16 v[100:103], v[124:125], v[104:105], v[96:99]
    v_mfma_f32_4x4x4_16b_bf16 v[116:119], v[124:125], v[120:121], v[112:115]
    s_nop 3
    v_cvt_pk_bf16_f32 v90, v100, v101
    v_cvt_pk_bf16_f32 v91, v102, v103
    ds_cmpst_rtn_b64 v[92:93], v78, v[104:105], v[90:91] offset:8752
    v_cvt_pk_bf16_f32 v106, v116, v117
    v_cvt_pk_bf16_f32 v107, v118, v119
    ds_cmpst_rtn_b64 v[108:109], v79, v[120:121], v[106:107] offset:8752
    s_waitcnt lgkmcnt(0)
    v_cmp_ne_u64 vcc, v[92:93], v[104:105]
    s_mov_b64 s[70:71], vcc
    v_cmp_ne_u64 vcc, v[108:109], v[120:121]
    s_mov_b64 s[90:91], vcc
    s_or_b64 s[62:63], s[70:71], vcc
    s_cbranch_scc0 gemnet_accum_kernel_pokb_2
    s_bcnt1_i32_b64 s65, s[70:71]
    s_bcnt1_i32_b64 s66, s[90:91]
    s_add_u32 s65, s65, s66
    s_cmp_le_u32 s65, 6
    s_cbranch_scc1 gemnet_accum_kernel_ppkb_2
gemnet_accum_kernel_prtb_2:
    v_mfma_f32_4x4x4_16b_bf16 v[100:103], v[124:125], v[92:93], v[96:99]
    v_mfma_f32_4x4x4_16b_bf16 v[116:119], v[124:125], v[108:109], v[112:115]
    s_mov_b64 exec, s[70:71]
    s_nop 2
    v_cvt_pk_bf16_f32 v90, v100, v101
    v_cvt_pk_bf16_f32 v91, v102, v103
    ds_cmpst_rtn_b64 v[104:105], v78, v[92:93], v[90:91] offset:8752
    s_mov_b64 exec, s[90:91]
    v_cvt_pk_bf16_f32 v106, v116, v117
    v_cvt_pk_bf16_f32 v107, v118, v119
    ds_cmpst_rtn_b64 v[120:121], v79, v[108:109], v[106:107] offset:8752
    s_waitcnt lgkmcnt(0)
    v_cmp_ne_u64 vcc, v[108:109], v[120:121]
    s_mov_b64 s[90:91], vcc
    s_mov_b64 exec, s[70:71]
    v_cmp_ne_u64 vcc, v[92:93], v[104:105]
    s_mov_b64 s[70:71], vcc
    s_or_b64 s[62:63], s[90:91], vcc
    s_cbranch_scc0 gemnet_accum_kernel_pfinb_2
gemnet_accum_kernel_ppkb_2:
    s_mov_b64 exec, s[70:71]
    s_cbranch_execz gemnet_accum_kernel_pkab_2
    v_cvt_pk_bf16_f32 v90, v96, v97
    v_cvt_pk_bf16_f32 v91, v98, v99
    ds_pk_add_bf16 v78, v90 offset:8752
    ds_pk_add_bf16 v78, v91 offset:8756
gemnet_accum_kernel_pkab_2:
    s_mov_b64 exec, s[90:91]
    s_cbranch_execz gemnet_accum_kernel_pfinb_2
    v_cvt_pk_bf16_f32 v106, v112, v113
    v_cvt_pk_bf16_f32 v107, v114, v115
    ds_pk_add_bf16 v79, v106 offset:8752
    ds_pk_add_bf16 v79, v107 offset:8756
gemnet_accum_kernel_pfinb_2:
    s_mov_b64 exec, -1
gemnet_accum_kernel_pokb_2:
    s_cmp_ge_u32 s68, 6
    s_cbranch_scc0 gemnet_accum_kernel_h2sbn_4
    v_lshrrev_b32 v126, 8, v22
    v_and_b32 v126, 4092, v126
    ds_add_rtn_u32 v78, v126, v3 offset:0
    v_lshrrev_b32 v126, 8, v24
    v_and_b32 v126, 4092, v126
    ds_add_rtn_u32 v79, v126, v3 offset:0
    s_branch gemnet_accum_kernel_h2ebn_4
gemnet_accum_kernel_h2sbn_4:
    s_cmp_gt_u32 s72, 4
    s_cbranch_scc0 gemnet_accum_kernel_hgbn_4
    s_cmp_eq_u32 s73, 4
    s_cselect_b64 exec, s[74:75], -1
    v_lshrrev_b32 v126, 8, v22
    v_and_b32 v126, 4092, v126
    ds_add_rtn_u32 v78, v126, v3 offset:0
    s_mov_b64 exec, -1
gemnet_accum_kernel_hgbn_4:
    s_cmp_gt_u32 s72, 5
    s_cbranch_scc0 gemnet_accum_kernel_hgbn_5
    s_cmp_eq_u32 s73, 5
    s_cselect_b64 exec, s[74:75], -1
    v_lshrrev_b32 v126, 8, v24
    v_and_b32 v126, 4092, v126
    ds_add_rtn_u32 v79, v126, v3 offset:0
    s_mov_b64 exec, -1
gemnet_accum_kernel_hgbn_5:
gemnet_accum_kernel_h2ebn_4:
    s_movk_i32 s25, 1920
    v_add3_u32 v55, v54, v2, s25
    v_and_b32 v54, -4, v55
    v_cmp_ne_u32 s[38:39], v54, v55
gemnet_accum_kernel_fbbn_5:
    v_readlane_b32 s62, v127, 6
    v_readlane_b32 s63, v0, 6
    s_nop 1
    v_mbcnt_lo_u32_b32 v126, s62, 0
    v_mbcnt_hi_u32_b32 v126, s63, v126
    v_add_lshl_u32 v126, v126, s24, 2
    s_bcnt1_i32_b64 s65, s[62:63]
    ds_bpermute_b32 v56, v126, v89
    s_add_u32 s24, s24, s65
gemnet_accum_kernel_fabn_6:
    s_cmp_ge_u32 s27, 8
    s_cbranch_scc0 gemnet_accum_kernel_tailb_6
    s_setprio 2
    s_cmp_ge_u32 s27, 10
    s_cbranch_scc0 gemnet_accum_kernel_g2sb_3
    v_and_b32 v65, 0xffff8, v82
    buffer_load_dwordx2 v[66:67], v65, s[4:7], s23 offen
    v_and_b32 v65, 0xffff8, v83
    buffer_load_dwordx2 v[68:69], v65, s[4:7], s23 offen
    s_branch gemnet_accum_kernel_g2eb_3
gemnet_accum_kernel_g2sb_3:
    s_cmp_eq_u32 s27, 8
    s_cselect_b64 s[62:63], s[60:61], 1
    v_and_b32 v65, 0xffff8, v82
    s_cmp_gt_u32 s27, 8
    s_cselect_b64 exec, -1, s[62:63]
    buffer_load_dwordx2 v[66:67], v65, s[4:7], s23 offen
    s_mov_b64 exec, -1
    s_cmp_eq_u32 s27, 9
    s_cselect_b64 s[62:63], s[60:61], 1
    v_and_b32 v65, 0xffff8, v83
    s_cmp_gt_u32 s27, 9
    s_cselect_b64 exec, -1, s[62:63]
    buffer_load_dwordx2 v[68:69], v65, s[4:7], s23 offen
    s_mov_b64 exec, -1
gemnet_accum_kernel_g2eb_3:
    v_lshrrev_b32 v94, 16, v80
    v_lshrrev_b32 v110, 16, v81
    v_and_b32 v94, 0xfff0, v94
    v_and_b32 v110, 0xfff0, v110
    ds_read_b128 v[90:93], v94 offset:33760
    ds_read_b128 v[106:109], v110 offset:33760
    v_lshrrev_b32 v80, 1, v94
    v_lshrrev_b32 v81, 1, v110
    v_mul_f32 v94, s20, v58
    v_mul_f32 v110, s20, v59
    v_fract_f32 v94, v94
    v_fract_f32 v110, v110
    v_cos_f32 v94, v94
    v_cos_f32 v110, v110
    v_add_f32 v95, v94, v94
    v_add_f32 v111, v110, v110
    v_fma_f32 v95, v95, v94, -1.0
    v_fma_f32 v111, v111, v110, -1.0
    v_cvt_pk_bf16_f32 v95, v94, v95
    v_cvt_pk_bf16_f32 v111, v110, v111
    s_waitcnt vmcnt(2)
    v_mfma_f32_4x4x4_16b_bf16 v[96:99], v[122:123], v[70:71], 0
    v_mfma_f32_4x4x4_16b_bf16 v[112:115], v[122:123], v[72:73], 0
    s_waitcnt lgkmcnt(0)
    ds_read_b64 v[104:105], v80 offset:8752
    ds_read_b64 v[120:121], v81 offset:8752
    v_dot2_f32_bf16 v100, v90, v95, 0
    v_dot2_f32_bf16 v116, v106, v111, 0
    v_dot2_f32_bf16 v101, v91, v95, 0
    v_dot2_f32_bf16 v117, v107, v111, 0
    v_dot2_f32_bf16 v102, v92, v95, 0
    v_dot2_f32_bf16 v118, v108, v111, 0
    v_dot2_f32_bf16 v103, v93, v95, 0
    v_dot2_f32_bf16 v119, v109, v111, 0
    v_pk_mul_f32 v[96:97], v[96:97], v[100:101]
    v_pk_mul_f32 v[112:113], v[112:113], v[116:117]
    v_pk_mul_f32 v[98:99], v[98:99], v[102:103]
    v_pk_mul_f32 v[114:115], v[114:115], v[118:119]
    s_waitcnt lgkmcnt(0)
    s_nop 0
    v_mfma_f32_4x4x4_16b_bf16 v[100:103], v[124:125], v[104:105], v[96:99]
    v_mfma_f32_4x4x4_16b_bf16 v[116:119], v[124:125], v[120:121], v[112:115]
    s_nop 3
    v_cvt_pk_bf16_f32 v90, v100, v101
    v_cvt_pk_bf16_f32 v91, v102, v103
    ds_cmpst_rtn_b64 v[92:93], v80, v[104:105], v[90:91] offset:8752
    v_cvt_pk_bf16_f32 v106, v116, v117
    v_cvt_pk_bf16_f32 v107, v118, v119
    ds_cmpst_rtn_b64 v[108:109], v81, v[120:121], v[106:107] offset:8752
    s_waitcnt lgkmcnt(0)
    v_cmp_ne_u64 vcc, v[92:93], v[104:105]
    s_mov_b64 s[70:71], vcc
    v_cmp_ne_u64 vcc, v[108:109], v[120:121]
    s_mov_b64 s[90:91], vcc
    s_or_b64 s[62:63], s[70:71], vcc
    s_cbranch_scc0 gemnet_accum_kernel_pokb_3
    s_bcnt1_i32_b64 s65, s[70:71]
    s_bcnt1_i32_b64 s66, s[90:91]
    s_add_u32 s65, s65, s66
    s_cmp_le_u32 s65, 6
    s_cbranch_scc1 gemnet_accum_kernel_ppkb_3
gemnet_accum_kernel_prtb_3:
    v_mfma_f32_4x4x4_16b_bf16 v[100:103], v[124:125], v[92:93], v[96:99]
    v_mfma_f32_4x4x4_16b_bf16 v[116:119], v[124:125], v[108:109], v[112:115]
    s_mov_b64 exec, s[70:71]
    s_nop 2
    v_cvt_pk_bf16_f32 v90, v100, v101
    v_cvt_pk_bf16_f32 v91, v102, v103
    ds_cmpst_rtn_b64 v[104:105], v80, v[92:93], v[90:91] offset:8752
    s_mov_b64 exec, s[90:91]
    v_cvt_pk_bf16_f32 v106, v116, v117
    v_cvt_pk_bf16_f32 v107, v118, v119
    ds_cmpst_rtn_b64 v[120:121], v81, v[108:109], v[106:107] offset:8752
    s_waitcnt lgkmcnt(0)
    v_cmp_ne_u64 vcc, v[108:109], v[120:121]
    s_mov_b64 s[90:91], vcc
    s_mov_b64 exec, s[70:71]
    v_cmp_ne_u64 vcc, v[92:93], v[104:105]
    s_mov_b64 s[70:71], vcc
    s_or_b64 s[62:63], s[90:91], vcc
    s_cbranch_scc0 gemnet_accum_kernel_pfinb_3
gemnet_accum_kernel_ppkb_3:
    s_mov_b64 exec, s[70:71]
    s_cbranch_execz gemnet_accum_kernel_pkab_3
    v_cvt_pk_bf16_f32 v90, v96, v97
    v_cvt_pk_bf16_f32 v91, v98, v99
    ds_pk_add_bf16 v80, v90 offset:8752
    ds_pk_add_bf16 v80, v91 offset:8756
gemnet_accum_kernel_pkab_3:
    s_mov_b64 exec, s[90:91]
    s_cbranch_execz gemnet_accum_kernel_pfinb_3
    v_cvt_pk_bf16_f32 v106, v112, v113
    v_cvt_pk_bf16_f32 v107, v114, v115
    ds_pk_add_bf16 v81, v106 offset:8752
    ds_pk_add_bf16 v81, v107 offset:8756
gemnet_accum_kernel_pfinb_3:
    s_mov_b64 exec, -1
gemnet_accum_kernel_pokb_3:
    s_cmp_ge_u32 s68, 8
    s_cbranch_scc0 gemnet_accum_kernel_h2sbn_6
    v_lshrrev_b32 v126, 8, v26
    v_and_b32 v126, 4092, v126
    ds_add_rtn_u32 v80, v126, v3 offset:0
    v_lshrrev_b32 v126, 8, v28
    v_and_b32 v126, 4092, v126
    ds_add_rtn_u32 v81, v126, v3 offset:0
    s_branch gemnet_accum_kernel_h2ebn_6
gemnet_accum_kernel_h2sbn_6:
    s_cmp_gt_u32 s72, 6
    s_cbranch_scc0 gemnet_accum_kernel_hgbn_6
    s_cmp_eq_u32 s73, 6
    s_cselect_b64 exec, s[74:75], -1
    v_lshrrev_b32 v126, 8, v26
    v_and_b32 v126, 4092, v126
    ds_add_rtn_u32 v80, v126, v3 offset:0
    s_mov_b64 exec, -1
gemnet_accum_kernel_hgbn_6:
    s_cmp_gt_u32 s72, 7
    s_cbranch_scc0 gemnet_accum_kernel_hgbn_7
    s_cmp_eq_u32 s73, 7
    s_cselect_b64 exec, s[74:75], -1
    v_lshrrev_b32 v126, 8, v28
    v_and_b32 v126, 4092, v126
    ds_add_rtn_u32 v81, v126, v3 offset:0
    s_mov_b64 exec, -1
gemnet_accum_kernel_hgbn_7:
gemnet_accum_kernel_h2ebn_6:
    s_movk_i32 s25, 2304
    v_add3_u32 v57, v56, v2, s25
    v_and_b32 v56, -4, v57
    v_cmp_ne_u32 s[40:41], v56, v57
gemnet_accum_kernel_fbbn_6:
    v_readlane_b32 s62, v127, 7
    v_readlane_b32 s63, v0, 7
    s_nop 1
    v_mbcnt_lo_u32_b32 v126, s62, 0
    v_mbcnt_hi_u32_b32 v126, s63, v126
    v_add_lshl_u32 v126, v126, s24, 2
    s_bcnt1_i32_b64 s65, s[62:63]
    ds_bpermute_b32 v58, v126, v89
    s_add_u32 s24, s24, s65
gemnet_accum_kernel_fabn_7:
    s_cmp_ge_u32 s27, 10
    s_cbranch_scc0 gemnet_accum_kernel_tailb_8
    s_setprio 1
    s_cmp_ge_u32 s27, 12
    s_cbranch_scc0 gemnet_accum_kernel_g2sb_4
    v_and_b32 v65, 0xffff8, v84
    buffer_load_dwordx2 v[70:71], v65, s[4:7], s23 offen
    v_and_b32 v65, 0xffff8, v85
    buffer_load_dwordx2 v[72:73], v65, s[4:7], s23 offen
    s_branch gemnet_accum_kernel_g2eb_4
gemnet_accum_kernel_g2sb_4:
    s_cmp_eq_u32 s27, 10
    s_cselect_b64 s[62:63], s[60:61], 1
    v_and_b32 v65, 0xffff8, v84
    s_cmp_gt_u32 s27, 10
    s_cselect_b64 exec, -1, s[62:63]
    buffer_load_dwordx2 v[70:71], v65, s[4:7], s23 offen
    s_mov_b64 exec, -1
    s_cmp_eq_u32 s27, 11
    s_cselect_b64 s[62:63], s[60:61], 1
    v_and_b32 v65, 0xffff8, v85
    s_cmp_gt_u32 s27, 11
    s_cselect_b64 exec, -1, s[62:63]
    buffer_load_dwordx2 v[72:73], v65, s[4:7], s23 offen
    s_mov_b64 exec, -1
gemnet_accum_kernel_g2eb_4:
    v_lshrrev_b32 v94, 16, v82
    v_lshrrev_b32 v110, 16, v83
    v_and_b32 v94, 0xfff0, v94
    v_and_b32 v110, 0xfff0, v110
    ds_read_b128 v[90:93], v94 offset:33760
    ds_read_b128 v[106:109], v110 offset:33760
    v_lshrrev_b32 v82, 1, v94
    v_lshrrev_b32 v83, 1, v110
    v_mul_f32 v94, s20, v60
    v_mul_f32 v110, s20, v61
    v_fract_f32 v94, v94
    v_fract_f32 v110, v110
    v_cos_f32 v94, v94
    v_cos_f32 v110, v110
    v_add_f32 v95, v94, v94
    v_add_f32 v111, v110, v110
    v_fma_f32 v95, v95, v94, -1.0
    v_fma_f32 v111, v111, v110, -1.0
    v_cvt_pk_bf16_f32 v95, v94, v95
    v_cvt_pk_bf16_f32 v111, v110, v111
    s_waitcnt vmcnt(2)
    v_mfma_f32_4x4x4_16b_bf16 v[96:99], v[122:123], v[66:67], 0
    v_mfma_f32_4x4x4_16b_bf16 v[112:115], v[122:123], v[68:69], 0
    s_waitcnt lgkmcnt(0)
    ds_read_b64 v[104:105], v82 offset:8752
    ds_read_b64 v[120:121], v83 offset:8752
    v_dot2_f32_bf16 v100, v90, v95, 0
    v_dot2_f32_bf16 v116, v106, v111, 0
    v_dot2_f32_bf16 v101, v91, v95, 0
    v_dot2_f32_bf16 v117, v107, v111, 0
    v_dot2_f32_bf16 v102, v92, v95, 0
    v_dot2_f32_bf16 v118, v108, v111, 0
    v_dot2_f32_bf16 v103, v93, v95, 0
    v_dot2_f32_bf16 v119, v109, v111, 0
    v_pk_mul_f32 v[96:97], v[96:97], v[100:101]
    v_pk_mul_f32 v[112:113], v[112:113], v[116:117]
    v_pk_mul_f32 v[98:99], v[98:99], v[102:103]
    v_pk_mul_f32 v[114:115], v[114:115], v[118:119]
    s_waitcnt lgkmcnt(0)
    s_nop 0
    v_mfma_f32_4x4x4_16b_bf16 v[100:103], v[124:125], v[104:105], v[96:99]
    v_mfma_f32_4x4x4_16b_bf16 v[116:119], v[124:125], v[120:121], v[112:115]
    s_nop 3
    v_cvt_pk_bf16_f32 v90, v100, v101
    v_cvt_pk_bf16_f32 v91, v102, v103
    ds_cmpst_rtn_b64 v[92:93], v82, v[104:105], v[90:91] offset:8752
    v_cvt_pk_bf16_f32 v106, v116, v117
    v_cvt_pk_bf16_f32 v107, v118, v119
    ds_cmpst_rtn_b64 v[108:109], v83, v[120:121], v[106:107] offset:8752
    s_waitcnt lgkmcnt(0)
    v_cmp_ne_u64 vcc, v[92:93], v[104:105]
    s_mov_b64 s[70:71], vcc
    v_cmp_ne_u64 vcc, v[108:109], v[120:121]
    s_mov_b64 s[90:91], vcc
    s_or_b64 s[62:63], s[70:71], vcc
    s_cbranch_scc0 gemnet_accum_kernel_pokb_4
    s_bcnt1_i32_b64 s65, s[70:71]
    s_bcnt1_i32_b64 s66, s[90:91]
    s_add_u32 s65, s65, s66
    s_cmp_le_u32 s65, 6
    s_cbranch_scc1 gemnet_accum_kernel_ppkb_4
gemnet_accum_kernel_prtb_4:
    v_mfma_f32_4x4x4_16b_bf16 v[100:103], v[124:125], v[92:93], v[96:99]
    v_mfma_f32_4x4x4_16b_bf16 v[116:119], v[124:125], v[108:109], v[112:115]
    s_mov_b64 exec, s[70:71]
    s_nop 2
    v_cvt_pk_bf16_f32 v90, v100, v101
    v_cvt_pk_bf16_f32 v91, v102, v103
    ds_cmpst_rtn_b64 v[104:105], v82, v[92:93], v[90:91] offset:8752
    s_mov_b64 exec, s[90:91]
    v_cvt_pk_bf16_f32 v106, v116, v117
    v_cvt_pk_bf16_f32 v107, v118, v119
    ds_cmpst_rtn_b64 v[120:121], v83, v[108:109], v[106:107] offset:8752
    s_waitcnt lgkmcnt(0)
    v_cmp_ne_u64 vcc, v[108:109], v[120:121]
    s_mov_b64 s[90:91], vcc
    s_mov_b64 exec, s[70:71]
    v_cmp_ne_u64 vcc, v[92:93], v[104:105]
    s_mov_b64 s[70:71], vcc
    s_or_b64 s[62:63], s[90:91], vcc
    s_cbranch_scc0 gemnet_accum_kernel_pfinb_4
gemnet_accum_kernel_ppkb_4:
    s_mov_b64 exec, s[70:71]
    s_cbranch_execz gemnet_accum_kernel_pkab_4
    v_cvt_pk_bf16_f32 v90, v96, v97
    v_cvt_pk_bf16_f32 v91, v98, v99
    ds_pk_add_bf16 v82, v90 offset:8752
    ds_pk_add_bf16 v82, v91 offset:8756
gemnet_accum_kernel_pkab_4:
    s_mov_b64 exec, s[90:91]
    s_cbranch_execz gemnet_accum_kernel_pfinb_4
    v_cvt_pk_bf16_f32 v106, v112, v113
    v_cvt_pk_bf16_f32 v107, v114, v115
    ds_pk_add_bf16 v83, v106 offset:8752
    ds_pk_add_bf16 v83, v107 offset:8756
gemnet_accum_kernel_pfinb_4:
    s_mov_b64 exec, -1
gemnet_accum_kernel_pokb_4:
    s_cmp_ge_u32 s68, 10
    s_cbranch_scc0 gemnet_accum_kernel_h2sbn_8
    v_lshrrev_b32 v126, 8, v30
    v_and_b32 v126, 4092, v126
    ds_add_rtn_u32 v82, v126, v3 offset:0
    v_lshrrev_b32 v126, 8, v32
    v_and_b32 v126, 4092, v126
    ds_add_rtn_u32 v83, v126, v3 offset:0
    s_branch gemnet_accum_kernel_h2ebn_8
gemnet_accum_kernel_h2sbn_8:
    s_cmp_gt_u32 s72, 8
    s_cbranch_scc0 gemnet_accum_kernel_hgbn_8
    s_cmp_eq_u32 s73, 8
    s_cselect_b64 exec, s[74:75], -1
    v_lshrrev_b32 v126, 8, v30
    v_and_b32 v126, 4092, v126
    ds_add_rtn_u32 v82, v126, v3 offset:0
    s_mov_b64 exec, -1
gemnet_accum_kernel_hgbn_8:
    s_cmp_gt_u32 s72, 9
    s_cbranch_scc0 gemnet_accum_kernel_hgbn_9
    s_cmp_eq_u32 s73, 9
    s_cselect_b64 exec, s[74:75], -1
    v_lshrrev_b32 v126, 8, v32
    v_and_b32 v126, 4092, v126
    ds_add_rtn_u32 v83, v126, v3 offset:0
    s_mov_b64 exec, -1
gemnet_accum_kernel_hgbn_9:
gemnet_accum_kernel_h2ebn_8:
    s_movk_i32 s25, 2688
    v_add3_u32 v59, v58, v2, s25
    v_and_b32 v58, -4, v59
    v_cmp_ne_u32 s[42:43], v58, v59
gemnet_accum_kernel_fbbn_7:
    v_readlane_b32 s62, v127, 8
    v_readlane_b32 s63, v0, 8
    s_nop 1
    v_mbcnt_lo_u32_b32 v126, s62, 0
    v_mbcnt_hi_u32_b32 v126, s63, v126
    v_add_lshl_u32 v126, v126, s24, 2
    s_bcnt1_i32_b64 s65, s[62:63]
    ds_bpermute_b32 v60, v126, v89
    s_add_u32 s24, s24, s65
gemnet_accum_kernel_fabn_8:
    s_cmp_ge_u32 s27, 12
    s_cbranch_scc0 gemnet_accum_kernel_tailb_10
    s_setprio 0
    s_cmp_eq_u32 s27, 12
    s_cselect_b64 s[62:63], s[60:61], 1
    v_and_b32 v65, 0xffff8, v86
    s_cmp_gt_u32 s27, 12
    s_cselect_b64 exec, -1, s[62:63]
    buffer_load_dwordx2 v[66:67], v65, s[4:7], s23 offen
    s_mov_b64 exec, -1
    v_lshrrev_b32 v94, 16, v84
    v_lshrrev_b32 v110, 16, v85
    v_and_b32 v94, 0xfff0, v94
    v_and_b32 v110, 0xfff0, v110
    ds_read_b128 v[90:93], v94 offset:33760
    ds_read_b128 v[106:109], v110 offset:33760
    v_lshrrev_b32 v84, 1, v94
    v_lshrrev_b32 v85, 1, v110
    v_mul_f32 v94, s20, v62
    v_mul_f32 v110, s20, v63
    v_fract_f32 v94, v94
    v_fract_f32 v110, v110
    v_cos_f32 v94, v94
    v_cos_f32 v110, v110
    v_add_f32 v95, v94, v94
    v_add_f32 v111, v110, v110
    v_fma_f32 v95, v95, v94, -1.0
    v_fma_f32 v111, v111, v110, -1.0
    v_cvt_pk_bf16_f32 v95, v94, v95
    v_cvt_pk_bf16_f32 v111, v110, v111
    s_waitcnt vmcnt(1)
    v_mfma_f32_4x4x4_16b_bf16 v[96:99], v[122:123], v[70:71], 0
    v_mfma_f32_4x4x4_16b_bf16 v[112:115], v[122:123], v[72:73], 0
    s_waitcnt lgkmcnt(0)
    ds_read_b64 v[104:105], v84 offset:8752
    ds_read_b64 v[120:121], v85 offset:8752
    v_dot2_f32_bf16 v100, v90, v95, 0
    v_dot2_f32_bf16 v116, v106, v111, 0
    v_dot2_f32_bf16 v101, v91, v95, 0
    v_dot2_f32_bf16 v117, v107, v111, 0
    v_dot2_f32_bf16 v102, v92, v95, 0
    v_dot2_f32_bf16 v118, v108, v111, 0
    v_dot2_f32_bf16 v103, v93, v95, 0
    v_dot2_f32_bf16 v119, v109, v111, 0
    v_pk_mul_f32 v[96:97], v[96:97], v[100:101]
    v_pk_mul_f32 v[112:113], v[112:113], v[116:117]
    v_pk_mul_f32 v[98:99], v[98:99], v[102:103]
    v_pk_mul_f32 v[114:115], v[114:115], v[118:119]
    s_waitcnt lgkmcnt(0)
    s_nop 0
    v_mfma_f32_4x4x4_16b_bf16 v[100:103], v[124:125], v[104:105], v[96:99]
    v_mfma_f32_4x4x4_16b_bf16 v[116:119], v[124:125], v[120:121], v[112:115]
    s_nop 3
    v_cvt_pk_bf16_f32 v90, v100, v101
    v_cvt_pk_bf16_f32 v91, v102, v103
    ds_cmpst_rtn_b64 v[92:93], v84, v[104:105], v[90:91] offset:8752
    v_cvt_pk_bf16_f32 v106, v116, v117
    v_cvt_pk_bf16_f32 v107, v118, v119
    ds_cmpst_rtn_b64 v[108:109], v85, v[120:121], v[106:107] offset:8752
    s_waitcnt lgkmcnt(0)
    v_cmp_ne_u64 vcc, v[92:93], v[104:105]
    s_mov_b64 s[70:71], vcc
    v_cmp_ne_u64 vcc, v[108:109], v[120:121]
    s_mov_b64 s[90:91], vcc
    s_or_b64 s[62:63], s[70:71], vcc
    s_cbranch_scc0 gemnet_accum_kernel_pokb_5
    s_bcnt1_i32_b64 s65, s[70:71]
    s_bcnt1_i32_b64 s66, s[90:91]
    s_add_u32 s65, s65, s66
    s_cmp_le_u32 s65, 6
    s_cbranch_scc1 gemnet_accum_kernel_ppkb_5
gemnet_accum_kernel_prtb_5:
    v_mfma_f32_4x4x4_16b_bf16 v[100:103], v[124:125], v[92:93], v[96:99]
    v_mfma_f32_4x4x4_16b_bf16 v[116:119], v[124:125], v[108:109], v[112:115]
    s_mov_b64 exec, s[70:71]
    s_nop 2
    v_cvt_pk_bf16_f32 v90, v100, v101
    v_cvt_pk_bf16_f32 v91, v102, v103
    ds_cmpst_rtn_b64 v[104:105], v84, v[92:93], v[90:91] offset:8752
    s_mov_b64 exec, s[90:91]
    v_cvt_pk_bf16_f32 v106, v116, v117
    v_cvt_pk_bf16_f32 v107, v118, v119
    ds_cmpst_rtn_b64 v[120:121], v85, v[108:109], v[106:107] offset:8752
    s_waitcnt lgkmcnt(0)
    v_cmp_ne_u64 vcc, v[108:109], v[120:121]
    s_mov_b64 s[90:91], vcc
    s_mov_b64 exec, s[70:71]
    v_cmp_ne_u64 vcc, v[92:93], v[104:105]
    s_mov_b64 s[70:71], vcc
    s_or_b64 s[62:63], s[90:91], vcc
    s_cbranch_scc0 gemnet_accum_kernel_pfinb_5
gemnet_accum_kernel_ppkb_5:
    s_mov_b64 exec, s[70:71]
    s_cbranch_execz gemnet_accum_kernel_pkab_5
    v_cvt_pk_bf16_f32 v90, v96, v97
    v_cvt_pk_bf16_f32 v91, v98, v99
    ds_pk_add_bf16 v84, v90 offset:8752
    ds_pk_add_bf16 v84, v91 offset:8756
gemnet_accum_kernel_pkab_5:
    s_mov_b64 exec, s[90:91]
    s_cbranch_execz gemnet_accum_kernel_pfinb_5
    v_cvt_pk_bf16_f32 v106, v112, v113
    v_cvt_pk_bf16_f32 v107, v114, v115
    ds_pk_add_bf16 v85, v106 offset:8752
    ds_pk_add_bf16 v85, v107 offset:8756
gemnet_accum_kernel_pfinb_5:
    s_mov_b64 exec, -1
gemnet_accum_kernel_pokb_5:
    s_cmp_ge_u32 s68, 12
    s_cbranch_scc0 gemnet_accum_kernel_h2sbn_10
    v_lshrrev_b32 v126, 8, v34
    v_and_b32 v126, 4092, v126
    ds_add_rtn_u32 v84, v126, v3 offset:0
    v_lshrrev_b32 v126, 8, v36
    v_and_b32 v126, 4092, v126
    ds_add_rtn_u32 v85, v126, v3 offset:0
    s_branch gemnet_accum_kernel_h2ebn_10
gemnet_accum_kernel_h2sbn_10:
    s_cmp_gt_u32 s72, 10
    s_cbranch_scc0 gemnet_accum_kernel_hgbn_10
    s_cmp_eq_u32 s73, 10
    s_cselect_b64 exec, s[74:75], -1
    v_lshrrev_b32 v126, 8, v34
    v_and_b32 v126, 4092, v126
    ds_add_rtn_u32 v84, v126, v3 offset:0
    s_mov_b64 exec, -1
gemnet_accum_kernel_hgbn_10:
    s_cmp_gt_u32 s72, 11
    s_cbranch_scc0 gemnet_accum_kernel_hgbn_11
    s_cmp_eq_u32 s73, 11
    s_cselect_b64 exec, s[74:75], -1
    v_lshrrev_b32 v126, 8, v36
    v_and_b32 v126, 4092, v126
    ds_add_rtn_u32 v85, v126, v3 offset:0
    s_mov_b64 exec, -1
gemnet_accum_kernel_hgbn_11:
gemnet_accum_kernel_h2ebn_10:
    s_movk_i32 s25, 3072
    v_add3_u32 v61, v60, v2, s25
    v_and_b32 v60, -4, v61
    v_cmp_ne_u32 s[44:45], v60, v61
gemnet_accum_kernel_fbbn_8:
    v_readlane_b32 s62, v127, 9
    v_readlane_b32 s63, v0, 9
    s_nop 1
    v_mbcnt_lo_u32_b32 v126, s62, 0
    v_mbcnt_hi_u32_b32 v126, s63, v126
    v_add_lshl_u32 v126, v126, s24, 2
    s_bcnt1_i32_b64 s65, s[62:63]
    ds_bpermute_b32 v62, v126, v89
    s_add_u32 s24, s24, s65
gemnet_accum_kernel_fabn_9:
    s_cmp_gt_u32 s80, 12
    s_cbranch_scc0 gemnet_accum_kernel_nolastb
    s_cmp_gt_u32 s27, 12
    s_cselect_b64 exec, -1, s[58:59]
    v_lshrrev_b32 v94, 16, v86
    v_and_b32 v94, 0xfff0, v94
    ds_read_b128 v[90:93], v94 offset:33760
    v_lshrrev_b32 v86, 1, v94
    v_mul_f32 v94, s20, v64
    v_fract_f32 v94, v94
    v_cos_f32 v94, v94
    s_nop 0
    v_add_f32 v95, v94, v94
    v_fma_f32 v95, v95, v94, -1.0
    v_cvt_pk_bf16_f32 v95, v94, v95
    s_waitcnt vmcnt(0)
    v_mfma_f32_4x4x4_16b_bf16 v[96:99], v[122:123], v[66:67], 0
    s_waitcnt lgkmcnt(0)
    v_dot2_f32_bf16 v100, v90, v95, 0
    v_dot2_f32_bf16 v101, v91, v95, 0
    v_dot2_f32_bf16 v102, v92, v95, 0
    v_dot2_f32_bf16 v103, v93, v95, 0
    s_nop 2
    v_pk_mul_f32 v[96:97], v[96:97], v[100:101]
    v_pk_mul_f32 v[98:99], v[98:99], v[102:103]
    ds_read_b64 v[104:105], v86 offset:8752
    s_waitcnt lgkmcnt(0)
    s_nop 1
    v_mfma_f32_4x4x4_16b_bf16 v[100:103], v[124:125], v[104:105], v[96:99]
    s_nop 4
    v_cvt_pk_bf16_f32 v90, v100, v101
    v_cvt_pk_bf16_f32 v91, v102, v103
    ds_cmpst_rtn_b64 v[92:93], v86, v[104:105], v[90:91] offset:8752
    s_waitcnt lgkmcnt(0)
    v_cmp_ne_u64 vcc, v[92:93], v[104:105]
    v_mov_b32 v104, v92
    v_mov_b32 v105, v93
    s_and_b64 exec, exec, vcc
    s_cbranch_execz gemnet_accum_kernel_sgeb_last
    s_nop 1
    v_mfma_f32_4x4x4_16b_bf16 v[100:103], v[124:125], v[104:105], v[96:99]
    s_nop 4
    v_cvt_pk_bf16_f32 v90, v100, v101
    v_cvt_pk_bf16_f32 v91, v102, v103
    ds_cmpst_rtn_b64 v[92:93], v86, v[104:105], v[90:91] offset:8752
    s_waitcnt lgkmcnt(0)
    v_cmp_ne_u64 vcc, v[92:93], v[104:105]
    v_mov_b32 v104, v92
    v_mov_b32 v105, v93
    s_and_b64 exec, exec, vcc
    s_cbranch_execz gemnet_accum_kernel_sgeb_last
    v_cvt_pk_bf16_f32 v90, v96, v97
    v_cvt_pk_bf16_f32 v91, v98, v99
    ds_pk_add_bf16 v86, v90 offset:8752
    ds_pk_add_bf16 v86, v91 offset:8756
gemnet_accum_kernel_sgeb_last:
gemnet_accum_kernel_nolastb:
    s_mov_b64 exec, -1
    s_cmp_gt_u32 s72, 12
    s_cbranch_scc0 gemnet_accum_kernel_hgbn_12
    s_cmp_eq_u32 s73, 12
    s_cselect_b64 exec, s[74:75], -1
    v_lshrrev_b32 v126, 8, v38
    v_and_b32 v126, 4092, v126
    ds_add_rtn_u32 v86, v126, v3 offset:0
    s_mov_b64 exec, -1
gemnet_accum_kernel_hgbn_12:
    s_branch gemnet_accum_kernel_pdb
gemnet_accum_kernel_tailb_0:
    s_mov_b64 exec, -1
    s_waitcnt vmcnt(0)
    s_cmp_gt_u32 s80, 0
    s_cbranch_scc0 gemnet_accum_kernel_tskipb_0
    s_cmp_gt_u32 s27, 0
    s_cselect_b64 exec, -1, s[58:59]
    v_and_b32 v65, 0xffff8, v74
    buffer_load_dwordx2 v[66:67], v65, s[4:7], s23 offen
    v_lshrrev_b32 v94, 16, v74
    v_and_b32 v94, 0xfff0, v94
    ds_read_b128 v[90:93], v94 offset:33760
    v_lshrrev_b32 v74, 1, v94
    v_mul_f32 v94, s20, v52
    v_fract_f32 v94, v94
    v_cos_f32 v94, v94
    s_nop 0
    v_add_f32 v95, v94, v94
    v_fma_f32 v95, v95, v94, -1.0
    v_cvt_pk_bf16_f32 v95, v94, v95
    s_waitcnt vmcnt(0)
    v_mfma_f32_4x4x4_16b_bf16 v[96:99], v[122:123], v[66:67], 0
    s_waitcnt lgkmcnt(0)
    v_dot2_f32_bf16 v100, v90, v95, 0
    v_dot2_f32_bf16 v101, v91, v95, 0
    v_dot2_f32_bf16 v102, v92, v95, 0
    v_dot2_f32_bf16 v103, v93, v95, 0
    s_nop 2
    v_pk_mul_f32 v[96:97], v[96:97], v[100:101]
    v_pk_mul_f32 v[98:99], v[98:99], v[102:103]
    ds_read_b64 v[104:105], v74 offset:8752
    s_waitcnt lgkmcnt(0)
gemnet_accum_kernel_sgb_t0:
    s_nop 1
    v_mfma_f32_4x4x4_16b_bf16 v[100:103], v[124:125], v[104:105], v[96:99]
    s_nop 4
    v_cvt_pk_bf16_f32 v90, v100, v101
    v_cvt_pk_bf16_f32 v91, v102, v103
    ds_cmpst_rtn_b64 v[92:93], v74, v[104:105], v[90:91] offset:8752
    s_waitcnt lgkmcnt(0)
    v_cmp_ne_u64 vcc, v[92:93], v[104:105]
    v_mov_b32 v104, v92
    v_mov_b32 v105, v93
    s_and_b64 exec, exec, vcc
    s_cbranch_execnz gemnet_accum_kernel_sgb_t0
gemnet_accum_kernel_tskipb_0:
    s_mov_b64 exec, -1
    s_mov_b64 exec, -1
    s_waitcnt vmcnt(0)
    s_cmp_gt_u32 s80, 1
    s_cbranch_scc0 gemnet_accum_kernel_tskipb_1
    s_cmp_gt_u32 s27, 1
    s_cselect_b64 exec, -1, s[58:59]
    v_and_b32 v65, 0xffff8, v75
    buffer_load_dwordx2 v[68:69], v65, s[4:7], s23 offen
    v_lshrrev_b32 v94, 16, v75
    v_and_b32 v94, 0xfff0, v94
    ds_read_b128 v[90:93], v94 offset:33760
    v_lshrrev_b32 v75, 1, v94
    v_mul_f32 v94, s20, v53
    v_fract_f32 v94, v94
    v_cos_f32 v94, v94
    s_nop 0
    v_add_f32 v95, v94, v94
    v_fma_f32 v95, v95, v94, -1.0
    v_cvt_pk_bf16_f32 v95, v94, v95
    s_waitcnt vmcnt(0)
    v_mfma_f32_4x4x4_16b_bf16 v[96:99], v[122:123], v[68:69], 0
    s_waitcnt lgkmcnt(0)
    v_dot2_f32_bf16 v100, v90, v95, 0
    v_dot2_f32_bf16 v101, v91, v95, 0
    v_dot2_f32_bf16 v102, v92, v95, 0
    v_dot2_f32_bf16 v103, v93, v95, 0
    s_nop 2
    v_pk_mul_f32 v[96:97], v[96:97], v[100:101]
    v_pk_mul_f32 v[98:99], v[98:99], v[102:103]
    ds_read_b64 v[104:105], v75 offset:8752
    s_waitcnt lgkmcnt(0)
gemnet_accum_kernel_sgb_t1:
    s_nop 1
    v_mfma_f32_4x4x4_16b_bf16 v[100:103], v[124:125], v[104:105], v[96:99]
    s_nop 4
    v_cvt_pk_bf16_f32 v90, v100, v101
    v_cvt_pk_bf16_f32 v91, v102, v103
    ds_cmpst_rtn_b64 v[92:93], v75, v[104:105], v[90:91] offset:8752
    s_waitcnt lgkmcnt(0)
    v_cmp_ne_u64 vcc, v[92:93], v[104:105]
    v_mov_b32 v104, v92
    v_mov_b32 v105, v93
    s_and_b64 exec, exec, vcc
    s_cbranch_execnz gemnet_accum_kernel_sgb_t1
gemnet_accum_kernel_tskipb_1:
    s_mov_b64 exec, -1
    s_waitcnt lgkmcnt(0)
    v_lshrrev_b32 v126, 16, v14
    v_cndmask_b32 v14, v14, v15, s[28:29]
    v_cndmask_b32 v15, v15, v126, s[28:29]
    v_lshrrev_b32 v126, 16, v16
    v_cndmask_b32 v16, v16, v17, s[30:31]
    v_cndmask_b32 v17, v17, v126, s[30:31]
    v_lshrrev_b32 v126, 16, v18
    v_cndmask_b32 v18, v18, v19, s[32:33]
    v_cndmask_b32 v19, v19, v126, s[32:33]
    v_lshrrev_b32 v126, 16, v20
    v_cndmask_b32 v20, v20, v21, s[34:35]
    v_cndmask_b32 v21, v21, v126, s[34:35]
    v_lshrrev_b32 v126, 16, v22
    v_cndmask_b32 v22, v22, v23, s[36:37]
    v_cndmask_b32 v23, v23, v126, s[36:37]
    v_lshrrev_b32 v126, 16, v24
    v_cndmask_b32 v24, v24, v25, s[38:39]
    v_cndmask_b32 v25, v25, v126, s[38:39]
    v_lshrrev_b32 v126, 16, v26
    v_cndmask_b32 v26, v26, v27, s[40:41]
    v_cndmask_b32 v27, v27, v126, s[40:41]
    v_lshrrev_b32 v126, 16, v28
    v_cndmask_b32 v28, v28, v29, s[42:43]
    v_cndmask_b32 v29, v29, v126, s[42:43]
    v_lshrrev_b32 v126, 16, v30
    v_cndmask_b32 v30, v30, v31, s[44:45]
    v_cndmask_b32 v31, v31, v126, s[44:45]
    v_lshrrev_b32 v126, 16, v32
    v_cndmask_b32 v32, v32, v33, s[46:47]
    v_cndmask_b32 v33, v33, v126, s[46:47]
    v_lshrrev_b32 v126, 16, v34
    v_cndmask_b32 v34, v34, v35, s[48:49]
    v_cndmask_b32 v35, v35, v126, s[48:49]
    v_lshrrev_b32 v126, 16, v36
    v_cndmask_b32 v36, v36, v37, s[50:51]
    v_cndmask_b32 v37, v37, v126, s[50:51]
    v_lshrrev_b32 v126, 16, v38
    v_cndmask_b32 v38, v38, v39, s[52:53]
    v_cndmask_b32 v39, v39, v126, s[52:53]
    s_cmp_gt_u32 s72, 13
    s_cbranch_scc0 gemnet_accum_kernel_decbt
    v_lshrrev_b32 v126, 16, v40
    v_cndmask_b32 v40, v40, v41, s[54:55]
    v_cndmask_b32 v41, v41, v126, s[54:55]
    s_cmp_gt_u32 s72, 14
    s_cbranch_scc0 gemnet_accum_kernel_decbt
    v_lshrrev_b32 v126, 16, v42
    v_cndmask_b32 v42, v42, v43, s[56:57]
    v_cndmask_b32 v43, v43, v126, s[56:57]
gemnet_accum_kernel_decbt:
    s_cmp_ge_u32 s68, 2
    s_cbranch_scc0 gemnet_accum_kernel_h2sbt_0
    v_lshrrev_b32 v126, 8, v14
    v_and_b32 v126, 4092, v126
    ds_add_rtn_u32 v74, v126, v3 offset:0
    v_lshrrev_b32 v126, 8, v16
    v_and_b32 v126, 4092, v126
    ds_add_rtn_u32 v75, v126, v3 offset:0
    s_branch gemnet_accum_kernel_h2ebt_0
gemnet_accum_kernel_h2sbt_0:
    s_cmp_gt_u32 s72, 0
    s_cbranch_scc0 gemnet_accum_kernel_hgbt_0
    s_cmp_eq_u32 s73, 0
    s_cselect_b64 exec, s[74:75], -1
    v_lshrrev_b32 v126, 8, v14
    v_and_b32 v126, 4092, v126
    ds_add_rtn_u32 v74, v126, v3 offset:0
    s_mov_b64 exec, -1
gemnet_accum_kernel_hgbt_0:
    s_cmp_gt_u32 s72, 1
    s_cbranch_scc0 gemnet_accum_kernel_hgbt_1
    s_cmp_eq_u32 s73, 1
    s_cselect_b64 exec, s[74:75], -1
    v_lshrrev_b32 v126, 8, v16
    v_and_b32 v126, 4092, v126
    ds_add_rtn_u32 v75, v126, v3 offset:0
    s_mov_b64 exec, -1
gemnet_accum_kernel_hgbt_1:
gemnet_accum_kernel_h2ebt_0:
    v_readlane_b32 s62, v127, 0
    v_readlane_b32 s63, v0, 0
    s_nop 1
    v_mbcnt_lo_u32_b32 v126, s62, 0
    v_mbcnt_hi_u32_b32 v126, s63, v126
    v_add_lshl_u32 v126, v126, s24, 2
    s_bcnt1_i32_b64 s65, s[62:63]
    ds_bpermute_b32 v44, v126, v89
    s_add_u32 s24, s24, s65
gemnet_accum_kernel_fabt_0:
    v_readlane_b32 s62, v127, 1
    v_readlane_b32 s63, v0, 1
    s_nop 1
    v_mbcnt_lo_u32_b32 v126, s62, 0
    v_mbcnt_hi_u32_b32 v126, s63, v126
    v_add_lshl_u32 v126, v126, s24, 2
    s_bcnt1_i32_b64 s65, s[62:63]
    ds_bpermute_b32 v46, v126, v89
    s_add_u32 s24, s24, s65
gemnet_accum_kernel_fabt_1:
    v_readlane_b32 s62, v127, 2
    v_readlane_b32 s63, v0, 2
    s_nop 1
    v_mbcnt_lo_u32_b32 v126, s62, 0
    v_mbcnt_hi_u32_b32 v126, s63, v126
    v_add_lshl_u32 v126, v126, s24, 2
    s_bcnt1_i32_b64 s65, s[62:63]
    ds_bpermute_b32 v48, v126, v89
    s_add_u32 s24, s24, s65
gemnet_accum_kernel_fabt_2:
    v_readlane_b32 s62, v127, 3
    v_readlane_b32 s63, v0, 3
    s_nop 1
    v_mbcnt_lo_u32_b32 v126, s62, 0
    v_mbcnt_hi_u32_b32 v126, s63, v126
    v_add_lshl_u32 v126, v126, s24, 2
    s_bcnt1_i32_b64 s65, s[62:63]
    ds_bpermute_b32 v50, v126, v89
    s_add_u32 s24, s24, s65
gemnet_accum_kernel_fabt_3:
    v_readlane_b32 s62, v127, 4
    v_readlane_b32 s63, v0, 4
    s_nop 1
    v_mbcnt_lo_u32_b32 v126, s62, 0
    v_mbcnt_hi_u32_b32 v126, s63, v126
    v_add_lshl_u32 v126, v126, s24, 2
    s_bcnt1_i32_b64 s65, s[62:63]
    ds_bpermute_b32 v52, v126, v89
    s_add_u32 s24, s24, s65
gemnet_accum_kernel_fabt_4:
gemnet_accum_kernel_tailb_2:
    s_mov_b64 exec, -1
    s_waitcnt vmcnt(0)
    s_cmp_gt_u32 s80, 2
    s_cbranch_scc0 gemnet_accum_kernel_tskipb_2
    s_cmp_gt_u32 s27, 2
    s_cselect_b64 exec, -1, s[58:59]
    v_and_b32 v65, 0xffff8, v76
    buffer_load_dwordx2 v[70:71], v65, s[4:7], s23 offen
    v_lshrrev_b32 v94, 16, v76
    v_and_b32 v94, 0xfff0, v94
    ds_read_b128 v[90:93], v94 offset:33760
    v_lshrrev_b32 v76, 1, v94
    v_mul_f32 v94, s20, v54
    v_fract_f32 v94, v94
    v_cos_f32 v94, v94
    s_nop 0
    v_add_f32 v95, v94, v94
    v_fma_f32 v95, v95, v94, -1.0
    v_cvt_pk_bf16_f32 v95, v94, v95
    s_waitcnt vmcnt(0)
    v_mfma_f32_4x4x4_16b_bf16 v[96:99], v[122:123], v[70:71], 0
    s_waitcnt lgkmcnt(0)
    v_dot2_f32_bf16 v100, v90, v95, 0
    v_dot2_f32_bf16 v101, v91, v95, 0
    v_dot2_f32_bf16 v102, v92, v95, 0
    v_dot2_f32_bf16 v103, v93, v95, 0
    s_nop 2
    v_pk_mul_f32 v[96:97], v[96:97], v[100:101]
    v_pk_mul_f32 v[98:99], v[98:99], v[102:103]
    ds_read_b64 v[104:105], v76 offset:8752
    s_waitcnt lgkmcnt(0)
gemnet_accum_kernel_sgb_t2:
    s_nop 1
    v_mfma_f32_4x4x4_16b_bf16 v[100:103], v[124:125], v[104:105], v[96:99]
    s_nop 4
    v_cvt_pk_bf16_f32 v90, v100, v101
    v_cvt_pk_bf16_f32 v91, v102, v103
    ds_cmpst_rtn_b64 v[92:93], v76, v[104:105], v[90:91] offset:8752
    s_waitcnt lgkmcnt(0)
    v_cmp_ne_u64 vcc, v[92:93], v[104:105]
    v_mov_b32 v104, v92
    v_mov_b32 v105, v93
    s_and_b64 exec, exec, vcc
    s_cbranch_execnz gemnet_accum_kernel_sgb_t2
gemnet_accum_kernel_tskipb_2:
    s_mov_b64 exec, -1
    s_mov_b64 exec, -1
    s_waitcnt vmcnt(0)
    s_cmp_gt_u32 s80, 3
    s_cbranch_scc0 gemnet_accum_kernel_tskipb_3
    s_cmp_gt_u32 s27, 3
    s_cselect_b64 exec, -1, s[58:59]
    v_and_b32 v65, 0xffff8, v77
    buffer_load_dwordx2 v[72:73], v65, s[4:7], s23 offen
    v_lshrrev_b32 v94, 16, v77
    v_and_b32 v94, 0xfff0, v94
    ds_read_b128 v[90:93], v94 offset:33760
    v_lshrrev_b32 v77, 1, v94
    v_mul_f32 v94, s20, v55
    v_fract_f32 v94, v94
    v_cos_f32 v94, v94
    s_nop 0
    v_add_f32 v95, v94, v94
    v_fma_f32 v95, v95, v94, -1.0
    v_cvt_pk_bf16_f32 v95, v94, v95
    s_waitcnt vmcnt(0)
    v_mfma_f32_4x4x4_16b_bf16 v[96:99], v[122:123], v[72:73], 0
    s_waitcnt lgkmcnt(0)
    v_dot2_f32_bf16 v100, v90, v95, 0
    v_dot2_f32_bf16 v101, v91, v95, 0
    v_dot2_f32_bf16 v102, v92, v95, 0
    v_dot2_f32_bf16 v103, v93, v95, 0
    s_nop 2
    v_pk_mul_f32 v[96:97], v[96:97], v[100:101]
    v_pk_mul_f32 v[98:99], v[98:99], v[102:103]
    ds_read_b64 v[104:105], v77 offset:8752
    s_waitcnt lgkmcnt(0)
gemnet_accum_kernel_sgb_t3:
    s_nop 1
    v_mfma_f32_4x4x4_16b_bf16 v[100:103], v[124:125], v[104:105], v[96:99]
    s_nop 4
    v_cvt_pk_bf16_f32 v90, v100, v101
    v_cvt_pk_bf16_f32 v91, v102, v103
    ds_cmpst_rtn_b64 v[92:93], v77, v[104:105], v[90:91] offset:8752
    s_waitcnt lgkmcnt(0)
    v_cmp_ne_u64 vcc, v[92:93], v[104:105]
    v_mov_b32 v104, v92
    v_mov_b32 v105, v93
    s_and_b64 exec, exec, vcc
    s_cbranch_execnz gemnet_accum_kernel_sgb_t3
gemnet_accum_kernel_tskipb_3:
    s_mov_b64 exec, -1
    s_waitcnt lgkmcnt(0)
    s_cmp_ge_u32 s68, 4
    s_cbranch_scc0 gemnet_accum_kernel_h2sbt_2
    v_lshrrev_b32 v126, 8, v18
    v_and_b32 v126, 4092, v126
    ds_add_rtn_u32 v76, v126, v3 offset:0
    v_lshrrev_b32 v126, 8, v20
    v_and_b32 v126, 4092, v126
    ds_add_rtn_u32 v77, v126, v3 offset:0
    s_branch gemnet_accum_kernel_h2ebt_2
gemnet_accum_kernel_h2sbt_2:
    s_cmp_gt_u32 s72, 2
    s_cbranch_scc0 gemnet_accum_kernel_hgbt_2
    s_cmp_eq_u32 s73, 2
    s_cselect_b64 exec, s[74:75], -1
    v_lshrrev_b32 v126, 8, v18
    v_and_b32 v126, 4092, v126
    ds_add_rtn_u32 v76, v126, v3 offset:0
    s_mov_b64 exec, -1
gemnet_accum_kernel_hgbt_2:
    s_cmp_gt_u32 s72, 3
    s_cbranch_scc0 gemnet_accum_kernel_hgbt_3
    s_cmp_eq_u32 s73, 3
    s_cselect_b64 exec, s[74:75], -1
    v_lshrrev_b32 v126, 8, v20
    v_and_b32 v126, 4092, v126
    ds_add_rtn_u32 v77, v126, v3 offset:0
    s_mov_b64 exec, -1
gemnet_accum_kernel_hgbt_3:
gemnet_accum_kernel_h2ebt_2:
    s_movk_i32 s25, 0
    v_add3_u32 v45, v44, v2, s25
    v_and_b32 v44, -4, v45
    v_cmp_ne_u32 s[28:29], v44, v45
gemnet_accum_kernel_fbbt_0:
    s_movk_i32 s25, 384
    v_add3_u32 v47, v46, v2, s25
    v_and_b32 v46, -4, v47
    v_cmp_ne_u32 s[30:31], v46, v47
gemnet_accum_kernel_fbbt_1:
    s_movk_i32 s25, 768
    v_add3_u32 v49, v48, v2, s25
    v_and_b32 v48, -4, v49
    v_cmp_ne_u32 s[32:33], v48, v49
gemnet_accum_kernel_fbbt_2:
    s_movk_i32 s25, 1152
    v_add3_u32 v51, v50, v2, s25
    v_and_b32 v50, -4, v51
    v_cmp_ne_u32 s[34:35], v50, v51
gemnet_accum_kernel_fbbt_3:
    s_movk_i32 s25, 1536
    v_add3_u32 v53, v52, v2, s25
    v_and_b32 v52, -4, v53
    v_cmp_ne_u32 s[36:37], v52, v53
gemnet_accum_kernel_fbbt_4:
    v_readlane_b32 s62, v127, 5
    v_readlane_b32 s63, v0, 5
    s_nop 1
    v_mbcnt_lo_u32_b32 v126, s62, 0
    v_mbcnt_hi_u32_b32 v126, s63, v126
    v_add_lshl_u32 v126, v126, s24, 2
    s_bcnt1_i32_b64 s65, s[62:63]
    ds_bpermute_b32 v54, v126, v89
    s_add_u32 s24, s24, s65
gemnet_accum_kernel_fabt_5:
gemnet_accum_kernel_tailb_4:
    s_mov_b64 exec, -1
    s_waitcnt vmcnt(0)
    s_cmp_gt_u32 s80, 4
    s_cbranch_scc0 gemnet_accum_kernel_tskipb_4
    s_cmp_gt_u32 s27, 4
    s_cselect_b64 exec, -1, s[58:59]
    v_and_b32 v65, 0xffff8, v78
    buffer_load_dwordx2 v[66:67], v65, s[4:7], s23 offen
    v_lshrrev_b32 v94, 16, v78
    v_and_b32 v94, 0xfff0, v94
    ds_read_b128 v[90:93], v94 offset:33760
    v_lshrrev_b32 v78, 1, v94
    v_mul_f32 v94, s20, v56
    v_fract_f32 v94, v94
    v_cos_f32 v94, v94
    s_nop 0
    v_add_f32 v95, v94, v94
    v_fma_f32 v95, v95, v94, -1.0
    v_cvt_pk_bf16_f32 v95, v94, v95
    s_waitcnt vmcnt(0)
    v_mfma_f32_4x4x4_16b_bf16 v[96:99], v[122:123], v[66:67], 0
    s_waitcnt lgkmcnt(0)
    v_dot2_f32_bf16 v100, v90, v95, 0
    v_dot2_f32_bf16 v101, v91, v95, 0
    v_dot2_f32_bf16 v102, v92, v95, 0
    v_dot2_f32_bf16 v103, v93, v95, 0
    s_nop 2
    v_pk_mul_f32 v[96:97], v[96:97], v[100:101]
    v_pk_mul_f32 v[98:99], v[98:99], v[102:103]
    ds_read_b64 v[104:105], v78 offset:8752
    s_waitcnt lgkmcnt(0)
gemnet_accum_kernel_sgb_t4:
    s_nop 1
    v_mfma_f32_4x4x4_16b_bf16 v[100:103], v[124:125], v[104:105], v[96:99]
    s_nop 4
    v_cvt_pk_bf16_f32 v90, v100, v101
    v_cvt_pk_bf16_f32 v91, v102, v103
    ds_cmpst_rtn_b64 v[92:93], v78, v[104:105], v[90:91] offset:8752
    s_waitcnt lgkmcnt(0)
    v_cmp_ne_u64 vcc, v[92:93], v[104:105]
    v_mov_b32 v104, v92
    v_mov_b32 v105, v93
    s_and_b64 exec, exec, vcc
    s_cbranch_execnz gemnet_accum_kernel_sgb_t4
gemnet_accum_kernel_tskipb_4:
    s_mov_b64 exec, -1
    s_mov_b64 exec, -1
    s_waitcnt vmcnt(0)
    s_cmp_gt_u32 s80, 5
    s_cbranch_scc0 gemnet_accum_kernel_tskipb_5
    s_cmp_gt_u32 s27, 5
    s_cselect_b64 exec, -1, s[58:59]
    v_and_b32 v65, 0xffff8, v79
    buffer_load_dwordx2 v[68:69], v65, s[4:7], s23 offen
    v_lshrrev_b32 v94, 16, v79
    v_and_b32 v94, 0xfff0, v94
    ds_read_b128 v[90:93], v94 offset:33760
    v_lshrrev_b32 v79, 1, v94
    v_mul_f32 v94, s20, v57
    v_fract_f32 v94, v94
    v_cos_f32 v94, v94
    s_nop 0
    v_add_f32 v95, v94, v94
    v_fma_f32 v95, v95, v94, -1.0
    v_cvt_pk_bf16_f32 v95, v94, v95
    s_waitcnt vmcnt(0)
    v_mfma_f32_4x4x4_16b_bf16 v[96:99], v[122:123], v[68:69], 0
    s_waitcnt lgkmcnt(0)
    v_dot2_f32_bf16 v100, v90, v95, 0
    v_dot2_f32_bf16 v101, v91, v95, 0
    v_dot2_f32_bf16 v102, v92, v95, 0
    v_dot2_f32_bf16 v103, v93, v95, 0
    s_nop 2
    v_pk_mul_f32 v[96:97], v[96:97], v[100:101]
    v_pk_mul_f32 v[98:99], v[98:99], v[102:103]
    ds_read_b64 v[104:105], v79 offset:8752
    s_waitcnt lgkmcnt(0)
gemnet_accum_kernel_sgb_t5:
    s_nop 1
    v_mfma_f32_4x4x4_16b_bf16 v[100:103], v[124:125], v[104:105], v[96:99]
    s_nop 4
    v_cvt_pk_bf16_f32 v90, v100, v101
    v_cvt_pk_bf16_f32 v91, v102, v103
    ds_cmpst_rtn_b64 v[92:93], v79, v[104:105], v[90:91] offset:8752
    s_waitcnt lgkmcnt(0)
    v_cmp_ne_u64 vcc, v[92:93], v[104:105]
    v_mov_b32 v104, v92
    v_mov_b32 v105, v93
    s_and_b64 exec, exec, vcc
    s_cbranch_execnz gemnet_accum_kernel_sgb_t5
gemnet_accum_kernel_tskipb_5:
    s_mov_b64 exec, -1
    s_waitcnt lgkmcnt(0)
    s_cmp_ge_u32 s68, 6
    s_cbranch_scc0 gemnet_accum_kernel_h2sbt_4
    v_lshrrev_b32 v126, 8, v22
    v_and_b32 v126, 4092, v126
    ds_add_rtn_u32 v78, v126, v3 offset:0
    v_lshrrev_b32 v126, 8, v24
    v_and_b32 v126, 4092, v126
    ds_add_rtn_u32 v79, v126, v3 offset:0
    s_branch gemnet_accum_kernel_h2ebt_4
gemnet_accum_kernel_h2sbt_4:
    s_cmp_gt_u32 s72, 4
    s_cbranch_scc0 gemnet_accum_kernel_hgbt_4
    s_cmp_eq_u32 s73, 4
    s_cselect_b64 exec, s[74:75], -1
    v_lshrrev_b32 v126, 8, v22
    v_and_b32 v126, 4092, v126
    ds_add_rtn_u32 v78, v126, v3 offset:0
    s_mov_b64 exec, -1
gemnet_accum_kernel_hgbt_4:
    s_cmp_gt_u32 s72, 5
    s_cbranch_scc0 gemnet_accum_kernel_hgbt_5
    s_cmp_eq_u32 s73, 5
    s_cselect_b64 exec, s[74:75], -1
    v_lshrrev_b32 v126, 8, v24
    v_and_b32 v126, 4092, v126
    ds_add_rtn_u32 v79, v126, v3 offset:0
    s_mov_b64 exec, -1
gemnet_accum_kernel_hgbt_5:
gemnet_accum_kernel_h2ebt_4:
    s_movk_i32 s25, 1920
    v_add3_u32 v55, v54, v2, s25
    v_and_b32 v54, -4, v55
    v_cmp_ne_u32 s[38:39], v54, v55
gemnet_accum_kernel_fbbt_5:
    v_readlane_b32 s62, v127, 6
    v_readlane_b32 s63, v0, 6
    s_nop 1
    v_mbcnt_lo_u32_b32 v126, s62, 0
    v_mbcnt_hi_u32_b32 v126, s63, v126
    v_add_lshl_u32 v126, v126, s24, 2
    s_bcnt1_i32_b64 s65, s[62:63]
    ds_bpermute_b32 v56, v126, v89
    s_add_u32 s24, s24, s65
gemnet_accum_kernel_fabt_6:
gemnet_accum_kernel_tailb_6:
    s_mov_b64 exec, -1
    s_waitcnt vmcnt(0)
    s_cmp_gt_u32 s80, 6
    s_cbranch_scc0 gemnet_accum_kernel_tskipb_6
    s_cmp_gt_u32 s27, 6
    s_cselect_b64 exec, -1, s[58:59]
    v_and_b32 v65, 0xffff8, v80
    buffer_load_dwordx2 v[70:71], v65, s[4:7], s23 offen
    v_lshrrev_b32 v94, 16, v80
    v_and_b32 v94, 0xfff0, v94
    ds_read_b128 v[90:93], v94 offset:33760
    v_lshrrev_b32 v80, 1, v94
    v_mul_f32 v94, s20, v58
    v_fract_f32 v94, v94
    v_cos_f32 v94, v94
    s_nop 0
    v_add_f32 v95, v94, v94
    v_fma_f32 v95, v95, v94, -1.0
    v_cvt_pk_bf16_f32 v95, v94, v95
    s_waitcnt vmcnt(0)
    v_mfma_f32_4x4x4_16b_bf16 v[96:99], v[122:123], v[70:71], 0
    s_waitcnt lgkmcnt(0)
    v_dot2_f32_bf16 v100, v90, v95, 0
    v_dot2_f32_bf16 v101, v91, v95, 0
    v_dot2_f32_bf16 v102, v92, v95, 0
    v_dot2_f32_bf16 v103, v93, v95, 0
    s_nop 2
    v_pk_mul_f32 v[96:97], v[96:97], v[100:101]
    v_pk_mul_f32 v[98:99], v[98:99], v[102:103]
    ds_read_b64 v[104:105], v80 offset:8752
    s_waitcnt lgkmcnt(0)
gemnet_accum_kernel_sgb_t6:
    s_nop 1
    v_mfma_f32_4x4x4_16b_bf16 v[100:103], v[124:125], v[104:105], v[96:99]
    s_nop 4
    v_cvt_pk_bf16_f32 v90, v100, v101
    v_cvt_pk_bf16_f32 v91, v102, v103
    ds_cmpst_rtn_b64 v[92:93], v80, v[104:105], v[90:91] offset:8752
    s_waitcnt lgkmcnt(0)
    v_cmp_ne_u64 vcc, v[92:93], v[104:105]
    v_mov_b32 v104, v92
    v_mov_b32 v105, v93
    s_and_b64 exec, exec, vcc
    s_cbranch_execnz gemnet_accum_kernel_sgb_t6
gemnet_accum_kernel_tskipb_6:
    s_mov_b64 exec, -1
    s_mov_b64 exec, -1
    s_waitcnt vmcnt(0)
    s_cmp_gt_u32 s80, 7
    s_cbranch_scc0 gemnet_accum_kernel_tskipb_7
    s_cmp_gt_u32 s27, 7
    s_cselect_b64 exec, -1, s[58:59]
    v_and_b32 v65, 0xffff8, v81
    buffer_load_dwordx2 v[72:73], v65, s[4:7], s23 offen
    v_lshrrev_b32 v94, 16, v81
    v_and_b32 v94, 0xfff0, v94
    ds_read_b128 v[90:93], v94 offset:33760
    v_lshrrev_b32 v81, 1, v94
    v_mul_f32 v94, s20, v59
    v_fract_f32 v94, v94
    v_cos_f32 v94, v94
    s_nop 0
    v_add_f32 v95, v94, v94
    v_fma_f32 v95, v95, v94, -1.0
    v_cvt_pk_bf16_f32 v95, v94, v95
    s_waitcnt vmcnt(0)
    v_mfma_f32_4x4x4_16b_bf16 v[96:99], v[122:123], v[72:73], 0
    s_waitcnt lgkmcnt(0)
    v_dot2_f32_bf16 v100, v90, v95, 0
    v_dot2_f32_bf16 v101, v91, v95, 0
    v_dot2_f32_bf16 v102, v92, v95, 0
    v_dot2_f32_bf16 v103, v93, v95, 0
    s_nop 2
    v_pk_mul_f32 v[96:97], v[96:97], v[100:101]
    v_pk_mul_f32 v[98:99], v[98:99], v[102:103]
    ds_read_b64 v[104:105], v81 offset:8752
    s_waitcnt lgkmcnt(0)
gemnet_accum_kernel_sgb_t7:
    s_nop 1
    v_mfma_f32_4x4x4_16b_bf16 v[100:103], v[124:125], v[104:105], v[96:99]
    s_nop 4
    v_cvt_pk_bf16_f32 v90, v100, v101
    v_cvt_pk_bf16_f32 v91, v102, v103
    ds_cmpst_rtn_b64 v[92:93], v81, v[104:105], v[90:91] offset:8752
    s_waitcnt lgkmcnt(0)
    v_cmp_ne_u64 vcc, v[92:93], v[104:105]
    v_mov_b32 v104, v92
    v_mov_b32 v105, v93
    s_and_b64 exec, exec, vcc
    s_cbranch_execnz gemnet_accum_kernel_sgb_t7
gemnet_accum_kernel_tskipb_7:
    s_mov_b64 exec, -1
    s_waitcnt lgkmcnt(0)
    s_cmp_ge_u32 s68, 8
    s_cbranch_scc0 gemnet_accum_kernel_h2sbt_6
    v_lshrrev_b32 v126, 8, v26
    v_and_b32 v126, 4092, v126
    ds_add_rtn_u32 v80, v126, v3 offset:0
    v_lshrrev_b32 v126, 8, v28
    v_and_b32 v126, 4092, v126
    ds_add_rtn_u32 v81, v126, v3 offset:0
    s_branch gemnet_accum_kernel_h2ebt_6
gemnet_accum_kernel_h2sbt_6:
    s_cmp_gt_u32 s72, 6
    s_cbranch_scc0 gemnet_accum_kernel_hgbt_6
    s_cmp_eq_u32 s73, 6
    s_cselect_b64 exec, s[74:75], -1
    v_lshrrev_b32 v126, 8, v26
    v_and_b32 v126, 4092, v126
    ds_add_rtn_u32 v80, v126, v3 offset:0
    s_mov_b64 exec, -1
gemnet_accum_kernel_hgbt_6:
    s_cmp_gt_u32 s72, 7
    s_cbranch_scc0 gemnet_accum_kernel_hgbt_7
    s_cmp_eq_u32 s73, 7
    s_cselect_b64 exec, s[74:75], -1
    v_lshrrev_b32 v126, 8, v28
    v_and_b32 v126, 4092, v126
    ds_add_rtn_u32 v81, v126, v3 offset:0
    s_mov_b64 exec, -1
gemnet_accum_kernel_hgbt_7:
gemnet_accum_kernel_h2ebt_6:
    s_movk_i32 s25, 2304
    v_add3_u32 v57, v56, v2, s25
    v_and_b32 v56, -4, v57
    v_cmp_ne_u32 s[40:41], v56, v57
gemnet_accum_kernel_fbbt_6:
    v_readlane_b32 s62, v127, 7
    v_readlane_b32 s63, v0, 7
    s_nop 1
    v_mbcnt_lo_u32_b32 v126, s62, 0
    v_mbcnt_hi_u32_b32 v126, s63, v126
    v_add_lshl_u32 v126, v126, s24, 2
    s_bcnt1_i32_b64 s65, s[62:63]
    ds_bpermute_b32 v58, v126, v89
    s_add_u32 s24, s24, s65
gemnet_accum_kernel_fabt_7:
gemnet_accum_kernel_tailb_8:
    s_mov_b64 exec, -1
    s_waitcnt vmcnt(0)
    s_cmp_gt_u32 s80, 8
    s_cbranch_scc0 gemnet_accum_kernel_tskipb_8
    s_cmp_gt_u32 s27, 8
    s_cselect_b64 exec, -1, s[58:59]
    v_and_b32 v65, 0xffff8, v82
    buffer_load_dwordx2 v[66:67], v65, s[4:7], s23 offen
    v_lshrrev_b32 v94, 16, v82
    v_and_b32 v94, 0xfff0, v94
    ds_read_b128 v[90:93], v94 offset:33760
    v_lshrrev_b32 v82, 1, v94
    v_mul_f32 v94, s20, v60
    v_fract_f32 v94, v94
    v_cos_f32 v94, v94
    s_nop 0
    v_add_f32 v95, v94, v94
    v_fma_f32 v95, v95, v94, -1.0
    v_cvt_pk_bf16_f32 v95, v94, v95
    s_waitcnt vmcnt(0)
    v_mfma_f32_4x4x4_16b_bf16 v[96:99], v[122:123], v[66:67], 0
    s_waitcnt lgkmcnt(0)
    v_dot2_f32_bf16 v100, v90, v95, 0
    v_dot2_f32_bf16 v101, v91, v95, 0
    v_dot2_f32_bf16 v102, v92, v95, 0
    v_dot2_f32_bf16 v103, v93, v95, 0
    s_nop 2
    v_pk_mul_f32 v[96:97], v[96:97], v[100:101]
    v_pk_mul_f32 v[98:99], v[98:99], v[102:103]
    ds_read_b64 v[104:105], v82 offset:8752
    s_waitcnt lgkmcnt(0)
gemnet_accum_kernel_sgb_t8:
    s_nop 1
    v_mfma_f32_4x4x4_16b_bf16 v[100:103], v[124:125], v[104:105], v[96:99]
    s_nop 4
    v_cvt_pk_bf16_f32 v90, v100, v101
    v_cvt_pk_bf16_f32 v91, v102, v103
    ds_cmpst_rtn_b64 v[92:93], v82, v[104:105], v[90:91] offset:8752
    s_waitcnt lgkmcnt(0)
    v_cmp_ne_u64 vcc, v[92:93], v[104:105]
    v_mov_b32 v104, v92
    v_mov_b32 v105, v93
    s_and_b64 exec, exec, vcc
    s_cbranch_execnz gemnet_accum_kernel_sgb_t8
gemnet_accum_kernel_tskipb_8:
    s_mov_b64 exec, -1
    s_mov_b64 exec, -1
    s_waitcnt vmcnt(0)
    s_cmp_gt_u32 s80, 9
    s_cbranch_scc0 gemnet_accum_kernel_tskipb_9
    s_cmp_gt_u32 s27, 9
    s_cselect_b64 exec, -1, s[58:59]
    v_and_b32 v65, 0xffff8, v83
    buffer_load_dwordx2 v[68:69], v65, s[4:7], s23 offen
    v_lshrrev_b32 v94, 16, v83
    v_and_b32 v94, 0xfff0, v94
    ds_read_b128 v[90:93], v94 offset:33760
    v_lshrrev_b32 v83, 1, v94
    v_mul_f32 v94, s20, v61
    v_fract_f32 v94, v94
    v_cos_f32 v94, v94
    s_nop 0
    v_add_f32 v95, v94, v94
    v_fma_f32 v95, v95, v94, -1.0
    v_cvt_pk_bf16_f32 v95, v94, v95
    s_waitcnt vmcnt(0)
    v_mfma_f32_4x4x4_16b_bf16 v[96:99], v[122:123], v[68:69], 0
    s_waitcnt lgkmcnt(0)
    v_dot2_f32_bf16 v100, v90, v95, 0
    v_dot2_f32_bf16 v101, v91, v95, 0
    v_dot2_f32_bf16 v102, v92, v95, 0
    v_dot2_f32_bf16 v103, v93, v95, 0
    s_nop 2
    v_pk_mul_f32 v[96:97], v[96:97], v[100:101]
    v_pk_mul_f32 v[98:99], v[98:99], v[102:103]
    ds_read_b64 v[104:105], v83 offset:8752
    s_waitcnt lgkmcnt(0)
gemnet_accum_kernel_sgb_t9:
    s_nop 1
    v_mfma_f32_4x4x4_16b_bf16 v[100:103], v[124:125], v[104:105], v[96:99]
    s_nop 4
    v_cvt_pk_bf16_f32 v90, v100, v101
    v_cvt_pk_bf16_f32 v91, v102, v103
    ds_cmpst_rtn_b64 v[92:93], v83, v[104:105], v[90:91] offset:8752
    s_waitcnt lgkmcnt(0)
    v_cmp_ne_u64 vcc, v[92:93], v[104:105]
    v_mov_b32 v104, v92
    v_mov_b32 v105, v93
    s_and_b64 exec, exec, vcc
    s_cbranch_execnz gemnet_accum_kernel_sgb_t9
gemnet_accum_kernel_tskipb_9:
    s_mov_b64 exec, -1
    s_waitcnt lgkmcnt(0)
    s_cmp_ge_u32 s68, 10
    s_cbranch_scc0 gemnet_accum_kernel_h2sbt_8
    v_lshrrev_b32 v126, 8, v30
    v_and_b32 v126, 4092, v126
    ds_add_rtn_u32 v82, v126, v3 offset:0
    v_lshrrev_b32 v126, 8, v32
    v_and_b32 v126, 4092, v126
    ds_add_rtn_u32 v83, v126, v3 offset:0
    s_branch gemnet_accum_kernel_h2ebt_8
gemnet_accum_kernel_h2sbt_8:
    s_cmp_gt_u32 s72, 8
    s_cbranch_scc0 gemnet_accum_kernel_hgbt_8
    s_cmp_eq_u32 s73, 8
    s_cselect_b64 exec, s[74:75], -1
    v_lshrrev_b32 v126, 8, v30
    v_and_b32 v126, 4092, v126
    ds_add_rtn_u32 v82, v126, v3 offset:0
    s_mov_b64 exec, -1
gemnet_accum_kernel_hgbt_8:
    s_cmp_gt_u32 s72, 9
    s_cbranch_scc0 gemnet_accum_kernel_hgbt_9
    s_cmp_eq_u32 s73, 9
    s_cselect_b64 exec, s[74:75], -1
    v_lshrrev_b32 v126, 8, v32
    v_and_b32 v126, 4092, v126
    ds_add_rtn_u32 v83, v126, v3 offset:0
    s_mov_b64 exec, -1
gemnet_accum_kernel_hgbt_9:
gemnet_accum_kernel_h2ebt_8:
    s_movk_i32 s25, 2688
    v_add3_u32 v59, v58, v2, s25
    v_and_b32 v58, -4, v59
    v_cmp_ne_u32 s[42:43], v58, v59
gemnet_accum_kernel_fbbt_7:
    v_readlane_b32 s62, v127, 8
    v_readlane_b32 s63, v0, 8
    s_nop 1
    v_mbcnt_lo_u32_b32 v126, s62, 0
    v_mbcnt_hi_u32_b32 v126, s63, v126
    v_add_lshl_u32 v126, v126, s24, 2
    s_bcnt1_i32_b64 s65, s[62:63]
    ds_bpermute_b32 v60, v126, v89
    s_add_u32 s24, s24, s65
gemnet_accum_kernel_fabt_8:
gemnet_accum_kernel_tailb_10:
    s_mov_b64 exec, -1
    s_waitcnt vmcnt(0)
    s_cmp_gt_u32 s80, 10
    s_cbranch_scc0 gemnet_accum_kernel_tskipb_10
    s_cmp_gt_u32 s27, 10
    s_cselect_b64 exec, -1, s[58:59]
    v_and_b32 v65, 0xffff8, v84
    buffer_load_dwordx2 v[70:71], v65, s[4:7], s23 offen
    v_lshrrev_b32 v94, 16, v84
    v_and_b32 v94, 0xfff0, v94
    ds_read_b128 v[90:93], v94 offset:33760
    v_lshrrev_b32 v84, 1, v94
    v_mul_f32 v94, s20, v62
    v_fract_f32 v94, v94
    v_cos_f32 v94, v94
    s_nop 0
    v_add_f32 v95, v94, v94
    v_fma_f32 v95, v95, v94, -1.0
    v_cvt_pk_bf16_f32 v95, v94, v95
    s_waitcnt vmcnt(0)
    v_mfma_f32_4x4x4_16b_bf16 v[96:99], v[122:123], v[70:71], 0
    s_waitcnt lgkmcnt(0)
    v_dot2_f32_bf16 v100, v90, v95, 0
    v_dot2_f32_bf16 v101, v91, v95, 0
    v_dot2_f32_bf16 v102, v92, v95, 0
    v_dot2_f32_bf16 v103, v93, v95, 0
    s_nop 2
    v_pk_mul_f32 v[96:97], v[96:97], v[100:101]
    v_pk_mul_f32 v[98:99], v[98:99], v[102:103]
    ds_read_b64 v[104:105], v84 offset:8752
    s_waitcnt lgkmcnt(0)
gemnet_accum_kernel_sgb_t10:
    s_nop 1
    v_mfma_f32_4x4x4_16b_bf16 v[100:103], v[124:125], v[104:105], v[96:99]
    s_nop 4
    v_cvt_pk_bf16_f32 v90, v100, v101
    v_cvt_pk_bf16_f32 v91, v102, v103
    ds_cmpst_rtn_b64 v[92:93], v84, v[104:105], v[90:91] offset:8752
    s_waitcnt lgkmcnt(0)
    v_cmp_ne_u64 vcc, v[92:93], v[104:105]
    v_mov_b32 v104, v92
    v_mov_b32 v105, v93
    s_and_b64 exec, exec, vcc
    s_cbranch_execnz gemnet_accum_kernel_sgb_t10
gemnet_accum_kernel_tskipb_10:
    s_mov_b64 exec, -1
    s_mov_b64 exec, -1
    s_waitcnt vmcnt(0)
    s_cmp_gt_u32 s80, 11
    s_cbranch_scc0 gemnet_accum_kernel_tskipb_11
    s_cmp_gt_u32 s27, 11
    s_cselect_b64 exec, -1, s[58:59]
    v_and_b32 v65, 0xffff8, v85
    buffer_load_dwordx2 v[72:73], v65, s[4:7], s23 offen
    v_lshrrev_b32 v94, 16, v85
    v_and_b32 v94, 0xfff0, v94
    ds_read_b128 v[90:93], v94 offset:33760
    v_lshrrev_b32 v85, 1, v94
    v_mul_f32 v94, s20, v63
    v_fract_f32 v94, v94
    v_cos_f32 v94, v94
    s_nop 0
    v_add_f32 v95, v94, v94
    v_fma_f32 v95, v95, v94, -1.0
    v_cvt_pk_bf16_f32 v95, v94, v95
    s_waitcnt vmcnt(0)
    v_mfma_f32_4x4x4_16b_bf16 v[96:99], v[122:123], v[72:73], 0
    s_waitcnt lgkmcnt(0)
    v_dot2_f32_bf16 v100, v90, v95, 0
    v_dot2_f32_bf16 v101, v91, v95, 0
    v_dot2_f32_bf16 v102, v92, v95, 0
    v_dot2_f32_bf16 v103, v93, v95, 0
    s_nop 2
    v_pk_mul_f32 v[96:97], v[96:97], v[100:101]
    v_pk_mul_f32 v[98:99], v[98:99], v[102:103]
    ds_read_b64 v[104:105], v85 offset:8752
    s_waitcnt lgkmcnt(0)
gemnet_accum_kernel_sgb_t11:
    s_nop 1
    v_mfma_f32_4x4x4_16b_bf16 v[100:103], v[124:125], v[104:105], v[96:99]
    s_nop 4
    v_cvt_pk_bf16_f32 v90, v100, v101
    v_cvt_pk_bf16_f32 v91, v102, v103
    ds_cmpst_rtn_b64 v[92:93], v85, v[104:105], v[90:91] offset:8752
    s_waitcnt lgkmcnt(0)
    v_cmp_ne_u64 vcc, v[92:93], v[104:105]
    v_mov_b32 v104, v92
    v_mov_b32 v105, v93
    s_and_b64 exec, exec, vcc
    s_cbranch_execnz gemnet_accum_kernel_sgb_t11
gemnet_accum_kernel_tskipb_11:
    s_mov_b64 exec, -1
    s_waitcnt lgkmcnt(0)
    s_cmp_ge_u32 s68, 12
    s_cbranch_scc0 gemnet_accum_kernel_h2sbt_10
    v_lshrrev_b32 v126, 8, v34
    v_and_b32 v126, 4092, v126
    ds_add_rtn_u32 v84, v126, v3 offset:0
    v_lshrrev_b32 v126, 8, v36
    v_and_b32 v126, 4092, v126
    ds_add_rtn_u32 v85, v126, v3 offset:0
    s_branch gemnet_accum_kernel_h2ebt_10
gemnet_accum_kernel_h2sbt_10:
    s_cmp_gt_u32 s72, 10
    s_cbranch_scc0 gemnet_accum_kernel_hgbt_10
    s_cmp_eq_u32 s73, 10
    s_cselect_b64 exec, s[74:75], -1
    v_lshrrev_b32 v126, 8, v34
    v_and_b32 v126, 4092, v126
    ds_add_rtn_u32 v84, v126, v3 offset:0
    s_mov_b64 exec, -1
gemnet_accum_kernel_hgbt_10:
    s_cmp_gt_u32 s72, 11
    s_cbranch_scc0 gemnet_accum_kernel_hgbt_11
    s_cmp_eq_u32 s73, 11
    s_cselect_b64 exec, s[74:75], -1
    v_lshrrev_b32 v126, 8, v36
    v_and_b32 v126, 4092, v126
    ds_add_rtn_u32 v85, v126, v3 offset:0
    s_mov_b64 exec, -1
gemnet_accum_kernel_hgbt_11:
gemnet_accum_kernel_h2ebt_10:
    s_movk_i32 s25, 3072
    v_add3_u32 v61, v60, v2, s25
    v_and_b32 v60, -4, v61
    v_cmp_ne_u32 s[44:45], v60, v61
gemnet_accum_kernel_fbbt_8:
    v_readlane_b32 s62, v127, 9
    v_readlane_b32 s63, v0, 9
    s_nop 1
    v_mbcnt_lo_u32_b32 v126, s62, 0
    v_mbcnt_hi_u32_b32 v126, s63, v126
    v_add_lshl_u32 v126, v126, s24, 2
    s_bcnt1_i32_b64 s65, s[62:63]
    ds_bpermute_b32 v62, v126, v89
    s_add_u32 s24, s24, s65
gemnet_accum_kernel_fabt_9:
    s_mov_b64 exec, -1
    s_waitcnt vmcnt(0)
    s_cmp_gt_u32 s80, 12
    s_cbranch_scc0 gemnet_accum_kernel_tskipb_12
    s_cmp_gt_u32 s27, 12
    s_cselect_b64 exec, -1, s[58:59]
    v_and_b32 v65, 0xffff8, v86
    buffer_load_dwordx2 v[66:67], v65, s[4:7], s23 offen
    v_lshrrev_b32 v94, 16, v86
    v_and_b32 v94, 0xfff0, v94
    ds_read_b128 v[90:93], v94 offset:33760
    v_lshrrev_b32 v86, 1, v94
    v_mul_f32 v94, s20, v64
    v_fract_f32 v94, v94
    v_cos_f32 v94, v94
    s_nop 0
    v_add_f32 v95, v94, v94
    v_fma_f32 v95, v95, v94, -1.0
    v_cvt_pk_bf16_f32 v95, v94, v95
    s_waitcnt vmcnt(0)
    v_mfma_f32_4x4x4_16b_bf16 v[96:99], v[122:123], v[66:67], 0
    s_waitcnt lgkmcnt(0)
    v_dot2_f32_bf16 v100, v90, v95, 0
    v_dot2_f32_bf16 v101, v91, v95, 0
    v_dot2_f32_bf16 v102, v92, v95, 0
    v_dot2_f32_bf16 v103, v93, v95, 0
    s_nop 2
    v_pk_mul_f32 v[96:97], v[96:97], v[100:101]
    v_pk_mul_f32 v[98:99], v[98:99], v[102:103]
    ds_read_b64 v[104:105], v86 offset:8752
    s_waitcnt lgkmcnt(0)
gemnet_accum_kernel_sgb_t12:
    s_nop 1
    v_mfma_f32_4x4x4_16b_bf16 v[100:103], v[124:125], v[104:105], v[96:99]
    s_nop 4
    v_cvt_pk_bf16_f32 v90, v100, v101
    v_cvt_pk_bf16_f32 v91, v102, v103
    ds_cmpst_rtn_b64 v[92:93], v86, v[104:105], v[90:91] offset:8752
    s_waitcnt lgkmcnt(0)
    v_cmp_ne_u64 vcc, v[92:93], v[104:105]
    v_mov_b32 v104, v92
    v_mov_b32 v105, v93
    s_and_b64 exec, exec, vcc
    s_cbranch_execnz gemnet_accum_kernel_sgb_t12
gemnet_accum_kernel_tskipb_12:
    s_mov_b64 exec, -1
    s_cmp_gt_u32 s72, 12
    s_cbranch_scc0 gemnet_accum_kernel_hgbt_12
    s_cmp_eq_u32 s73, 12
    s_cselect_b64 exec, s[74:75], -1
    v_lshrrev_b32 v126, 8, v38
    v_and_b32 v126, 4092, v126
    ds_add_rtn_u32 v86, v126, v3 offset:0
    s_mov_b64 exec, -1
gemnet_accum_kernel_hgbt_12:
gemnet_accum_kernel_pdb:
    s_mov_b64 exec, -1
    s_setprio 0
    s_cmp_gt_u32 s72, 13
    s_cbranch_scc0 gemnet_accum_kernel_hgbe_13
    s_cmp_eq_u32 s73, 13
    s_cselect_b64 exec, s[74:75], -1
    v_lshrrev_b32 v126, 8, v40
    v_and_b32 v126, 4092, v126
    ds_add_rtn_u32 v87, v126, v3 offset:0
    s_mov_b64 exec, -1
gemnet_accum_kernel_hgbe_13:
    s_cmp_gt_u32 s72, 14
    s_cbranch_scc0 gemnet_accum_kernel_hgbe_14
    s_cmp_eq_u32 s73, 14
    s_cselect_b64 exec, s[74:75], -1
    v_lshrrev_b32 v126, 8, v42
    v_and_b32 v126, 4092, v126
    ds_add_rtn_u32 v88, v126, v3 offset:0
    s_mov_b64 exec, -1
gemnet_accum_kernel_hgbe_14:
    s_waitcnt vmcnt(0) lgkmcnt(0)
    s_movk_i32 s25, 3456
    v_add3_u32 v63, v62, v2, s25
    v_and_b32 v62, -4, v63
    v_cmp_ne_u32 s[46:47], v62, v63
gemnet_accum_kernel_fbbe_9:
    v_readlane_b32 s62, v127, 10
    v_readlane_b32 s63, v0, 10
    s_nop 1
    v_mbcnt_lo_u32_b32 v126, s62, 0
    v_mbcnt_hi_u32_b32 v126, s63, v126
    v_add_lshl_u32 v126, v126, s24, 2
    s_bcnt1_i32_b64 s65, s[62:63]
    ds_bpermute_b32 v64, v126, v89
    s_add_u32 s24, s24, s65
gemnet_accum_kernel_fabe_10:
    v_readlane_b32 s62, v127, 11
    v_readlane_b32 s63, v0, 11
    s_nop 1
    v_mbcnt_lo_u32_b32 v126, s62, 0
    v_mbcnt_hi_u32_b32 v126, s63, v126
    v_add_lshl_u32 v126, v126, s24, 2
    s_bcnt1_i32_b64 s65, s[62:63]
    ds_bpermute_b32 v66, v126, v89
    s_add_u32 s24, s24, s65
gemnet_accum_kernel_fabe_11:
    v_readlane_b32 s62, v127, 12
    v_readlane_b32 s63, v0, 12
    s_nop 1
    v_mbcnt_lo_u32_b32 v126, s62, 0
    v_mbcnt_hi_u32_b32 v126, s63, v126
    v_add_lshl_u32 v126, v126, s24, 2
    s_bcnt1_i32_b64 s65, s[62:63]
    ds_bpermute_b32 v68, v126, v89
    s_add_u32 s24, s24, s65
gemnet_accum_kernel_fabe_12:
    s_cmp_gt_u32 s76, 13
    s_cbranch_scc0 gemnet_accum_kernel_fabe_13
    v_readlane_b32 s62, v127, 13
    v_readlane_b32 s63, v0, 13
    s_nop 1
    v_mbcnt_lo_u32_b32 v126, s62, 0
    v_mbcnt_hi_u32_b32 v126, s63, v126
    v_add_lshl_u32 v126, v126, s24, 2
    s_bcnt1_i32_b64 s65, s[62:63]
    ds_bpermute_b32 v70, v126, v89
    s_add_u32 s24, s24, s65
gemnet_accum_kernel_fabe_13:
    s_cmp_gt_u32 s76, 14
    s_cbranch_scc0 gemnet_accum_kernel_fabe_14
    v_readlane_b32 s62, v127, 14
    v_readlane_b32 s63, v0, 14
    s_nop 1
    v_mbcnt_lo_u32_b32 v126, s62, 0
    v_mbcnt_hi_u32_b32 v126, s63, v126
    v_add_lshl_u32 v126, v126, s24, 2
    s_bcnt1_i32_b64 s65, s[62:63]
    ds_bpermute_b32 v72, v126, v89
    s_add_u32 s24, s24, s65
gemnet_accum_kernel_fabe_14:
    s_waitcnt lgkmcnt(0)
    s_movk_i32 s25, 3840
    v_add3_u32 v65, v64, v2, s25
    v_and_b32 v64, -4, v65
    v_cmp_ne_u32 s[48:49], v64, v65
gemnet_accum_kernel_fbbe_10:
    s_movk_i32 s25, 4224
    v_add3_u32 v67, v66, v2, s25
    v_and_b32 v66, -4, v67
    v_cmp_ne_u32 s[50:51], v66, v67
gemnet_accum_kernel_fbbe_11:
    s_movk_i32 s25, 4608
    v_add3_u32 v69, v68, v2, s25
    v_and_b32 v68, -4, v69
    v_cmp_ne_u32 s[52:53], v68, v69
gemnet_accum_kernel_fbbe_12:
    s_cmp_gt_u32 s76, 13
    s_cbranch_scc0 gemnet_accum_kernel_fbbe_13
    s_movk_i32 s25, 4992
    v_add3_u32 v71, v70, v2, s25
    v_and_b32 v70, -4, v71
    v_cmp_ne_u32 s[54:55], v70, v71
gemnet_accum_kernel_fbbe_13:
    s_cmp_gt_u32 s76, 14
    s_cbranch_scc0 gemnet_accum_kernel_fbbe_14
    s_movk_i32 s25, 5376
    v_add3_u32 v73, v72, v2, s25
    v_and_b32 v72, -4, v73
    v_cmp_ne_u32 s[56:57], v72, v73
gemnet_accum_kernel_fbbe_14:
    s_add_u32 s23, s23, 800000
    s_cmp_eq_u32 s81, 3
    s_cbranch_scc1 gemnet_accum_kernel_fastdone
    s_waitcnt vmcnt(0)
    s_cmp_lt_u32 s22, 4
    s_cbranch_scc0 gemnet_accum_kernel_nopfa
    v_lshlrev_b32 v5, 7, v1
    s_add_u32 s64, s23, s89
    buffer_load_dword v5, v5, s[4:7], s64 offen
gemnet_accum_kernel_nopfa:
    s_cmp_gt_u32 s76, 0
    s_cbranch_scc0 gemnet_accum_kernel_hna_0
    s_cmp_eq_u32 s77, 0
    s_cselect_b64 exec, s[78:79], -1
    buffer_load_dwordx2 v[44:45], v44, s[8:11], 0 offen
    s_mov_b64 exec, -1
gemnet_accum_kernel_hna_0:
    s_waitcnt lgkmcnt(0)
    s_barrier
    s_cmp_eq_u32 s22, 0
    s_cbranch_scc1 gemnet_accum_kernel_doscana
    s_cmp_gt_u32 s76, 1
    s_cbranch_scc0 gemnet_accum_kernel_hmao_1
    s_cmp_eq_u32 s77, 1
    s_cselect_b64 exec, s[78:79], -1
    buffer_load_dwordx2 v[46:47], v46, s[8:11], 0 offen
    s_mov_b64 exec, -1
gemnet_accum_kernel_hmao_1:
    s_cmp_gt_u32 s76, 2
    s_cbranch_scc0 gemnet_accum_kernel_hmao_2
    s_cmp_eq_u32 s77, 2
    s_cselect_b64 exec, s[78:79], -1
    buffer_load_dwordx2 v[48:49], v48, s[8:11], 0 offen
    s_mov_b64 exec, -1
gemnet_accum_kernel_hmao_2:
    s_cmp_gt_u32 s76, 3
    s_cbranch_scc0 gemnet_accum_kernel_hmao_3
    s_cmp_eq_u32 s77, 3
    s_cselect_b64 exec, s[78:79], -1
    buffer_load_dwordx2 v[50:51], v50, s[8:11], 0 offen
    s_mov_b64 exec, -1
gemnet_accum_kernel_hmao_3:
    s_branch gemnet_accum_kernel_noscana
gemnet_accum_kernel_doscana:
    v_mul_u32_u24 v114, 52, v1
    ds_read_b32 v98, v114 offset:0
    ds_read_b32 v99, v114 offset:4
    ds_read_b32 v100, v114 offset:8
    ds_read_b32 v101, v114 offset:12
    ds_read_b32 v102, v114 offset:16
    ds_read_b32 v103, v114 offset:20
    ds_read_b32 v104, v114 offset:24
    ds_read_b32 v105, v114 offset:28
    ds_read_b32 v106, v114 offset:32
    ds_read_b32 v107, v114 offset:36
    ds_read_b32 v108, v114 offset:40
    ds_read_b32 v109, v114 offset:44
    ds_read_b32 v110, v114 offset:48
    s_waitcnt lgkmcnt(0)
    v_add_u32 v115, v98, v99
    v_add_u32 v115, v115, v100
    v_add_u32 v115, v115, v101
    v_add_u32 v115, v115, v102
    v_add_u32 v115, v115, v103
    v_add_u32 v115, v115, v104
    v_add_u32 v115, v115, v105
    v_add_u32 v115, v115, v106
    v_add_u32 v115, v115, v107
    v_add_u32 v115, v115, v108
    v_add_u32 v115, v115, v109
    v_add_u32 v115, v115, v110
    v_mov_b32 v116, v115
    s_nop 1
    v_add_u32_dpp v116, v116, v116 row_shr:1 row_mask:0xf bank_mask:0xf
    s_nop 1
    v_add_u32_dpp v116, v116, v116 row_shr:2 row_mask:0xf bank_mask:0xf
    s_nop 1
    v_add_u32_dpp v116, v116, v116 row_shr:4 row_mask:0xf bank_mask:0xf
    s_nop 1
    v_add_u32_dpp v116, v116, v116 row_shr:8 row_mask:0xf bank_mask:0xf
    s_nop 1
    v_add_u32_dpp v116, v116, v116 row_bcast:15 row_mask:0xa bank_mask:0xf
    s_nop 1
    v_add_u32_dpp v116, v116, v116 row_bcast:31 row_mask:0xc bank_mask:0xf
    s_mov_b32 s62, 0
    s_mov_b32 s63, 0x80000000
    s_mov_b64 exec, s[62:63]
    v_mov_b32 v90, 0
    ds_write_b32 v90, v116 offset:6656
    s_mov_b64 exec, -1
    v_sub_u32 v116, v116, v115
    v_add_u32 v116, 27596, v116
    ds_write_b32 v114, v116 offset:0
    v_add_u32 v116, v116, v98
    ds_write_b32 v114, v116 offset:4
    v_add_u32 v116, v116, v99
    ds_write_b32 v114, v116 offset:8
    v_add_u32 v116, v116, v100
    ds_write_b32 v114, v116 offset:12
    v_add_u32 v116, v116, v101
    ds_write_b32 v114, v116 offset:16
    v_add_u32 v116, v116, v102
    ds_write_b32 v114, v116 offset:20
    v_add_u32 v116, v116, v103
    ds_write_b32 v114, v116 offset:24
    v_add_u32 v116, v116, v104
    ds_write_b32 v114, v116 offset:28
    v_add_u32 v116, v116, v105
    ds_write_b32 v114, v116 offset:32
    v_add_u32 v116, v116, v106
    ds_write_b32 v114, v116 offset:36
    v_add_u32 v116, v116, v107
    ds_write_b32 v114, v116 offset:40
    v_add_u32 v116, v116, v108
    ds_write_b32 v114, v116 offset:44
    v_add_u32 v116, v116, v109
    ds_write_b32 v114, v116 offset:48
    s_cmp_gt_u32 s76, 1
    s_cbranch_scc0 gemnet_accum_kernel_hmas_1
    s_cmp_eq_u32 s77, 1
    s_cselect_b64 exec, s[78:79], -1
    buffer_load_dwordx2 v[46:47], v46, s[8:11], 0 offen
    s_mov_b64 exec, -1
gemnet_accum_kernel_hmas_1:
    s_cmp_gt_u32 s76, 2
    s_cbranch_scc0 gemnet_accum_kernel_hmas_2
    s_cmp_eq_u32 s77, 2
    s_cselect_b64 exec, s[78:79], -1
    buffer_load_dwordx2 v[48:49], v48, s[8:11], 0 offen
    s_mov_b64 exec, -1
gemnet_accum_kernel_hmas_2:
    s_cmp_gt_u32 s76, 3
    s_cbranch_scc0 gemnet_accum_kernel_hmas_3
    s_cmp_eq_u32 s77, 3
    s_cselect_b64 exec, s[78:79], -1
    buffer_load_dwordx2 v[50:51], v50, s[8:11], 0 offen
    s_mov_b64 exec, -1
gemnet_accum_kernel_hmas_3:
    s_waitcnt lgkmcnt(0)
gemnet_accum_kernel_noscana:
    s_barrier
    v_mov_b32 v90, 0
    ds_read_b32 v91, v90 offset:6656
    s_min_u32 s64, s68, s69
    s_cmp_ge_u32 s64, 11
    s_cbranch_scc0 gemnet_accum_kernel_scga
    v_lshrrev_b32 v98, 8, v14
    v_and_b32 v98, 4092, v98
    ds_read_b32 v98, v98 offset:0
    v_lshrrev_b32 v99, 8, v16
    v_and_b32 v99, 4092, v99
    ds_read_b32 v99, v99 offset:0
    v_lshrrev_b32 v100, 8, v18
    v_and_b32 v100, 4092, v100
    ds_read_b32 v100, v100 offset:0
    v_lshrrev_b32 v101, 8, v20
    v_and_b32 v101, 4092, v101
    ds_read_b32 v101, v101 offset:0
    v_lshrrev_b32 v102, 8, v22
    v_and_b32 v102, 4092, v102
    ds_read_b32 v102, v102 offset:0
    v_lshrrev_b32 v103, 8, v24
    v_and_b32 v103, 4092, v103
    ds_read_b32 v103, v103 offset:0
    v_lshrrev_b32 v104, 8, v26
    v_and_b32 v104, 4092, v104
    ds_read_b32 v104, v104 offset:0
    v_lshrrev_b32 v105, 8, v28
    v_and_b32 v105, 4092, v105
    ds_read_b32 v105, v105 offset:0
    v_lshrrev_b32 v106, 8, v30
    v_and_b32 v106, 4092, v106
    ds_read_b32 v106, v106 offset:0
    v_lshrrev_b32 v107, 8, v32
    v_and_b32 v107, 4092, v107
    ds_read_b32 v107, v107 offset:0
    v_lshrrev_b32 v108, 8, v34
    v_and_b32 v108, 4092, v108
    ds_read_b32 v108, v108 offset:0
    s_cmp_gt_u32 s72, 11
    s_cbranch_scc0 gemnet_accum_kernel_saaf
    s_cmp_eq_u32 s73, 11
    s_cselect_b64 exec, s[74:75], -1
    v_lshrrev_b32 v109, 8, v36
    v_and_b32 v109, 4092, v109
    ds_read_b32 v109, v109 offset:0
    s_cmp_gt_u32 s72, 12
    s_cbranch_scc0 gemnet_accum_kernel_saaf
    s_cmp_eq_u32 s73, 12
    s_cselect_b64 exec, s[74:75], -1
    v_lshrrev_b32 v110, 8, v38
    v_and_b32 v110, 4092, v110
    ds_read_b32 v110, v110 offset:0
    s_cmp_gt_u32 s72, 13
    s_cbranch_scc0 gemnet_accum_kernel_saaf
    s_cmp_eq_u32 s73, 13
    s_cselect_b64 exec, s[74:75], -1
    v_lshrrev_b32 v111, 8, v40
    v_and_b32 v111, 4092, v111
    ds_read_b32 v111, v111 offset:0
    s_cmp_gt_u32 s72, 14
    s_cbranch_scc0 gemnet_accum_kernel_saaf
    s_cmp_eq_u32 s73, 14
    s_cselect_b64 exec, s[74:75], -1
    v_lshrrev_b32 v112, 8, v42
    v_and_b32 v112, 4092, v112
    ds_read_b32 v112, v112 offset:0
gemnet_accum_kernel_saaf:
    s_mov_b64 exec, -1
    s_waitcnt lgkmcnt(0)
    v_readfirstlane_b32 s26, v91
    v_add_u32 v98, v98, v74
    v_lshlrev_b32 v74, 2, v98
    v_add_u32 v98, v98, v98
    ds_write_b32 v74, v14
    ds_write_b16 v98, v15 offset:28568
    v_add_u32 v99, v99, v75
    v_lshlrev_b32 v75, 2, v99
    v_add_u32 v99, v99, v99
    ds_write_b32 v75, v16
    ds_write_b16 v99, v17 offset:28568
    v_add_u32 v100, v100, v76
    v_lshlrev_b32 v76, 2, v100
    v_add_u32 v100, v100, v100
    ds_write_b32 v76, v18
    ds_write_b16 v100, v19 offset:28568
    v_add_u32 v101, v101, v77
    v_lshlrev_b32 v77, 2, v101
    v_add_u32 v101, v101, v101
    ds_write_b32 v77, v20
    ds_write_b16 v101, v21 offset:28568
    v_add_u32 v102, v102, v78
    v_lshlrev_b32 v78, 2, v102
    v_add_u32 v102, v102, v102
    ds_write_b32 v78, v22
    ds_write_b16 v102, v23 offset:28568
    buffer_load_dwordx2 v[52:53], v52, s[8:11], 0 offen
    v_add_u32 v103, v103, v79
    v_lshlrev_b32 v79, 2, v103
    v_add_u32 v103, v103, v103
    ds_write_b32 v79, v24
    ds_write_b16 v103, v25 offset:28568
    buffer_load_dwordx2 v[54:55], v54, s[8:11], 0 offen
    v_add_u32 v104, v104, v80
    v_lshlrev_b32 v80, 2, v104
    v_add_u32 v104, v104, v104
    ds_write_b32 v80, v26
    ds_write_b16 v104, v27 offset:28568
    buffer_load_dwordx2 v[56:57], v56, s[8:11], 0 offen
    v_add_u32 v105, v105, v81
    v_lshlrev_b32 v81, 2, v105
    v_add_u32 v105, v105, v105
    ds_write_b32 v81, v28
    ds_write_b16 v105, v29 offset:28568
    buffer_load_dwordx2 v[58:59], v58, s[8:11], 0 offen
    v_add_u32 v106, v106, v82
    v_lshlrev_b32 v82, 2, v106
    v_add_u32 v106, v106, v106
    ds_write_b32 v82, v30
    ds_write_b16 v106, v31 offset:28568
    buffer_load_dwordx2 v[60:61], v60, s[8:11], 0 offen
    v_add_u32 v107, v107, v83
    v_lshlrev_b32 v83, 2, v107
    v_add_u32 v107, v107, v107
    ds_write_b32 v83, v32
    ds_write_b16 v107, v33 offset:28568
    buffer_load_dwordx2 v[62:63], v62, s[8:11], 0 offen
    v_add_u32 v108, v108, v84
    v_lshlrev_b32 v84, 2, v108
    v_add_u32 v108, v108, v108
    ds_write_b32 v84, v34
    ds_write_b16 v108, v35 offset:28568
    buffer_load_dwordx2 v[64:65], v64, s[8:11], 0 offen
    s_cmp_gt_u32 s72, 11
    s_cbranch_scc0 gemnet_accum_kernel_sbaf_11
    s_cmp_eq_u32 s73, 11
    s_cselect_b64 exec, s[74:75], -1
    v_add_u32 v109, v109, v85
    v_lshlrev_b32 v85, 2, v109
    v_add_u32 v109, v109, v109
    ds_write_b32 v85, v36
    ds_write_b16 v109, v37 offset:28568
gemnet_accum_kernel_sbaf_11:
    s_cmp_gt_u32 s76, 11
    s_cbranch_scc0 gemnet_accum_kernel_snaf_11
    s_cmp_eq_u32 s77, 11
    s_cselect_b64 exec, s[78:79], -1
    buffer_load_dwordx2 v[66:67], v66, s[8:11], 0 offen
    s_mov_b64 exec, -1
gemnet_accum_kernel_snaf_11:
    s_cmp_gt_u32 s72, 12
    s_cbranch_scc0 gemnet_accum_kernel_sbaf_12
    s_cmp_eq_u32 s73, 12
    s_cselect_b64 exec, s[74:75], -1
    v_add_u32 v110, v110, v86
    v_lshlrev_b32 v86, 2, v110
    v_add_u32 v110, v110, v110
    ds_write_b32 v86, v38
    ds_write_b16 v110, v39 offset:28568
gemnet_accum_kernel_sbaf_12:
    s_cmp_gt_u32 s76, 12
    s_cbranch_scc0 gemnet_accum_kernel_snaf_12
    s_cmp_eq_u32 s77, 12
    s_cselect_b64 exec, s[78:79], -1
    buffer_load_dwordx2 v[68:69], v68, s[8:11], 0 offen
    s_mov_b64 exec, -1
gemnet_accum_kernel_snaf_12:
    s_cmp_gt_u32 s72, 13
    s_cbranch_scc0 gemnet_accum_kernel_sbaf_13
    s_cmp_eq_u32 s73, 13
    s_cselect_b64 exec, s[74:75], -1
    v_add_u32 v111, v111, v87
    v_lshlrev_b32 v87, 2, v111
    v_add_u32 v111, v111, v111
    ds_write_b32 v87, v40
    ds_write_b16 v111, v41 offset:28568
gemnet_accum_kernel_sbaf_13:
    s_cmp_gt_u32 s76, 13
    s_cbranch_scc0 gemnet_accum_kernel_snaf_13
    s_cmp_eq_u32 s77, 13
    s_cselect_b64 exec, s[78:79], -1
    buffer_load_dwordx2 v[70:71], v70, s[8:11], 0 offen
    s_mov_b64 exec, -1
gemnet_accum_kernel_snaf_13:
    s_cmp_gt_u32 s72, 14
    s_cbranch_scc0 gemnet_accum_kernel_sbaf_14
    s_cmp_eq_u32 s73, 14
    s_cselect_b64 exec, s[74:75], -1
    v_add_u32 v112, v112, v88
    v_lshlrev_b32 v88, 2, v112
    v_add_u32 v112, v112, v112
    ds_write_b32 v88, v42
    ds_write_b16 v112, v43 offset:28568
gemnet_accum_kernel_sbaf_14:
    s_cmp_gt_u32 s76, 14
    s_cbranch_scc0 gemnet_accum_kernel_snaf_14
    s_cmp_eq_u32 s77, 14
    s_cselect_b64 exec, s[78:79], -1
    buffer_load_dwordx2 v[72:73], v72, s[8:11], 0 offen
    s_mov_b64 exec, -1
gemnet_accum_kernel_snaf_14:
    s_branch gemnet_accum_kernel_scea
gemnet_accum_kernel_scga:
    s_cmp_gt_u32 s72, 0
    s_cbranch_scc0 gemnet_accum_kernel_saag
    s_cmp_eq_u32 s73, 0
    s_cselect_b64 exec, s[74:75], -1
    v_lshrrev_b32 v98, 8, v14
    v_and_b32 v98, 4092, v98
    ds_read_b32 v98, v98 offset:0
    s_cmp_gt_u32 s72, 1
    s_cbranch_scc0 gemnet_accum_kernel_saag
    s_cmp_eq_u32 s73, 1
    s_cselect_b64 exec, s[74:75], -1
    v_lshrrev_b32 v99, 8, v16
    v_and_b32 v99, 4092, v99
    ds_read_b32 v99, v99 offset:0
    s_cmp_gt_u32 s72, 2
    s_cbranch_scc0 gemnet_accum_kernel_saag
    s_cmp_eq_u32 s73, 2
    s_cselect_b64 exec, s[74:75], -1
    v_lshrrev_b32 v100, 8, v18
    v_and_b32 v100, 4092, v100
    ds_read_b32 v100, v100 offset:0
    s_cmp_gt_u32 s72, 3
    s_cbranch_scc0 gemnet_accum_kernel_saag
    s_cmp_eq_u32 s73, 3
    s_cselect_b64 exec, s[74:75], -1
    v_lshrrev_b32 v101, 8, v20
    v_and_b32 v101, 4092, v101
    ds_read_b32 v101, v101 offset:0
    s_cmp_gt_u32 s72, 4
    s_cbranch_scc0 gemnet_accum_kernel_saag
    s_cmp_eq_u32 s73, 4
    s_cselect_b64 exec, s[74:75], -1
    v_lshrrev_b32 v102, 8, v22
    v_and_b32 v102, 4092, v102
    ds_read_b32 v102, v102 offset:0
    s_cmp_gt_u32 s72, 5
    s_cbranch_scc0 gemnet_accum_kernel_saag
    s_cmp_eq_u32 s73, 5
    s_cselect_b64 exec, s[74:75], -1
    v_lshrrev_b32 v103, 8, v24
    v_and_b32 v103, 4092, v103
    ds_read_b32 v103, v103 offset:0
    s_cmp_gt_u32 s72, 6
    s_cbranch_scc0 gemnet_accum_kernel_saag
    s_cmp_eq_u32 s73, 6
    s_cselect_b64 exec, s[74:75], -1
    v_lshrrev_b32 v104, 8, v26
    v_and_b32 v104, 4092, v104
    ds_read_b32 v104, v104 offset:0
    s_cmp_gt_u32 s72, 7
    s_cbranch_scc0 gemnet_accum_kernel_saag
    s_cmp_eq_u32 s73, 7
    s_cselect_b64 exec, s[74:75], -1
    v_lshrrev_b32 v105, 8, v28
    v_and_b32 v105, 4092, v105
    ds_read_b32 v105, v105 offset:0
    s_cmp_gt_u32 s72, 8
    s_cbranch_scc0 gemnet_accum_kernel_saag
    s_cmp_eq_u32 s73, 8
    s_cselect_b64 exec, s[74:75], -1
    v_lshrrev_b32 v106, 8, v30
    v_and_b32 v106, 4092, v106
    ds_read_b32 v106, v106 offset:0
    s_cmp_gt_u32 s72, 9
    s_cbranch_scc0 gemnet_accum_kernel_saag
    s_cmp_eq_u32 s73, 9
    s_cselect_b64 exec, s[74:75], -1
    v_lshrrev_b32 v107, 8, v32
    v_and_b32 v107, 4092, v107
    ds_read_b32 v107, v107 offset:0
    s_cmp_gt_u32 s72, 10
    s_cbranch_scc0 gemnet_accum_kernel_saag
    s_cmp_eq_u32 s73, 10
    s_cselect_b64 exec, s[74:75], -1
    v_lshrrev_b32 v108, 8, v34
    v_and_b32 v108, 4092, v108
    ds_read_b32 v108, v108 offset:0
    s_cmp_gt_u32 s72, 11
    s_cbranch_scc0 gemnet_accum_kernel_saag
    s_cmp_eq_u32 s73, 11
    s_cselect_b64 exec, s[74:75], -1
    v_lshrrev_b32 v109, 8, v36
    v_and_b32 v109, 4092, v109
    ds_read_b32 v109, v109 offset:0
    s_cmp_gt_u32 s72, 12
    s_cbranch_scc0 gemnet_accum_kernel_saag
    s_cmp_eq_u32 s73, 12
    s_cselect_b64 exec, s[74:75], -1
    v_lshrrev_b32 v110, 8, v38
    v_and_b32 v110, 4092, v110
    ds_read_b32 v110, v110 offset:0
    s_cmp_gt_u32 s72, 13
    s_cbranch_scc0 gemnet_accum_kernel_saag
    s_cmp_eq_u32 s73, 13
    s_cselect_b64 exec, s[74:75], -1
    v_lshrrev_b32 v111, 8, v40
    v_and_b32 v111, 4092, v111
    ds_read_b32 v111, v111 offset:0
    s_cmp_gt_u32 s72, 14
    s_cbranch_scc0 gemnet_accum_kernel_saag
    s_cmp_eq_u32 s73, 14
    s_cselect_b64 exec, s[74:75], -1
    v_lshrrev_b32 v112, 8, v42
    v_and_b32 v112, 4092, v112
    ds_read_b32 v112, v112 offset:0
gemnet_accum_kernel_saag:
    s_mov_b64 exec, -1
    s_waitcnt lgkmcnt(0)
    v_readfirstlane_b32 s26, v91
    s_cmp_gt_u32 s72, 0
    s_cbranch_scc0 gemnet_accum_kernel_sbag_0
    s_cmp_eq_u32 s73, 0
    s_cselect_b64 exec, s[74:75], -1
    v_add_u32 v98, v98, v74
    v_lshlrev_b32 v74, 2, v98
    v_add_u32 v98, v98, v98
    ds_write_b32 v74, v14
    ds_write_b16 v98, v15 offset:28568
gemnet_accum_kernel_sbag_0:
    s_cmp_gt_u32 s72, 1
    s_cbranch_scc0 gemnet_accum_kernel_sbag_1
    s_cmp_eq_u32 s73, 1
    s_cselect_b64 exec, s[74:75], -1
    v_add_u32 v99, v99, v75
    v_lshlrev_b32 v75, 2, v99
    v_add_u32 v99, v99, v99
    ds_write_b32 v75, v16
    ds_write_b16 v99, v17 offset:28568
gemnet_accum_kernel_sbag_1:
    s_cmp_gt_u32 s72, 2
    s_cbranch_scc0 gemnet_accum_kernel_sbag_2
    s_cmp_eq_u32 s73, 2
    s_cselect_b64 exec, s[74:75], -1
    v_add_u32 v100, v100, v76
    v_lshlrev_b32 v76, 2, v100
    v_add_u32 v100, v100, v100
    ds_write_b32 v76, v18
    ds_write_b16 v100, v19 offset:28568
gemnet_accum_kernel_sbag_2:
    s_cmp_gt_u32 s72, 3
    s_cbranch_scc0 gemnet_accum_kernel_sbag_3
    s_cmp_eq_u32 s73, 3
    s_cselect_b64 exec, s[74:75], -1
    v_add_u32 v101, v101, v77
    v_lshlrev_b32 v77, 2, v101
    v_add_u32 v101, v101, v101
    ds_write_b32 v77, v20
    ds_write_b16 v101, v21 offset:28568
gemnet_accum_kernel_sbag_3:
    s_cmp_gt_u32 s72, 4
    s_cbranch_scc0 gemnet_accum_kernel_sbag_4
    s_cmp_eq_u32 s73, 4
    s_cselect_b64 exec, s[74:75], -1
    v_add_u32 v102, v102, v78
    v_lshlrev_b32 v78, 2, v102
    v_add_u32 v102, v102, v102
    ds_write_b32 v78, v22
    ds_write_b16 v102, v23 offset:28568
gemnet_accum_kernel_sbag_4:
    s_cmp_gt_u32 s76, 4
    s_cbranch_scc0 gemnet_accum_kernel_snag_4
    s_cmp_eq_u32 s77, 4
    s_cselect_b64 exec, s[78:79], -1
    buffer_load_dwordx2 v[52:53], v52, s[8:11], 0 offen
    s_mov_b64 exec, -1
gemnet_accum_kernel_snag_4:
    s_cmp_gt_u32 s72, 5
    s_cbranch_scc0 gemnet_accum_kernel_sbag_5
    s_cmp_eq_u32 s73, 5
    s_cselect_b64 exec, s[74:75], -1
    v_add_u32 v103, v103, v79
    v_lshlrev_b32 v79, 2, v103
    v_add_u32 v103, v103, v103
    ds_write_b32 v79, v24
    ds_write_b16 v103, v25 offset:28568
gemnet_accum_kernel_sbag_5:
    s_cmp_gt_u32 s76, 5
    s_cbranch_scc0 gemnet_accum_kernel_snag_5
    s_cmp_eq_u32 s77, 5
    s_cselect_b64 exec, s[78:79], -1
    buffer_load_dwordx2 v[54:55], v54, s[8:11], 0 offen
    s_mov_b64 exec, -1
gemnet_accum_kernel_snag_5:
    s_cmp_gt_u32 s72, 6
    s_cbranch_scc0 gemnet_accum_kernel_sbag_6
    s_cmp_eq_u32 s73, 6
    s_cselect_b64 exec, s[74:75], -1
    v_add_u32 v104, v104, v80
    v_lshlrev_b32 v80, 2, v104
    v_add_u32 v104, v104, v104
    ds_write_b32 v80, v26
    ds_write_b16 v104, v27 offset:28568
gemnet_accum_kernel_sbag_6:
    s_cmp_gt_u32 s76, 6
    s_cbranch_scc0 gemnet_accum_kernel_snag_6
    s_cmp_eq_u32 s77, 6
    s_cselect_b64 exec, s[78:79], -1
    buffer_load_dwordx2 v[56:57], v56, s[8:11], 0 offen
    s_mov_b64 exec, -1
gemnet_accum_kernel_snag_6:
    s_cmp_gt_u32 s72, 7
    s_cbranch_scc0 gemnet_accum_kernel_sbag_7
    s_cmp_eq_u32 s73, 7
    s_cselect_b64 exec, s[74:75], -1
    v_add_u32 v105, v105, v81
    v_lshlrev_b32 v81, 2, v105
    v_add_u32 v105, v105, v105
    ds_write_b32 v81, v28
    ds_write_b16 v105, v29 offset:28568
gemnet_accum_kernel_sbag_7:
    s_cmp_gt_u32 s76, 7
    s_cbranch_scc0 gemnet_accum_kernel_snag_7
    s_cmp_eq_u32 s77, 7
    s_cselect_b64 exec, s[78:79], -1
    buffer_load_dwordx2 v[58:59], v58, s[8:11], 0 offen
    s_mov_b64 exec, -1
gemnet_accum_kernel_snag_7:
    s_cmp_gt_u32 s72, 8
    s_cbranch_scc0 gemnet_accum_kernel_sbag_8
    s_cmp_eq_u32 s73, 8
    s_cselect_b64 exec, s[74:75], -1
    v_add_u32 v106, v106, v82
    v_lshlrev_b32 v82, 2, v106
    v_add_u32 v106, v106, v106
    ds_write_b32 v82, v30
    ds_write_b16 v106, v31 offset:28568
gemnet_accum_kernel_sbag_8:
    s_cmp_gt_u32 s76, 8
    s_cbranch_scc0 gemnet_accum_kernel_snag_8
    s_cmp_eq_u32 s77, 8
    s_cselect_b64 exec, s[78:79], -1
    buffer_load_dwordx2 v[60:61], v60, s[8:11], 0 offen
    s_mov_b64 exec, -1
gemnet_accum_kernel_snag_8:
    s_cmp_gt_u32 s72, 9
    s_cbranch_scc0 gemnet_accum_kernel_sbag_9
    s_cmp_eq_u32 s73, 9
    s_cselect_b64 exec, s[74:75], -1
    v_add_u32 v107, v107, v83
    v_lshlrev_b32 v83, 2, v107
    v_add_u32 v107, v107, v107
    ds_write_b32 v83, v32
    ds_write_b16 v107, v33 offset:28568
gemnet_accum_kernel_sbag_9:
    s_cmp_gt_u32 s76, 9
    s_cbranch_scc0 gemnet_accum_kernel_snag_9
    s_cmp_eq_u32 s77, 9
    s_cselect_b64 exec, s[78:79], -1
    buffer_load_dwordx2 v[62:63], v62, s[8:11], 0 offen
    s_mov_b64 exec, -1
gemnet_accum_kernel_snag_9:
    s_cmp_gt_u32 s72, 10
    s_cbranch_scc0 gemnet_accum_kernel_sbag_10
    s_cmp_eq_u32 s73, 10
    s_cselect_b64 exec, s[74:75], -1
    v_add_u32 v108, v108, v84
    v_lshlrev_b32 v84, 2, v108
    v_add_u32 v108, v108, v108
    ds_write_b32 v84, v34
    ds_write_b16 v108, v35 offset:28568
gemnet_accum_kernel_sbag_10:
    s_cmp_gt_u32 s76, 10
    s_cbranch_scc0 gemnet_accum_kernel_snag_10
    s_cmp_eq_u32 s77, 10
    s_cselect_b64 exec, s[78:79], -1
    buffer_load_dwordx2 v[64:65], v64, s[8:11], 0 offen
    s_mov_b64 exec, -1
gemnet_accum_kernel_snag_10:
    s_cmp_gt_u32 s72, 11
    s_cbranch_scc0 gemnet_accum_kernel_sbag_11
    s_cmp_eq_u32 s73, 11
    s_cselect_b64 exec, s[74:75], -1
    v_add_u32 v109, v109, v85
    v_lshlrev_b32 v85, 2, v109
    v_add_u32 v109, v109, v109
    ds_write_b32 v85, v36
    ds_write_b16 v109, v37 offset:28568
gemnet_accum_kernel_sbag_11:
    s_cmp_gt_u32 s76, 11
    s_cbranch_scc0 gemnet_accum_kernel_snag_11
    s_cmp_eq_u32 s77, 11
    s_cselect_b64 exec, s[78:79], -1
    buffer_load_dwordx2 v[66:67], v66, s[8:11], 0 offen
    s_mov_b64 exec, -1
gemnet_accum_kernel_snag_11:
    s_cmp_gt_u32 s72, 12
    s_cbranch_scc0 gemnet_accum_kernel_sbag_12
    s_cmp_eq_u32 s73, 12
    s_cselect_b64 exec, s[74:75], -1
    v_add_u32 v110, v110, v86
    v_lshlrev_b32 v86, 2, v110
    v_add_u32 v110, v110, v110
    ds_write_b32 v86, v38
    ds_write_b16 v110, v39 offset:28568
gemnet_accum_kernel_sbag_12:
    s_cmp_gt_u32 s76, 12
    s_cbranch_scc0 gemnet_accum_kernel_snag_12
    s_cmp_eq_u32 s77, 12
    s_cselect_b64 exec, s[78:79], -1
    buffer_load_dwordx2 v[68:69], v68, s[8:11], 0 offen
    s_mov_b64 exec, -1
gemnet_accum_kernel_snag_12:
    s_cmp_gt_u32 s72, 13
    s_cbranch_scc0 gemnet_accum_kernel_sbag_13
    s_cmp_eq_u32 s73, 13
    s_cselect_b64 exec, s[74:75], -1
    v_add_u32 v111, v111, v87
    v_lshlrev_b32 v87, 2, v111
    v_add_u32 v111, v111, v111
    ds_write_b32 v87, v40
    ds_write_b16 v111, v41 offset:28568
gemnet_accum_kernel_sbag_13:
    s_cmp_gt_u32 s76, 13
    s_cbranch_scc0 gemnet_accum_kernel_snag_13
    s_cmp_eq_u32 s77, 13
    s_cselect_b64 exec, s[78:79], -1
    buffer_load_dwordx2 v[70:71], v70, s[8:11], 0 offen
    s_mov_b64 exec, -1
gemnet_accum_kernel_snag_13:
    s_cmp_gt_u32 s72, 14
    s_cbranch_scc0 gemnet_accum_kernel_sbag_14
    s_cmp_eq_u32 s73, 14
    s_cselect_b64 exec, s[74:75], -1
    v_add_u32 v112, v112, v88
    v_lshlrev_b32 v88, 2, v112
    v_add_u32 v112, v112, v112
    ds_write_b32 v88, v42
    ds_write_b16 v112, v43 offset:28568
gemnet_accum_kernel_sbag_14:
    s_cmp_gt_u32 s76, 14
    s_cbranch_scc0 gemnet_accum_kernel_snag_14
    s_cmp_eq_u32 s77, 14
    s_cselect_b64 exec, s[78:79], -1
    buffer_load_dwordx2 v[72:73], v72, s[8:11], 0 offen
    s_mov_b64 exec, -1
gemnet_accum_kernel_snag_14:
gemnet_accum_kernel_scea:
    s_mov_b64 exec, -1
    s_waitcnt lgkmcnt(0)
    s_barrier
    v_mov_b32 v6, v7
    v_mov_b32 v10, v11
    v_mov_b32 v7, v8
    v_mov_b32 v11, v12
    v_mov_b32 v8, v9
    v_mov_b32 v12, v13
    s_add_u32 s81, s81, 1
    s_branch gemnet_accum_kernel_loop
gemnet_accum_kernel_fastdone:
    s_waitcnt vmcnt(0) lgkmcnt(0)
    s_branch gemnet_accum_kernel_epi
gemnet_accum_kernel_slow:
    s_waitcnt vmcnt(0)
    s_mov_b32 s23, 0
    s_mov_b32 s81, 0
gemnet_accum_kernel_sloop:
    v_sub_u32_sdwa v90, v10, v6 dst_sel:DWORD dst_unused:UNUSED_PAD src0_sel:WORD_0 src1_sel:WORD_0
    v_and_b32 v91, 0xffff, v6
    v_mul_u32_u24 v91, 6, v91
    v_add_u32 v91, v4, v91
    s_mov_b32 s64, 0
gemnet_accum_kernel_segs0:
    s_nop 0
    v_readlane_b32 s65, v90, s64
    v_readlane_b32 s66, v91, s64
gemnet_accum_kernel_chunks0:
    s_cmp_gt_i32 s65, 0
    s_cbranch_scc0 gemnet_accum_kernel_segends0
    v_cmp_gt_u32 s[58:59], s65, v1
    v_add_u32 v15, s66, v2
    v_and_b32 v14, -4, v15
    v_cmp_ne_u32 s[62:63], v14, v15
    s_mov_b64 exec, s[58:59]
    buffer_load_dwordx2 v[14:15], v14, s[8:11], 0 offen
    s_waitcnt vmcnt(0)
    v_lshrrev_b32 v18, 16, v14
    v_cndmask_b32 v14, v14, v15, s[62:63]
    v_cndmask_b32 v15, v15, v18, s[62:63]
    v_and_b32 v18, 0xffff8, v14
    v_lshlrev_b32 v15, 16, v15
    buffer_load_dwordx2 v[16:17], v18, s[4:7], s23 offen
    v_lshrrev_b32 v96, 16, v14
    v_and_b32 v96, 0xfff0, v96
    ds_read_b128 v[92:95], v96 offset:33760
    v_mul_f32 v97, s20, v15
    v_mul_f32 v98, s21, v15
    v_fract_f32 v97, v97
    v_fract_f32 v98, v98
    v_cos_f32 v97, v97
    v_cos_f32 v98, v98
    v_lshrrev_b32 v14, 17, v14
    v_and_b32 v14, 0x7ff8, v14
    v_cvt_pk_bf16_f32 v99, v97, v98
    s_waitcnt vmcnt(0)
    v_dot2_f32_bf16 v100, v16, s12, 0
    v_dot2_f32_bf16 v101, v16, s13, 0
    v_dot2_f32_bf16 v102, v16, s14, 0
    v_dot2_f32_bf16 v103, v16, s15, 0
    v_dot2_f32_bf16 v100, v17, s16, v100
    v_dot2_f32_bf16 v101, v17, s17, v101
    v_dot2_f32_bf16 v102, v17, s18, v102
    v_dot2_f32_bf16 v103, v17, s19, v103
    s_waitcnt lgkmcnt(0)
    v_dot2_f32_bf16 v104, v92, v99, 0
    v_dot2_f32_bf16 v105, v93, v99, 0
    v_dot2_f32_bf16 v106, v94, v99, 0
    v_dot2_f32_bf16 v107, v95, v99, 0
    s_nop 2
    v_mul_f32 v114, v100, v104
    v_mul_f32 v115, v101, v105
    v_mul_f32 v116, v102, v106
    v_mul_f32 v117, v103, v107
    v_cvt_pk_bf16_f32 v112, v114, v115
    v_cvt_pk_bf16_f32 v113, v116, v117
    ds_pk_add_bf16 v14, v112 offset:8752
    ds_pk_add_bf16 v14, v113 offset:8756
    s_mov_b64 exec, -1
    s_sub_i32 s65, s65, 64
    s_add_u32 s66, s66, 384
    s_branch gemnet_accum_kernel_chunks0
gemnet_accum_kernel_segends0:
    s_add_u32 s64, s64, 1
    s_cmp_lt_u32 s64, 64
    s_cbranch_scc1 gemnet_accum_kernel_segs0
    s_add_u32 s23, s23, 800000
    v_sub_u32_sdwa v90, v10, v6 dst_sel:DWORD dst_unused:UNUSED_PAD src0_sel:WORD_1 src1_sel:WORD_1
    v_lshrrev_b32 v91, 16, v6
    v_mul_u32_u24 v91, 6, v91
    v_add_u32 v91, v4, v91
    s_mov_b32 s64, 0
gemnet_accum_kernel_segs1:
    s_nop 0
    v_readlane_b32 s65, v90, s64
    v_readlane_b32 s66, v91, s64
gemnet_accum_kernel_chunks1:
    s_cmp_gt_i32 s65, 0
    s_cbranch_scc0 gemnet_accum_kernel_segends1
    v_cmp_gt_u32 s[58:59], s65, v1
    v_add_u32 v15, s66, v2
    v_and_b32 v14, -4, v15
    v_cmp_ne_u32 s[62:63], v14, v15
    s_mov_b64 exec, s[58:59]
    buffer_load_dwordx2 v[14:15], v14, s[8:11], 0 offen
    s_waitcnt vmcnt(0)
    v_lshrrev_b32 v18, 16, v14
    v_cndmask_b32 v14, v14, v15, s[62:63]
    v_cndmask_b32 v15, v15, v18, s[62:63]
    v_and_b32 v18, 0xffff8, v14
    v_lshlrev_b32 v15, 16, v15
    buffer_load_dwordx2 v[16:17], v18, s[4:7], s23 offen
    v_lshrrev_b32 v96, 16, v14
    v_and_b32 v96, 0xfff0, v96
    ds_read_b128 v[92:95], v96 offset:33760
    v_mul_f32 v97, s20, v15
    v_mul_f32 v98, s21, v15
    v_fract_f32 v97, v97
    v_fract_f32 v98, v98
    v_cos_f32 v97, v97
    v_cos_f32 v98, v98
    v_lshrrev_b32 v14, 17, v14
    v_and_b32 v14, 0x7ff8, v14
    v_cvt_pk_bf16_f32 v99, v97, v98
    s_waitcnt vmcnt(0)
    v_dot2_f32_bf16 v100, v16, s12, 0
    v_dot2_f32_bf16 v101, v16, s13, 0
    v_dot2_f32_bf16 v102, v16, s14, 0
    v_dot2_f32_bf16 v103, v16, s15, 0
    v_dot2_f32_bf16 v100, v17, s16, v100
    v_dot2_f32_bf16 v101, v17, s17, v101
    v_dot2_f32_bf16 v102, v17, s18, v102
    v_dot2_f32_bf16 v103, v17, s19, v103
    s_waitcnt lgkmcnt(0)
    v_dot2_f32_bf16 v104, v92, v99, 0
    v_dot2_f32_bf16 v105, v93, v99, 0
    v_dot2_f32_bf16 v106, v94, v99, 0
    v_dot2_f32_bf16 v107, v95, v99, 0
    s_nop 2
    v_mul_f32 v114, v100, v104
    v_mul_f32 v115, v101, v105
    v_mul_f32 v116, v102, v106
    v_mul_f32 v117, v103, v107
    v_cvt_pk_bf16_f32 v112, v114, v115
    v_cvt_pk_bf16_f32 v113, v116, v117
    ds_pk_add_bf16 v14, v112 offset:8752
    ds_pk_add_bf16 v14, v113 offset:8756
    s_mov_b64 exec, -1
    s_sub_i32 s65, s65, 64
    s_add_u32 s66, s66, 384
    s_branch gemnet_accum_kernel_chunks1
gemnet_accum_kernel_segends1:
    s_add_u32 s64, s64, 1
    s_cmp_lt_u32 s64, 64
    s_cbranch_scc1 gemnet_accum_kernel_segs1
    s_add_u32 s23, s23, 800000
    v_mov_b32 v6, v7
    v_mov_b32 v10, v11
    v_mov_b32 v7, v8
    v_mov_b32 v11, v12
    v_mov_b32 v8, v9
    v_mov_b32 v12, v13
    s_add_u32 s81, s81, 1
    s_cmp_lt_u32 s81, 4
    s_cbranch_scc1 gemnet_accum_kernel_sloop
    s_waitcnt lgkmcnt(0)
gemnet_accum_kernel_epi:
    s_lshl_b32 s64, s22, 6
    v_add_u32 v0, s64, v1
    s_load_dwordx16 s[28:43], s[100:101], 0
    s_load_dwordx8 s[44:51], s[96:97], 0
    s_load_dwordx4 s[52:55], s[94:95], 0
    s_mov_b32 s76, s92
    s_and_b32 s77, s93, 0xffff
    s_mov_b32 s78, 1600000
    s_mov_b32 s79, 0x00020000
    s_mov_b32 s84, s98
    s_and_b32 s85, s99, 0xffff
    s_mov_b32 s86, 6400000
    s_mov_b32 s87, 0x00020000
    s_mul_i32 s74, s3, 6250
    s_mul_i32 s73, s3, 25000
    v_lshlrev_b32 v14, 1, v0
    v_lshlrev_b32 v15, 3, v0
    s_add_u32 s75, s74, 0
    s_add_u32 s72, s73, 0
    buffer_load_ushort v16, v14, s[76:79], s75 offen
    buffer_load_dwordx2 v[20:21], v15, s[4:7], s72 offen
    s_add_u32 s75, s74, 2048
    s_add_u32 s72, s73, 8192
    buffer_load_ushort v17, v14, s[76:79], s75 offen
    buffer_load_dwordx2 v[22:23], v15, s[4:7], s72 offen
    s_add_u32 s75, s74, 4096
    s_add_u32 s72, s73, 16384
    buffer_load_ushort v18, v14, s[76:79], s75 offen
    buffer_load_dwordx2 v[24:25], v15, s[4:7], s72 offen
    s_add_u32 s75, s74, 6144
    s_add_u32 s72, s73, 24576
    buffer_load_ushort v19, v14, s[76:79], s75 offen
    buffer_load_dwordx2 v[26:27], v15, s[4:7], s72 offen
    s_waitcnt lgkmcnt(0)
    s_barrier
    ds_read_b64 v[28:29], v15 offset:8752
    ds_read_b64 v[30:31], v15 offset:16944
    ds_read_b64 v[32:33], v15 offset:25136
    ds_read_b64 v[34:35], v15 offset:33328
    s_pack_ll_b32_b16 s56, s28, s30
    s_pack_hh_b32_b16 s57, s28, s30
    s_pack_ll_b32_b16 s58, s29, s31
    s_pack_hh_b32_b16 s59, s29, s31
    s_pack_ll_b32_b16 s60, s32, s34
    s_pack_hh_b32_b16 s61, s32, s34
    s_pack_ll_b32_b16 s62, s33, s35
    s_pack_hh_b32_b16 s63, s33, s35
    s_pack_ll_b32_b16 s64, s36, s38
    s_pack_hh_b32_b16 s65, s36, s38
    s_pack_ll_b32_b16 s66, s37, s39
    s_pack_hh_b32_b16 s67, s37, s39
    s_pack_ll_b32_b16 s68, s40, s42
    s_pack_hh_b32_b16 s69, s40, s42
    s_pack_ll_b32_b16 s70, s41, s43
    s_pack_hh_b32_b16 s71, s41, s43
    s_pack_ll_b32_b16 s12, s44, s46
    s_pack_ll_b32_b16 s16, s48, s50
    s_pack_hh_b32_b16 s13, s44, s46
    s_pack_hh_b32_b16 s17, s48, s50
    s_pack_ll_b32_b16 s14, s45, s47
    s_pack_ll_b32_b16 s18, s49, s51
    s_pack_hh_b32_b16 s15, s45, s47
    s_pack_hh_b32_b16 s19, s49, s51
    s_lshl_b32 s92, s52, 16
    s_and_b32 s93, s52, 0xffff0000
    s_lshl_b32 s94, s53, 16
    s_and_b32 s95, s53, 0xffff0000
    s_lshl_b32 s96, s54, 16
    s_and_b32 s97, s54, 0xffff0000
    s_lshl_b32 s98, s55, 16
    s_and_b32 s99, s55, 0xffff0000
    s_waitcnt vmcnt(0) lgkmcnt(0)
    v_lshlrev_b32 v16, 16, v16
    v_subrev_f32 v44, s92, v16
    v_subrev_f32 v45, s93, v16
    v_subrev_f32 v46, s94, v16
    v_subrev_f32 v47, s95, v16
    v_subrev_f32 v48, s96, v16
    v_subrev_f32 v49, s97, v16
    v_subrev_f32 v50, s98, v16
    v_subrev_f32 v51, s99, v16
    v_mul_f32 v44, v44, v44
    v_mul_f32 v45, v45, v45
    v_mul_f32 v46, v46, v46
    v_mul_f32 v47, v47, v47
    v_mul_f32 v48, v48, v48
    v_mul_f32 v49, v49, v49
    v_mul_f32 v50, v50, v50
    v_mul_f32 v51, v51, v51
    v_mul_f32 v44, 0xc166d4ca, v44
    v_mul_f32 v45, 0xc166d4ca, v45
    v_mul_f32 v46, 0xc166d4ca, v46
    v_mul_f32 v47, 0xc166d4ca, v47
    v_mul_f32 v48, 0xc166d4ca, v48
    v_mul_f32 v49, 0xc166d4ca, v49
    v_mul_f32 v50, 0xc166d4ca, v50
    v_mul_f32 v51, 0xc166d4ca, v51
    v_exp_f32 v44, v44
    v_exp_f32 v45, v45
    v_exp_f32 v46, v46
    v_exp_f32 v47, v47
    v_exp_f32 v48, v48
    v_exp_f32 v49, v49
    v_exp_f32 v50, v50
    v_exp_f32 v51, v51
    s_nop 0
    v_cvt_pk_bf16_f32 v52, v44, v45
    v_cvt_pk_bf16_f32 v53, v46, v47
    v_cvt_pk_bf16_f32 v54, v48, v49
    v_cvt_pk_bf16_f32 v55, v50, v51
    v_dot2_f32_bf16 v56, v52, s56, 0
    v_dot2_f32_bf16 v56, v53, s60, v56
    v_dot2_f32_bf16 v56, v54, s64, v56
    v_dot2_f32_bf16 v56, v55, s68, v56
    v_dot2_f32_bf16 v57, v52, s57, 0
    v_dot2_f32_bf16 v57, v53, s61, v57
    v_dot2_f32_bf16 v57, v54, s65, v57
    v_dot2_f32_bf16 v57, v55, s69, v57
    v_dot2_f32_bf16 v58, v52, s58, 0
    v_dot2_f32_bf16 v58, v53, s62, v58
    v_dot2_f32_bf16 v58, v54, s66, v58
    v_dot2_f32_bf16 v58, v55, s70, v58
    v_dot2_f32_bf16 v59, v52, s59, 0
    v_dot2_f32_bf16 v59, v53, s63, v59
    v_dot2_f32_bf16 v59, v54, s67, v59
    v_dot2_f32_bf16 v59, v55, s71, v59
    v_dot2_f32_bf16 v60, v28, s12, 0
    v_dot2_f32_bf16 v61, v28, s13, 0
    v_dot2_f32_bf16 v62, v28, s14, 0
    v_dot2_f32_bf16 v63, v28, s15, 0
    v_dot2_f32_bf16 v60, v29, s16, v60
    v_dot2_f32_bf16 v61, v29, s17, v61
    v_dot2_f32_bf16 v62, v29, s18, v62
    v_dot2_f32_bf16 v63, v29, s19, v63
    v_lshlrev_b32 v64, 16, v20
    v_and_b32 v65, 0xffff0000, v20
    v_lshlrev_b32 v66, 16, v21
    v_and_b32 v67, 0xffff0000, v21
    v_fmac_f32 v64, v60, v56
    v_fmac_f32 v65, v61, v57
    v_fmac_f32 v66, v62, v58
    v_fmac_f32 v67, v63, v59
    v_cvt_pk_bf16_f32 v68, v64, v65
    v_cvt_pk_bf16_f32 v69, v66, v67
    s_add_u32 s72, s73, 0
    buffer_store_dwordx2 v[68:69], v15, s[84:87], s72 offen
    v_lshlrev_b32 v17, 16, v17
    v_subrev_f32 v44, s92, v17
    v_subrev_f32 v45, s93, v17
    v_subrev_f32 v46, s94, v17
    v_subrev_f32 v47, s95, v17
    v_subrev_f32 v48, s96, v17
    v_subrev_f32 v49, s97, v17
    v_subrev_f32 v50, s98, v17
    v_subrev_f32 v51, s99, v17
    v_mul_f32 v44, v44, v44
    v_mul_f32 v45, v45, v45
    v_mul_f32 v46, v46, v46
    v_mul_f32 v47, v47, v47
    v_mul_f32 v48, v48, v48
    v_mul_f32 v49, v49, v49
    v_mul_f32 v50, v50, v50
    v_mul_f32 v51, v51, v51
    v_mul_f32 v44, 0xc166d4ca, v44
    v_mul_f32 v45, 0xc166d4ca, v45
    v_mul_f32 v46, 0xc166d4ca, v46
    v_mul_f32 v47, 0xc166d4ca, v47
    v_mul_f32 v48, 0xc166d4ca, v48
    v_mul_f32 v49, 0xc166d4ca, v49
    v_mul_f32 v50, 0xc166d4ca, v50
    v_mul_f32 v51, 0xc166d4ca, v51
    v_exp_f32 v44, v44
    v_exp_f32 v45, v45
    v_exp_f32 v46, v46
    v_exp_f32 v47, v47
    v_exp_f32 v48, v48
    v_exp_f32 v49, v49
    v_exp_f32 v50, v50
    v_exp_f32 v51, v51
    s_nop 0
    v_cvt_pk_bf16_f32 v52, v44, v45
    v_cvt_pk_bf16_f32 v53, v46, v47
    v_cvt_pk_bf16_f32 v54, v48, v49
    v_cvt_pk_bf16_f32 v55, v50, v51
    v_dot2_f32_bf16 v56, v52, s56, 0
    v_dot2_f32_bf16 v56, v53, s60, v56
    v_dot2_f32_bf16 v56, v54, s64, v56
    v_dot2_f32_bf16 v56, v55, s68, v56
    v_dot2_f32_bf16 v57, v52, s57, 0
    v_dot2_f32_bf16 v57, v53, s61, v57
    v_dot2_f32_bf16 v57, v54, s65, v57
    v_dot2_f32_bf16 v57, v55, s69, v57
    v_dot2_f32_bf16 v58, v52, s58, 0
    v_dot2_f32_bf16 v58, v53, s62, v58
    v_dot2_f32_bf16 v58, v54, s66, v58
    v_dot2_f32_bf16 v58, v55, s70, v58
    v_dot2_f32_bf16 v59, v52, s59, 0
    v_dot2_f32_bf16 v59, v53, s63, v59
    v_dot2_f32_bf16 v59, v54, s67, v59
    v_dot2_f32_bf16 v59, v55, s71, v59
    v_dot2_f32_bf16 v60, v30, s12, 0
    v_dot2_f32_bf16 v61, v30, s13, 0
    v_dot2_f32_bf16 v62, v30, s14, 0
    v_dot2_f32_bf16 v63, v30, s15, 0
    v_dot2_f32_bf16 v60, v31, s16, v60
    v_dot2_f32_bf16 v61, v31, s17, v61
    v_dot2_f32_bf16 v62, v31, s18, v62
    v_dot2_f32_bf16 v63, v31, s19, v63
    v_lshlrev_b32 v64, 16, v22
    v_and_b32 v65, 0xffff0000, v22
    v_lshlrev_b32 v66, 16, v23
    v_and_b32 v67, 0xffff0000, v23
    v_fmac_f32 v64, v60, v56
    v_fmac_f32 v65, v61, v57
    v_fmac_f32 v66, v62, v58
    v_fmac_f32 v67, v63, v59
    v_cvt_pk_bf16_f32 v68, v64, v65
    v_cvt_pk_bf16_f32 v69, v66, v67
    s_add_u32 s72, s73, 8192
    buffer_store_dwordx2 v[68:69], v15, s[84:87], s72 offen
    v_lshlrev_b32 v18, 16, v18
    v_subrev_f32 v44, s92, v18
    v_subrev_f32 v45, s93, v18
    v_subrev_f32 v46, s94, v18
    v_subrev_f32 v47, s95, v18
    v_subrev_f32 v48, s96, v18
    v_subrev_f32 v49, s97, v18
    v_subrev_f32 v50, s98, v18
    v_subrev_f32 v51, s99, v18
    v_mul_f32 v44, v44, v44
    v_mul_f32 v45, v45, v45
    v_mul_f32 v46, v46, v46
    v_mul_f32 v47, v47, v47
    v_mul_f32 v48, v48, v48
    v_mul_f32 v49, v49, v49
    v_mul_f32 v50, v50, v50
    v_mul_f32 v51, v51, v51
    v_mul_f32 v44, 0xc166d4ca, v44
    v_mul_f32 v45, 0xc166d4ca, v45
    v_mul_f32 v46, 0xc166d4ca, v46
    v_mul_f32 v47, 0xc166d4ca, v47
    v_mul_f32 v48, 0xc166d4ca, v48
    v_mul_f32 v49, 0xc166d4ca, v49
    v_mul_f32 v50, 0xc166d4ca, v50
    v_mul_f32 v51, 0xc166d4ca, v51
    v_exp_f32 v44, v44
    v_exp_f32 v45, v45
    v_exp_f32 v46, v46
    v_exp_f32 v47, v47
    v_exp_f32 v48, v48
    v_exp_f32 v49, v49
    v_exp_f32 v50, v50
    v_exp_f32 v51, v51
    s_nop 0
    v_cvt_pk_bf16_f32 v52, v44, v45
    v_cvt_pk_bf16_f32 v53, v46, v47
    v_cvt_pk_bf16_f32 v54, v48, v49
    v_cvt_pk_bf16_f32 v55, v50, v51
    v_dot2_f32_bf16 v56, v52, s56, 0
    v_dot2_f32_bf16 v56, v53, s60, v56
    v_dot2_f32_bf16 v56, v54, s64, v56
    v_dot2_f32_bf16 v56, v55, s68, v56
    v_dot2_f32_bf16 v57, v52, s57, 0
    v_dot2_f32_bf16 v57, v53, s61, v57
    v_dot2_f32_bf16 v57, v54, s65, v57
    v_dot2_f32_bf16 v57, v55, s69, v57
    v_dot2_f32_bf16 v58, v52, s58, 0
    v_dot2_f32_bf16 v58, v53, s62, v58
    v_dot2_f32_bf16 v58, v54, s66, v58
    v_dot2_f32_bf16 v58, v55, s70, v58
    v_dot2_f32_bf16 v59, v52, s59, 0
    v_dot2_f32_bf16 v59, v53, s63, v59
    v_dot2_f32_bf16 v59, v54, s67, v59
    v_dot2_f32_bf16 v59, v55, s71, v59
    v_dot2_f32_bf16 v60, v32, s12, 0
    v_dot2_f32_bf16 v61, v32, s13, 0
    v_dot2_f32_bf16 v62, v32, s14, 0
    v_dot2_f32_bf16 v63, v32, s15, 0
    v_dot2_f32_bf16 v60, v33, s16, v60
    v_dot2_f32_bf16 v61, v33, s17, v61
    v_dot2_f32_bf16 v62, v33, s18, v62
    v_dot2_f32_bf16 v63, v33, s19, v63
    v_lshlrev_b32 v64, 16, v24
    v_and_b32 v65, 0xffff0000, v24
    v_lshlrev_b32 v66, 16, v25
    v_and_b32 v67, 0xffff0000, v25
    v_fmac_f32 v64, v60, v56
    v_fmac_f32 v65, v61, v57
    v_fmac_f32 v66, v62, v58
    v_fmac_f32 v67, v63, v59
    v_cvt_pk_bf16_f32 v68, v64, v65
    v_cvt_pk_bf16_f32 v69, v66, v67
    s_add_u32 s72, s73, 16384
    buffer_store_dwordx2 v[68:69], v15, s[84:87], s72 offen
    s_cmp_eq_u32 s22, 0
    s_cbranch_scc0 gemnet_accum_kernel_exit
    v_cmp_gt_u32 vcc, 53, v0
    s_and_saveexec_b64 s[82:83], vcc
    v_lshlrev_b32 v19, 16, v19
    v_subrev_f32 v44, s92, v19
    v_subrev_f32 v45, s93, v19
    v_subrev_f32 v46, s94, v19
    v_subrev_f32 v47, s95, v19
    v_subrev_f32 v48, s96, v19
    v_subrev_f32 v49, s97, v19
    v_subrev_f32 v50, s98, v19
    v_subrev_f32 v51, s99, v19
    v_mul_f32 v44, v44, v44
    v_mul_f32 v45, v45, v45
    v_mul_f32 v46, v46, v46
    v_mul_f32 v47, v47, v47
    v_mul_f32 v48, v48, v48
    v_mul_f32 v49, v49, v49
    v_mul_f32 v50, v50, v50
    v_mul_f32 v51, v51, v51
    v_mul_f32 v44, 0xc166d4ca, v44
    v_mul_f32 v45, 0xc166d4ca, v45
    v_mul_f32 v46, 0xc166d4ca, v46
    v_mul_f32 v47, 0xc166d4ca, v47
    v_mul_f32 v48, 0xc166d4ca, v48
    v_mul_f32 v49, 0xc166d4ca, v49
    v_mul_f32 v50, 0xc166d4ca, v50
    v_mul_f32 v51, 0xc166d4ca, v51
    v_exp_f32 v44, v44
    v_exp_f32 v45, v45
    v_exp_f32 v46, v46
    v_exp_f32 v47, v47
    v_exp_f32 v48, v48
    v_exp_f32 v49, v49
    v_exp_f32 v50, v50
    v_exp_f32 v51, v51
    s_nop 0
    v_cvt_pk_bf16_f32 v52, v44, v45
    v_cvt_pk_bf16_f32 v53, v46, v47
    v_cvt_pk_bf16_f32 v54, v48, v49
    v_cvt_pk_bf16_f32 v55, v50, v51
    v_dot2_f32_bf16 v56, v52, s56, 0
    v_dot2_f32_bf16 v56, v53, s60, v56
    v_dot2_f32_bf16 v56, v54, s64, v56
    v_dot2_f32_bf16 v56, v55, s68, v56
    v_dot2_f32_bf16 v57, v52, s57, 0
    v_dot2_f32_bf16 v57, v53, s61, v57
    v_dot2_f32_bf16 v57, v54, s65, v57
    v_dot2_f32_bf16 v57, v55, s69, v57
    v_dot2_f32_bf16 v58, v52, s58, 0
    v_dot2_f32_bf16 v58, v53, s62, v58
    v_dot2_f32_bf16 v58, v54, s66, v58
    v_dot2_f32_bf16 v58, v55, s70, v58
    v_dot2_f32_bf16 v59, v52, s59, 0
    v_dot2_f32_bf16 v59, v53, s63, v59
    v_dot2_f32_bf16 v59, v54, s67, v59
    v_dot2_f32_bf16 v59, v55, s71, v59
    v_dot2_f32_bf16 v60, v34, s12, 0
    v_dot2_f32_bf16 v61, v34, s13, 0
    v_dot2_f32_bf16 v62, v34, s14, 0
    v_dot2_f32_bf16 v63, v34, s15, 0
    v_dot2_f32_bf16 v60, v35, s16, v60
    v_dot2_f32_bf16 v61, v35, s17, v61
    v_dot2_f32_bf16 v62, v35, s18, v62
    v_dot2_f32_bf16 v63, v35, s19, v63
    v_lshlrev_b32 v64, 16, v26
    v_and_b32 v65, 0xffff0000, v26
    v_lshlrev_b32 v66, 16, v27
    v_and_b32 v67, 0xffff0000, v27
    v_fmac_f32 v64, v60, v56
    v_fmac_f32 v65, v61, v57
    v_fmac_f32 v66, v62, v58
    v_fmac_f32 v67, v63, v59
    v_cvt_pk_bf16_f32 v68, v64, v65
    v_cvt_pk_bf16_f32 v69, v66, v67
    s_add_u32 s72, s73, 24576
    buffer_store_dwordx2 v[68:69], v15, s[84:87], s72 offen
gemnet_accum_kernel_exit:
    s_endpgm
.section .rodata,"a"
.p2align 6
.amdhsa_kernel gemnet_part_kernel
  .amdhsa_next_free_vgpr 128
  .amdhsa_next_free_sgpr 80
  .amdhsa_accum_offset 128
  .amdhsa_group_segment_fixed_size 0
  .amdhsa_kernarg_size 112
  .amdhsa_user_sgpr_count 2
  .amdhsa_user_sgpr_kernarg_segment_ptr 1
  .amdhsa_system_sgpr_workgroup_id_x 1
  .amdhsa_float_denorm_mode_32 3
.end_amdhsa_kernel
.p2align 6
.amdhsa_kernel gemnet_accum_kernel
  .amdhsa_next_free_vgpr 128
  .amdhsa_next_free_sgpr 102
  .amdhsa_accum_offset 128
  .amdhsa_group_segment_fixed_size 0
  .amdhsa_kernarg_size 112
  .amdhsa_user_sgpr_count 2
  .amdhsa_user_sgpr_kernarg_segment_ptr 1
  .amdhsa_system_sgpr_workgroup_id_x 1
  .amdhsa_float_denorm_mode_32 3
.end_amdhsa_kernel
```
